```python
import torch

def _softmax(x, axis=-1):
    return torch.softmax(x, dim=axis)
def _gelu(x):
    return torch.nn.functional.gelu(x, approximate="tanh")
def _silu(x):
    return torch.nn.functional.silu(x)
def _sigmoid(x):
    return torch.sigmoid(x)
def _layernorm(x, axis=-1, eps=1e-5):
    m = x.mean(dim=axis, keepdim=True)
    v = x.var(dim=axis, keepdim=True, unbiased=False)
    return (x - m) / torch.sqrt(v + eps)
def _scatter_add(tgt, idx, src, axis=0):
    return tgt.clone().index_add_(axis, idx, src)
def _segment_sum(src, seg, n):
    out = torch.zeros((n,) + src.shape[1:], dtype=src.dtype)
    return out.index_add_(0, seg, src)
def _pad(x, pw):
    flat = tuple(v for pair in reversed(pw) for v in pair)
    return torch.nn.functional.pad(x, flat)

kernel_name = 'sequential_preLN__linear_attn_block__glu_gated_reglu__prompt'

def setup_inputs():

    _w = (lambda a: (lambda t: t.to(torch.bfloat16) if t.is_floating_point() else t)(torch.as_tensor(a)))
    def _A_setup():
        B, S, D = 1, 2048, 640
        return {
            "x": _w((lambda *s: torch.randn(*s, dtype=torch.bfloat16) * 0.05)(B, S, D)),
            "wqkv": _w((lambda *s: torch.randn(*s, dtype=torch.bfloat16) * 0.05)(D, 3 * D)),
            "wo": _w((lambda *s: torch.randn(*s, dtype=torch.bfloat16) * 0.05)(D, D)),
        }
    _A_in = _A_setup()

    def _B_setup():
        B, S, D, F = 1, 2048, 640, 1728
        return {
            "x": _w((lambda *s: torch.randn(*s, dtype=torch.bfloat16) * 0.05)(B, S, D)),
            "W_gate": _w((lambda *s: torch.randn(*s, dtype=torch.bfloat16) * 0.2)(D, F) * (2.0 / D) ** 0.5),
            "W_up": _w((lambda *s: torch.randn(*s, dtype=torch.bfloat16) * 0.2)(D, F) * (2.0 / D) ** 0.5),
            "W_down": _w((lambda *s: torch.randn(*s, dtype=torch.bfloat16) * 0.2)(F, D) * (1.0 / F) ** 0.5),
        }
    _B_in = _B_setup()

    return {
        "A_x": _A_in["x"],
        "A_wqkv": _A_in["wqkv"],
        "A_wo": _A_in["wo"],
        "B_x": _B_in["x"],
        "B_W_gate": _B_in["W_gate"],
        "B_W_up": _B_in["W_up"],
        "B_W_down": _B_in["W_down"],
    }

def reference(A_x, A_wqkv, A_wo, B_x, B_W_gate, B_W_up, B_W_down):
    def _A_ref(x, wqkv, wo):
        B, S, D = x.shape
        H = 32; Dh = D // H
        qkv = (lambda x, *d: x.permute(*d))((x @ wqkv).reshape(B, S, 3, H, Dh), 2, 0, 3, 1, 4)
        q, k, v = qkv[0], qkv[1], qkv[2]
        phi = lambda t: torch.where(t > 0, t + 1, torch.exp(t)) + 1e-6
        pq, pk = phi(q), phi(k)
        kv = torch.einsum("bhsd,bhse->bhde", pk, v)
        z = torch.einsum("bhsd->bhd", pk)
        num = torch.einsum("bhqd,bhde->bhqe", pq, kv)
        den = torch.einsum("bhqd,bhd->bhq", pq, z)[..., None] + 1e-6
        o = num / den
        return (lambda x, *d: x.permute(*d))(o, 0, 2, 1, 3).reshape(B, S, D) @ wo

    def _B_ref(x, W_gate, W_up, W_down):
        gate = torch.einsum("bsd,df->bsf", x, W_gate)
        up = torch.einsum("bsd,df->bsf", x, W_up)
        gate = gate * (lambda x, dt: x.to(dt))(gate > 0, gate.dtype)
        h = gate * up
        return torch.einsum("bsf,fd->bsd", h, W_down)

    x = A_x
    h = x + _A_ref(_layernorm(x, axis=-1), A_wqkv, A_wo)
    h2 = h + _B_ref(_layernorm(h, axis=-1), B_W_gate, B_W_up, B_W_down)
    return h2
```

```asm
; @launch grid=(256,1,1) block=(256,1,1) lds=163840
.amdgcn_target "amdgcn-amd-amdhsa--gfx950"
.text
.globl sequential_preLN__linear_attn_block__glu_gated_reglu__prompt_kernel
.p2align 8
.type sequential_preLN__linear_attn_block__glu_gated_reglu__prompt_kernel,@function
sequential_preLN__linear_attn_block__glu_gated_reglu__prompt_kernel:
    s_cmp_ge_u32 s2, 256
    s_cbranch_scc1 L_end
    s_load_dwordx16 s[40:55], s[0:1], 0
    s_load_dwordx4 s[56:59], s[0:1], 64
    v_and_b32 v1, 63, v0
    v_lshrrev_b32 v2, 6, v0
    s_and_b32 s64, s2, 7
    v_readfirstlane_b32 s60, v2
    s_lshr_b32 s65, s2, 3
    s_and_b32 s63, s65, 7
    s_lshr_b32 s66, s64, 1
    s_lshl_b32 s66, s66, 3
    s_add_u32 s61, s66, s63
    s_and_b32 s66, s64, 1
    s_lshl_b32 s66, s66, 2
    s_lshr_b32 s67, s65, 3
    s_add_u32 s62, s66, s67
    s_cmp_ge_u32 s63, 5
    s_cselect_b32 s66, 5, 0
    s_sub_u32 s63, s63, s66
    s_lshl_b32 s63, s63, 1
    s_mov_b32 s90, 2048
    v_lshrrev_b32 v2, 3, v1
    v_and_b32 v3, 6, v2
    v_and_b32 v4, 7, v1
    v_xor_b32 v3, v3, v4
    v_lshlrev_b32 v3, 4, v3
    v_mul_u32_u24 v2, 1280, v2
    v_add3_u32 v240, v2, v3, s90
    v_add_u32 v241, 9216, v240
    v_subrev_u32 v242, 1920, v240
    v_add_u32 v243, 7296, v240
    s_lshl_b32 s66, s61, 6
    s_lshl_b32 s67, s60, 4
    s_add_u32 s66, s66, s67
    s_mul_i32 s69, s66, 1280
    s_mul_i32 s75, s60, 20480
    s_mov_b32 s92, 6554
    s_mov_b32 s93, 3840
    s_waitcnt lgkmcnt(0)
    s_cmp_ge_u32 s2, 32
    s_cbranch_scc1 L_nz_1
    s_cmp_lg_u32 s60, 3
    s_cbranch_scc1 L_nz_1
    s_mov_b32 s24, s58
    s_mov_b32 s25, s59
    s_mov_b32 s26, 32768
    s_mov_b32 s27, 0x20000
    v_lshlrev_b32 v2, 4, v1
    s_lshl_b32 s71, s2, 10
    v_mov_b32 v4, 0
    v_mov_b32 v5, 0
    v_mov_b32 v6, 0
    v_mov_b32 v7, 0
    buffer_store_dwordx4 v[4:7], v2, s[24:27], s71 offen sc1
L_nz_1:
    s_sub_u32 s4, s40, 2048
    s_subb_u32 s5, s41, 0
    s_mov_b32 s6, 2623488
    s_mov_b32 s7, 0x20000
    s_lshr_b32 s70, s63, 1
    s_sub_u32 s70, 5, s70
    s_cmp_ge_u32 s70, 5
    s_cselect_b32 s46, 5, 0
    s_sub_u32 s70, s70, s46
    s_lshl_b32 s46, s70, 12
    s_add_u32 m0, s75, s46
    s_add_u32 s70, s70, 1
    buffer_load_dwordx4 v240, s[4:7], s69 offen offset:0 lds
    v_add_u32 v2, 0, v1
    v_mul_lo_u32 v3, v2, s92
    v_lshrrev_b32 v3, 16, v3
    v_mul_u32_u24 v4, 10, v3
    v_sub_u32 v4, v2, v4
    buffer_load_dwordx4 v241, s[4:7], s69 offen offset:1024 lds
    v_and_b32 v5, 0x13, v3
    v_and_b32 v6, 4, v3
    v_lshlrev_b32 v6, 1, v6
    v_and_b32 v7, 8, v3
    v_lshrrev_b32 v7, 1, v7
    buffer_load_dwordx4 v242, s[4:7], s69 offen offset:2048 lds
    v_or3_b32 v5, v5, v6, v7
    v_mul_lo_u32 v5, v5, s93
    v_lshl_add_u32 v250, v4, 4, v5
    v_add_u32 v2, 64, v1
    v_mul_lo_u32 v3, v2, s92
    buffer_load_dwordx4 v243, s[4:7], s69 offen offset:3072 lds
    v_lshrrev_b32 v3, 16, v3
    v_mul_u32_u24 v4, 10, v3
    v_sub_u32 v4, v2, v4
    v_and_b32 v5, 0x13, v3
    v_and_b32 v6, 4, v3
    s_cmp_ge_u32 s70, 5
    s_cselect_b32 s46, 5, 0
    s_sub_u32 s70, s70, s46
    s_lshl_b32 s46, s70, 12
    s_add_u32 m0, s75, s46
    s_add_u32 s70, s70, 1
    s_add_u32 s69, s69, 256
    buffer_load_dwordx4 v240, s[4:7], s69 offen offset:0 lds
    v_lshlrev_b32 v6, 1, v6
    v_and_b32 v7, 8, v3
    v_lshrrev_b32 v7, 1, v7
    v_or3_b32 v5, v5, v6, v7
    v_mul_lo_u32 v5, v5, s93
    buffer_load_dwordx4 v241, s[4:7], s69 offen offset:1024 lds
    v_lshl_add_u32 v251, v4, 4, v5
    v_subrev_u32 v251, 1024, v251
    v_add_u32 v2, 128, v1
    v_mul_lo_u32 v3, v2, s92
    v_lshrrev_b32 v3, 16, v3
    buffer_load_dwordx4 v242, s[4:7], s69 offen offset:2048 lds
    v_mul_u32_u24 v4, 10, v3
    v_sub_u32 v4, v2, v4
    v_and_b32 v5, 0x13, v3
    v_and_b32 v6, 4, v3
    v_lshlrev_b32 v6, 1, v6
    buffer_load_dwordx4 v243, s[4:7], s69 offen offset:3072 lds
    v_and_b32 v7, 8, v3
    v_lshrrev_b32 v7, 1, v7
    v_or3_b32 v5, v5, v6, v7
    v_mul_lo_u32 v5, v5, s93
    v_lshl_add_u32 v252, v4, 4, v5
    s_cmp_ge_u32 s70, 5
    s_cselect_b32 s46, 5, 0
    s_sub_u32 s70, s70, s46
    s_lshl_b32 s46, s70, 12
    s_add_u32 m0, s75, s46
    s_add_u32 s70, s70, 1
    s_add_u32 s69, s69, 256
    buffer_load_dwordx4 v240, s[4:7], s69 offen offset:0 lds
    v_subrev_u32 v252, 2048, v252
    v_add_u32 v2, 192, v1
    v_mul_lo_u32 v3, v2, s92
    v_lshrrev_b32 v3, 16, v3
    v_mul_u32_u24 v4, 10, v3
    buffer_load_dwordx4 v241, s[4:7], s69 offen offset:1024 lds
    v_sub_u32 v4, v2, v4
    v_and_b32 v5, 0x13, v3
    v_and_b32 v6, 4, v3
    v_lshlrev_b32 v6, 1, v6
    v_and_b32 v7, 8, v3
    buffer_load_dwordx4 v242, s[4:7], s69 offen offset:2048 lds
    v_lshrrev_b32 v7, 1, v7
    v_or3_b32 v5, v5, v6, v7
    v_mul_lo_u32 v5, v5, s93
    v_lshl_add_u32 v253, v4, 4, v5
    v_subrev_u32 v253, 3072, v253
    buffer_load_dwordx4 v243, s[4:7], s69 offen offset:3072 lds
    v_add_u32 v2, 256, v1
    v_mul_lo_u32 v3, v2, s92
    v_lshrrev_b32 v3, 16, v3
    v_mul_u32_u24 v4, 10, v3
    v_sub_u32 v4, v2, v4
    s_cmp_ge_u32 s70, 5
    s_cselect_b32 s46, 5, 0
    s_sub_u32 s70, s70, s46
    s_lshl_b32 s46, s70, 12
    s_add_u32 m0, s75, s46
    s_add_u32 s70, s70, 1
    s_add_u32 s69, s69, 256
    buffer_load_dwordx4 v240, s[4:7], s69 offen offset:0 lds
    v_and_b32 v5, 0x13, v3
    v_and_b32 v6, 4, v3
    v_lshlrev_b32 v6, 1, v6
    v_and_b32 v7, 8, v3
    v_lshrrev_b32 v7, 1, v7
    buffer_load_dwordx4 v241, s[4:7], s69 offen offset:1024 lds
    v_or3_b32 v5, v5, v6, v7
    v_mul_lo_u32 v5, v5, s93
    v_lshl_add_u32 v254, v4, 4, v5
    s_mov_b32 s8, s42
    s_mov_b32 s9, s43
    buffer_load_dwordx4 v242, s[4:7], s69 offen offset:2048 lds
    s_mov_b32 s10, 2457600
    s_mov_b32 s11, 0x20000
    s_and_b32 s66, s60, 1
    s_mul_i32 s66, s66, 122880
    s_mul_i32 s67, s62, 160
    buffer_load_dwordx4 v243, s[4:7], s69 offen offset:3072 lds
    s_add_u32 s73, s66, s67
    s_lshr_b32 s66, s60, 1
    s_add_u32 s68, s66, 1
    s_mul_i32 s68, s68, 1280
    s_add_u32 s74, s73, s68
    s_cmp_ge_u32 s70, 5
    s_cselect_b32 s46, 5, 0
    s_sub_u32 s70, s70, s46
    s_lshl_b32 s46, s70, 12
    s_add_u32 m0, s75, s46
    s_add_u32 s70, s70, 1
    s_add_u32 s69, s69, 256
    buffer_load_dwordx4 v240, s[4:7], s69 offen offset:0 lds
    s_mul_i32 s66, s66, 245760
    s_add_u32 s73, s73, s66
    s_add_u32 s76, s74, 2457600
    s_add_u32 s77, s73, 2457600
    s_mul_i32 s66, s63, 245760
    buffer_load_dwordx4 v241, s[4:7], s69 offen offset:1024 lds
    s_add_u32 s74, s74, s66
    s_add_u32 s73, s73, s66
    buffer_load_dwordx4 v242, s[4:7], s69 offen offset:2048 lds
    buffer_load_dwordx4 v243, s[4:7], s69 offen offset:3072 lds
    s_mul_i32 s75, s60, 5120
    s_lshl_b32 s66, s2, 2
    s_add_u32 s66, s66, s60
    s_mov_b32 s36, s44
    s_mov_b32 s37, s45
    s_mov_b32 s67, 819072
    s_cmp_ge_u32 s66, 100
    s_cselect_b32 s36, s48, s36
    s_cselect_b32 s37, s49, s37
    s_cselect_b32 s67, 2211712, s67
    s_cmp_ge_u32 s66, 370
    s_cselect_b32 s36, s50, s36
    s_cselect_b32 s37, s51, s37
    s_cselect_b32 s67, 2211712, s67
    s_cmp_ge_u32 s66, 640
    s_cselect_b32 s36, s52, s36
    s_cselect_b32 s37, s53, s37
    s_cselect_b32 s67, 2211712, s67
    s_mov_b32 s68, 0
    s_cmp_ge_u32 s66, 100
    s_cselect_b32 s68, 100, s68
    s_cmp_ge_u32 s66, 370
    s_cselect_b32 s68, 370, s68
    s_cmp_ge_u32 s66, 640
    s_cselect_b32 s68, 640, s68
    s_sub_u32 s66, s66, s68
    s_lshl_b32 s66, s66, 13
    v_lshl_add_u32 v6, v1, 7, s66
    v_min_u32 v6, s67, v6
    global_load_dword a248, v6, s[36:37]
    s_getpc_b64 s[36:37]
L_pc0:
    s_lshl_b32 s66, s65, 2
    s_add_u32 s66, s66, s60
    s_lshl_b32 s66, s66, 10
    s_min_u32 s66, s66, L_end-L_pc0-1024
    v_lshl_add_u32 v6, v1, 4, s66
    global_load_dwordx4 a[244:247], v6, s[36:37]
    s_mov_b32 s24, s58
    s_mov_b32 s25, s59
    s_mov_b32 s26, 32768
    s_mov_b32 s27, 0x20000
    s_mov_b32 s32, s56
    s_mov_b32 s33, s57
    s_mov_b32 s34, 256
    s_mov_b32 s35, 0x20000
    s_add_u32 s28, s58, 20971520
    s_addc_u32 s29, s59, 0
    s_mov_b32 s30, 16777216
    s_mov_b32 s31, 0x20000
    v_bfe_u32 v2, v1, 2, 2
    v_bfe_u32 v3, v1, 4, 1
    v_lshl_add_u32 v2, v3, 2, v2
    v_bfe_u32 v3, v1, 5, 1
    v_lshl_add_u32 v2, v3, 4, v2
    v_mul_u32_u24 v2, 160, v2
    v_and_b32 v3, 3, v1
    v_lshl_add_u32 v232, v3, 3, v2
    v_add_u32 v233, 61440, v232
    v_add_u32 v234, 122880, v232
    v_and_b32 v2, 15, v1
    v_lshrrev_b32 v3, 3, v2
    v_lshlrev_b32 v3, 10, v3
    v_and_b32 v4, 7, v2
    v_lshl_add_u32 v3, v4, 7, v3
    s_mul_i32 s66, s60, 20480
    v_add_u32 v3, s66, v3
    v_and_b32 v4, 6, v2
    v_lshrrev_b32 v5, 4, v1
    v_xor_b32 v6, v5, v4
    v_lshl_add_u32 v10, v6, 4, v3
    v_or_b32 v5, 4, v5
    v_xor_b32 v6, v5, v4
    v_lshl_add_u32 v11, v6, 4, v3
    v_mov_b32 v148, 0x3f803f80
    v_mov_b32 v136, 0x358637bd
    v_mov_b32 v149, 0x3f803f80
    v_mov_b32 v137, 0x358637bd
    v_mov_b32 v150, 0x3f803f80
    v_mov_b32 v138, 0x358637bd
    v_mov_b32 v151, 0x3f803f80
    v_mov_b32 v139, 0x358637bd
    v_and_b32 v3, 3, v1
    v_cmp_eq_u32 s[82:83], 1, v3
    v_cmp_eq_u32 s[84:85], 2, v3
    v_cmp_eq_u32 s[86:87], 3, v3
    v_bfe_u32 v3, v1, 2, 2
    v_lshrrev_b32 v4, 4, v1
    v_cmp_eq_u32 s[88:89], v3, v4
    s_add_u32 m0, s75, 81920
    s_nop 0
    buffer_load_dwordx4 v250, s[8:11], s74 offen lds
    buffer_load_dwordx4 v251, s[8:11], s74 offen offset:1024 lds
    buffer_load_dwordx4 v252, s[8:11], s74 offen offset:2048 lds
    buffer_load_dwordx4 v253, s[8:11], s74 offen offset:3072 lds
    s_add_u32 m0, s75, 86016
    s_nop 0
    buffer_load_dwordx4 v254, s[8:11], s74 offen lds
    s_add_u32 s74, s74, 245760
    s_cmp_ge_u32 s74, s76
    s_cselect_b32 s46, 2457600, 0
    s_sub_u32 s74, s74, s46
    s_waitcnt vmcnt(7)
    s_cmp_ge_u32 s2, 32
    s_cbranch_scc1 L_nzr_2
    s_cmp_lg_u32 s60, 3
    s_cbranch_scc1 L_nzr_2
    v_mov_b32 v4, 1
    v_mov_b32 v2, 0
    s_mov_b64 exec, 1
    buffer_atomic_add v4, v2, s[32:35], 0 offen sc1
    s_mov_b64 exec, -1
L_nzr_2:
    ds_read_b128 v[16:19], v10 offset:0
    ds_read_b128 v[20:23], v11 offset:0
    ds_read_b128 v[24:27], v10 offset:2048
    ds_read_b128 v[28:31], v11 offset:2048
    ds_read_b128 v[32:35], v10 offset:4096
    ds_read_b128 v[36:39], v11 offset:4096
    ds_read_b128 v[40:43], v10 offset:6144
    ds_read_b128 v[44:47], v11 offset:6144
    s_waitcnt lgkmcnt(6)
    v_mfma_f32_16x16x32_bf16 v[140:143], v[148:151], v[16:19], 0
    ds_read_b128 v[48:51], v10 offset:8192
    v_mfma_f32_16x16x32_bf16 v[144:147], v[16:19], v[16:19], 0
    v_mfma_f32_16x16x32_bf16 v[140:143], v[148:151], v[20:23], v[140:143]
    ds_read_b128 v[52:55], v11 offset:8192
    v_mfma_f32_16x16x32_bf16 v[144:147], v[20:23], v[20:23], v[144:147]
    s_waitcnt lgkmcnt(6)
    v_mfma_f32_16x16x32_bf16 v[140:143], v[148:151], v[24:27], v[140:143]
    ds_read_b128 v[56:59], v10 offset:10240
    v_mfma_f32_16x16x32_bf16 v[144:147], v[24:27], v[24:27], v[144:147]
    v_mfma_f32_16x16x32_bf16 v[140:143], v[148:151], v[28:31], v[140:143]
    ds_read_b128 v[60:63], v11 offset:10240
    v_mfma_f32_16x16x32_bf16 v[144:147], v[28:31], v[28:31], v[144:147]
    s_waitcnt lgkmcnt(6)
    v_mfma_f32_16x16x32_bf16 v[140:143], v[148:151], v[32:35], v[140:143]
    ds_read_b128 v[64:67], v10 offset:12288
    v_mfma_f32_16x16x32_bf16 v[144:147], v[32:35], v[32:35], v[144:147]
    v_mfma_f32_16x16x32_bf16 v[140:143], v[148:151], v[36:39], v[140:143]
    ds_read_b128 v[68:71], v11 offset:12288
    v_mfma_f32_16x16x32_bf16 v[144:147], v[36:39], v[36:39], v[144:147]
    s_waitcnt lgkmcnt(6)
    v_mfma_f32_16x16x32_bf16 v[140:143], v[148:151], v[40:43], v[140:143]
    ds_read_b128 v[72:75], v10 offset:14336
    v_mfma_f32_16x16x32_bf16 v[144:147], v[40:43], v[40:43], v[144:147]
    v_mfma_f32_16x16x32_bf16 v[140:143], v[148:151], v[44:47], v[140:143]
    ds_read_b128 v[76:79], v11 offset:14336
    v_mfma_f32_16x16x32_bf16 v[144:147], v[44:47], v[44:47], v[144:147]
    s_waitcnt lgkmcnt(6)
    v_mfma_f32_16x16x32_bf16 v[140:143], v[148:151], v[48:51], v[140:143]
    ds_read_b128 v[80:83], v10 offset:16384
    v_mfma_f32_16x16x32_bf16 v[144:147], v[48:51], v[48:51], v[144:147]
    v_mfma_f32_16x16x32_bf16 v[140:143], v[148:151], v[52:55], v[140:143]
    ds_read_b128 v[84:87], v11 offset:16384
    v_mfma_f32_16x16x32_bf16 v[144:147], v[52:55], v[52:55], v[144:147]
    s_waitcnt lgkmcnt(6)
    v_mfma_f32_16x16x32_bf16 v[140:143], v[148:151], v[56:59], v[140:143]
    ds_read_b128 v[88:91], v10 offset:18432
    v_mfma_f32_16x16x32_bf16 v[144:147], v[56:59], v[56:59], v[144:147]
    v_mfma_f32_16x16x32_bf16 v[140:143], v[148:151], v[60:63], v[140:143]
    ds_read_b128 v[92:95], v11 offset:18432
    v_mfma_f32_16x16x32_bf16 v[144:147], v[60:63], v[60:63], v[144:147]
    s_waitcnt lgkmcnt(6)
    v_mfma_f32_16x16x32_bf16 v[140:143], v[148:151], v[64:67], v[140:143]
    v_mfma_f32_16x16x32_bf16 v[144:147], v[64:67], v[64:67], v[144:147]
    s_add_u32 m0, s75, 102400
    s_nop 0
    buffer_load_dwordx4 v250, s[8:11], s74 offen lds
    v_mfma_f32_16x16x32_bf16 v[140:143], v[148:151], v[68:71], v[140:143]
    v_mfma_f32_16x16x32_bf16 v[144:147], v[68:71], v[68:71], v[144:147]
    s_waitcnt lgkmcnt(4)
    v_mfma_f32_16x16x32_bf16 v[140:143], v[148:151], v[72:75], v[140:143]
    v_mfma_f32_16x16x32_bf16 v[144:147], v[72:75], v[72:75], v[144:147]
    v_mfma_f32_16x16x32_bf16 v[140:143], v[148:151], v[76:79], v[140:143]
    v_mfma_f32_16x16x32_bf16 v[144:147], v[76:79], v[76:79], v[144:147]
    buffer_load_dwordx4 v251, s[8:11], s74 offen offset:1024 lds
    s_waitcnt lgkmcnt(2)
    v_mfma_f32_16x16x32_bf16 v[140:143], v[148:151], v[80:83], v[140:143]
    v_mfma_f32_16x16x32_bf16 v[144:147], v[80:83], v[80:83], v[144:147]
    v_mfma_f32_16x16x32_bf16 v[140:143], v[148:151], v[84:87], v[140:143]
    v_mfma_f32_16x16x32_bf16 v[144:147], v[84:87], v[84:87], v[144:147]
    s_waitcnt lgkmcnt(0)
    v_mfma_f32_16x16x32_bf16 v[140:143], v[148:151], v[88:91], v[140:143]
    v_mfma_f32_16x16x32_bf16 v[144:147], v[88:91], v[88:91], v[144:147]
    buffer_load_dwordx4 v252, s[8:11], s74 offen offset:2048 lds
    v_mfma_f32_16x16x32_bf16 v[140:143], v[148:151], v[92:95], v[140:143]
    v_mfma_f32_16x16x32_bf16 v[144:147], v[92:95], v[92:95], v[144:147]
    s_barrier
    s_nop 0
    s_nop 2
    s_nop 2
    v_cndmask_b32 v152, v144, v145, s[82:83]
    v_cndmask_b32 v152, v152, v146, s[84:85]
    v_cndmask_b32 v152, v152, v147, s[86:87]
    v_cndmask_b32 v152, 0, v152, s[88:89]
    v_mov_b32 v153, v152
    v_mul_f32 v154, 0.0015625, v140
    s_nop 0
    v_permlane16_swap_b32 v152, v153
    v_add_f32 v152, v152, v153
    v_mov_b32 v153, v152
    s_mov_b32 s92, 0xffff0000
    s_nop 0
    v_permlane32_swap_b32 v152, v153
    v_add_f32 v152, v152, v153
    buffer_load_dwordx4 v253, s[8:11], s74 offen offset:3072 lds
    v_mul_f32 v152, 0.0015625, v152
    v_fma_f32 v152, -v154, v154, v152
    v_max_f32 v152, 0, v152
    v_add_f32 v152, 0x3727c5ac, v152
    v_rsq_f32 v156, v152
    s_nop 0
    v_mul_f32 v158, v154, v156
    v_lshlrev_b32 v160, 16, v16
    v_lshlrev_b32 v162, 16, v17
    v_lshlrev_b32 v164, 16, v18
    v_lshlrev_b32 v166, 16, v19
    v_and_b32 v161, s92, v16
    v_and_b32 v163, s92, v17
    v_and_b32 v165, s92, v18
    v_and_b32 v167, s92, v19
    v_pk_fma_f32 v[160:161], v[160:161], v[156:157], v[158:159] op_sel_hi:[1,0,0] neg_lo:[0,0,1] neg_hi:[0,0,1]
    v_pk_fma_f32 v[162:163], v[162:163], v[156:157], v[158:159] op_sel_hi:[1,0,0] neg_lo:[0,0,1] neg_hi:[0,0,1]
    s_add_u32 m0, s75, 106496
    s_nop 0
    buffer_load_dwordx4 v254, s[8:11], s74 offen lds
    s_add_u32 s74, s74, 245760
    s_cmp_ge_u32 s74, s76
    s_cselect_b32 s46, 2457600, 0
    s_sub_u32 s74, s74, s46
    v_pk_fma_f32 v[164:165], v[164:165], v[156:157], v[158:159] op_sel_hi:[1,0,0] neg_lo:[0,0,1] neg_hi:[0,0,1]
    v_pk_fma_f32 v[166:167], v[166:167], v[156:157], v[158:159] op_sel_hi:[1,0,0] neg_lo:[0,0,1] neg_hi:[0,0,1]
    v_cvt_pk_bf16_f32 v16, v160, v161
    v_cvt_pk_bf16_f32 v17, v162, v163
    v_cvt_pk_bf16_f32 v18, v164, v165
    v_cvt_pk_bf16_f32 v19, v166, v167
    v_lshlrev_b32 v160, 16, v20
    v_lshlrev_b32 v162, 16, v21
    v_lshlrev_b32 v164, 16, v22
    v_lshlrev_b32 v166, 16, v23
    v_and_b32 v161, s92, v20
    v_and_b32 v163, s92, v21
    v_and_b32 v165, s92, v22
    v_and_b32 v167, s92, v23
    v_pk_fma_f32 v[160:161], v[160:161], v[156:157], v[158:159] op_sel_hi:[1,0,0] neg_lo:[0,0,1] neg_hi:[0,0,1]
    v_pk_fma_f32 v[162:163], v[162:163], v[156:157], v[158:159] op_sel_hi:[1,0,0] neg_lo:[0,0,1] neg_hi:[0,0,1]
    v_pk_fma_f32 v[164:165], v[164:165], v[156:157], v[158:159] op_sel_hi:[1,0,0] neg_lo:[0,0,1] neg_hi:[0,0,1]
    s_add_u32 m0, s75, 122880
    s_nop 0
    buffer_load_dwordx4 v250, s[8:11], s74 offen lds
    v_pk_fma_f32 v[166:167], v[166:167], v[156:157], v[158:159] op_sel_hi:[1,0,0] neg_lo:[0,0,1] neg_hi:[0,0,1]
    v_cvt_pk_bf16_f32 v20, v160, v161
    v_cvt_pk_bf16_f32 v21, v162, v163
    v_cvt_pk_bf16_f32 v22, v164, v165
    v_cvt_pk_bf16_f32 v23, v166, v167
    v_lshlrev_b32 v160, 16, v24
    v_lshlrev_b32 v162, 16, v25
    v_lshlrev_b32 v164, 16, v26
    v_lshlrev_b32 v166, 16, v27
    v_and_b32 v161, s92, v24
    v_and_b32 v163, s92, v25
    v_and_b32 v165, s92, v26
    v_and_b32 v167, s92, v27
    v_pk_fma_f32 v[160:161], v[160:161], v[156:157], v[158:159] op_sel_hi:[1,0,0] neg_lo:[0,0,1] neg_hi:[0,0,1]
    v_pk_fma_f32 v[162:163], v[162:163], v[156:157], v[158:159] op_sel_hi:[1,0,0] neg_lo:[0,0,1] neg_hi:[0,0,1]
    v_pk_fma_f32 v[164:165], v[164:165], v[156:157], v[158:159] op_sel_hi:[1,0,0] neg_lo:[0,0,1] neg_hi:[0,0,1]
    v_pk_fma_f32 v[166:167], v[166:167], v[156:157], v[158:159] op_sel_hi:[1,0,0] neg_lo:[0,0,1] neg_hi:[0,0,1]
    buffer_load_dwordx4 v251, s[8:11], s74 offen offset:1024 lds
    v_cvt_pk_bf16_f32 v24, v160, v161
    v_cvt_pk_bf16_f32 v25, v162, v163
    v_cvt_pk_bf16_f32 v26, v164, v165
    v_cvt_pk_bf16_f32 v27, v166, v167
    v_lshlrev_b32 v160, 16, v28
    v_lshlrev_b32 v162, 16, v29
    v_lshlrev_b32 v164, 16, v30
    v_lshlrev_b32 v166, 16, v31
    v_and_b32 v161, s92, v28
    v_and_b32 v163, s92, v29
    v_and_b32 v165, s92, v30
    v_and_b32 v167, s92, v31
    v_pk_fma_f32 v[160:161], v[160:161], v[156:157], v[158:159] op_sel_hi:[1,0,0] neg_lo:[0,0,1] neg_hi:[0,0,1]
    v_pk_fma_f32 v[162:163], v[162:163], v[156:157], v[158:159] op_sel_hi:[1,0,0] neg_lo:[0,0,1] neg_hi:[0,0,1]
    v_pk_fma_f32 v[164:165], v[164:165], v[156:157], v[158:159] op_sel_hi:[1,0,0] neg_lo:[0,0,1] neg_hi:[0,0,1]
    v_pk_fma_f32 v[166:167], v[166:167], v[156:157], v[158:159] op_sel_hi:[1,0,0] neg_lo:[0,0,1] neg_hi:[0,0,1]
    v_cvt_pk_bf16_f32 v28, v160, v161
    buffer_load_dwordx4 v252, s[8:11], s74 offen offset:2048 lds
    v_cvt_pk_bf16_f32 v29, v162, v163
    v_cvt_pk_bf16_f32 v30, v164, v165
    v_cvt_pk_bf16_f32 v31, v166, v167
    v_lshlrev_b32 v160, 16, v32
    v_lshlrev_b32 v162, 16, v33
    v_lshlrev_b32 v164, 16, v34
    v_lshlrev_b32 v166, 16, v35
    v_and_b32 v161, s92, v32
    v_and_b32 v163, s92, v33
    v_and_b32 v165, s92, v34
    v_and_b32 v167, s92, v35
    v_pk_fma_f32 v[160:161], v[160:161], v[156:157], v[158:159] op_sel_hi:[1,0,0] neg_lo:[0,0,1] neg_hi:[0,0,1]
    v_pk_fma_f32 v[162:163], v[162:163], v[156:157], v[158:159] op_sel_hi:[1,0,0] neg_lo:[0,0,1] neg_hi:[0,0,1]
    v_pk_fma_f32 v[164:165], v[164:165], v[156:157], v[158:159] op_sel_hi:[1,0,0] neg_lo:[0,0,1] neg_hi:[0,0,1]
    v_pk_fma_f32 v[166:167], v[166:167], v[156:157], v[158:159] op_sel_hi:[1,0,0] neg_lo:[0,0,1] neg_hi:[0,0,1]
    v_cvt_pk_bf16_f32 v32, v160, v161
    v_cvt_pk_bf16_f32 v33, v162, v163
    buffer_load_dwordx4 v253, s[8:11], s74 offen offset:3072 lds
    v_cvt_pk_bf16_f32 v34, v164, v165
    v_cvt_pk_bf16_f32 v35, v166, v167
    v_lshlrev_b32 v160, 16, v36
    v_lshlrev_b32 v162, 16, v37
    v_lshlrev_b32 v164, 16, v38
    v_lshlrev_b32 v166, 16, v39
    v_and_b32 v161, s92, v36
    v_and_b32 v163, s92, v37
    v_and_b32 v165, s92, v38
    v_and_b32 v167, s92, v39
    v_pk_fma_f32 v[160:161], v[160:161], v[156:157], v[158:159] op_sel_hi:[1,0,0] neg_lo:[0,0,1] neg_hi:[0,0,1]
    v_pk_fma_f32 v[162:163], v[162:163], v[156:157], v[158:159] op_sel_hi:[1,0,0] neg_lo:[0,0,1] neg_hi:[0,0,1]
    v_pk_fma_f32 v[164:165], v[164:165], v[156:157], v[158:159] op_sel_hi:[1,0,0] neg_lo:[0,0,1] neg_hi:[0,0,1]
    v_pk_fma_f32 v[166:167], v[166:167], v[156:157], v[158:159] op_sel_hi:[1,0,0] neg_lo:[0,0,1] neg_hi:[0,0,1]
    v_cvt_pk_bf16_f32 v36, v160, v161
    v_cvt_pk_bf16_f32 v37, v162, v163
    v_cvt_pk_bf16_f32 v38, v164, v165
    s_add_u32 m0, s75, 126976
    s_nop 0
    buffer_load_dwordx4 v254, s[8:11], s74 offen lds
    s_add_u32 s74, s74, 245760
    s_cmp_ge_u32 s74, s76
    s_cselect_b32 s46, 2457600, 0
    s_sub_u32 s74, s74, s46
    v_cvt_pk_bf16_f32 v39, v166, v167
    v_lshlrev_b32 v160, 16, v40
    v_lshlrev_b32 v162, 16, v41
    v_lshlrev_b32 v164, 16, v42
    v_lshlrev_b32 v166, 16, v43
    v_and_b32 v161, s92, v40
    v_and_b32 v163, s92, v41
    v_and_b32 v165, s92, v42
    v_and_b32 v167, s92, v43
    v_pk_fma_f32 v[160:161], v[160:161], v[156:157], v[158:159] op_sel_hi:[1,0,0] neg_lo:[0,0,1] neg_hi:[0,0,1]
    v_pk_fma_f32 v[162:163], v[162:163], v[156:157], v[158:159] op_sel_hi:[1,0,0] neg_lo:[0,0,1] neg_hi:[0,0,1]
    v_pk_fma_f32 v[164:165], v[164:165], v[156:157], v[158:159] op_sel_hi:[1,0,0] neg_lo:[0,0,1] neg_hi:[0,0,1]
    v_pk_fma_f32 v[166:167], v[166:167], v[156:157], v[158:159] op_sel_hi:[1,0,0] neg_lo:[0,0,1] neg_hi:[0,0,1]
    v_cvt_pk_bf16_f32 v40, v160, v161
    v_cvt_pk_bf16_f32 v41, v162, v163
    v_cvt_pk_bf16_f32 v42, v164, v165
    v_cvt_pk_bf16_f32 v43, v166, v167
    s_add_u32 m0, s75, 143360
    s_nop 0
    buffer_load_dwordx4 v250, s[8:11], s74 offen lds
    v_lshlrev_b32 v160, 16, v44
    v_lshlrev_b32 v162, 16, v45
    v_lshlrev_b32 v164, 16, v46
    v_lshlrev_b32 v166, 16, v47
    v_and_b32 v161, s92, v44
    v_and_b32 v163, s92, v45
    v_and_b32 v165, s92, v46
    v_and_b32 v167, s92, v47
    v_pk_fma_f32 v[160:161], v[160:161], v[156:157], v[158:159] op_sel_hi:[1,0,0] neg_lo:[0,0,1] neg_hi:[0,0,1]
    v_pk_fma_f32 v[162:163], v[162:163], v[156:157], v[158:159] op_sel_hi:[1,0,0] neg_lo:[0,0,1] neg_hi:[0,0,1]
    v_pk_fma_f32 v[164:165], v[164:165], v[156:157], v[158:159] op_sel_hi:[1,0,0] neg_lo:[0,0,1] neg_hi:[0,0,1]
    v_pk_fma_f32 v[166:167], v[166:167], v[156:157], v[158:159] op_sel_hi:[1,0,0] neg_lo:[0,0,1] neg_hi:[0,0,1]
    v_cvt_pk_bf16_f32 v44, v160, v161
    v_cvt_pk_bf16_f32 v45, v162, v163
    v_cvt_pk_bf16_f32 v46, v164, v165
    v_cvt_pk_bf16_f32 v47, v166, v167
    v_lshlrev_b32 v160, 16, v48
    buffer_load_dwordx4 v251, s[8:11], s74 offen offset:1024 lds
    v_lshlrev_b32 v162, 16, v49
    v_lshlrev_b32 v164, 16, v50
    v_lshlrev_b32 v166, 16, v51
    v_and_b32 v161, s92, v48
    v_and_b32 v163, s92, v49
    v_and_b32 v165, s92, v50
    v_and_b32 v167, s92, v51
    v_pk_fma_f32 v[160:161], v[160:161], v[156:157], v[158:159] op_sel_hi:[1,0,0] neg_lo:[0,0,1] neg_hi:[0,0,1]
    v_pk_fma_f32 v[162:163], v[162:163], v[156:157], v[158:159] op_sel_hi:[1,0,0] neg_lo:[0,0,1] neg_hi:[0,0,1]
    v_pk_fma_f32 v[164:165], v[164:165], v[156:157], v[158:159] op_sel_hi:[1,0,0] neg_lo:[0,0,1] neg_hi:[0,0,1]
    v_pk_fma_f32 v[166:167], v[166:167], v[156:157], v[158:159] op_sel_hi:[1,0,0] neg_lo:[0,0,1] neg_hi:[0,0,1]
    v_cvt_pk_bf16_f32 v48, v160, v161
    v_cvt_pk_bf16_f32 v49, v162, v163
    v_cvt_pk_bf16_f32 v50, v164, v165
    v_cvt_pk_bf16_f32 v51, v166, v167
    v_lshlrev_b32 v160, 16, v52
    v_lshlrev_b32 v162, 16, v53
    buffer_load_dwordx4 v252, s[8:11], s74 offen offset:2048 lds
    v_lshlrev_b32 v164, 16, v54
    v_lshlrev_b32 v166, 16, v55
    v_and_b32 v161, s92, v52
    v_and_b32 v163, s92, v53
    v_and_b32 v165, s92, v54
    v_and_b32 v167, s92, v55
    v_pk_fma_f32 v[160:161], v[160:161], v[156:157], v[158:159] op_sel_hi:[1,0,0] neg_lo:[0,0,1] neg_hi:[0,0,1]
    v_pk_fma_f32 v[162:163], v[162:163], v[156:157], v[158:159] op_sel_hi:[1,0,0] neg_lo:[0,0,1] neg_hi:[0,0,1]
    v_pk_fma_f32 v[164:165], v[164:165], v[156:157], v[158:159] op_sel_hi:[1,0,0] neg_lo:[0,0,1] neg_hi:[0,0,1]
    v_pk_fma_f32 v[166:167], v[166:167], v[156:157], v[158:159] op_sel_hi:[1,0,0] neg_lo:[0,0,1] neg_hi:[0,0,1]
    v_cvt_pk_bf16_f32 v52, v160, v161
    v_cvt_pk_bf16_f32 v53, v162, v163
    v_cvt_pk_bf16_f32 v54, v164, v165
    v_cvt_pk_bf16_f32 v55, v166, v167
    v_lshlrev_b32 v160, 16, v56
    v_lshlrev_b32 v162, 16, v57
    v_lshlrev_b32 v164, 16, v58
    buffer_load_dwordx4 v253, s[8:11], s74 offen offset:3072 lds
    v_lshlrev_b32 v166, 16, v59
    v_and_b32 v161, s92, v56
    v_and_b32 v163, s92, v57
    v_and_b32 v165, s92, v58
    v_and_b32 v167, s92, v59
    v_pk_fma_f32 v[160:161], v[160:161], v[156:157], v[158:159] op_sel_hi:[1,0,0] neg_lo:[0,0,1] neg_hi:[0,0,1]
    v_pk_fma_f32 v[162:163], v[162:163], v[156:157], v[158:159] op_sel_hi:[1,0,0] neg_lo:[0,0,1] neg_hi:[0,0,1]
    v_pk_fma_f32 v[164:165], v[164:165], v[156:157], v[158:159] op_sel_hi:[1,0,0] neg_lo:[0,0,1] neg_hi:[0,0,1]
    v_pk_fma_f32 v[166:167], v[166:167], v[156:157], v[158:159] op_sel_hi:[1,0,0] neg_lo:[0,0,1] neg_hi:[0,0,1]
    v_cvt_pk_bf16_f32 v56, v160, v161
    v_cvt_pk_bf16_f32 v57, v162, v163
    v_cvt_pk_bf16_f32 v58, v164, v165
    v_cvt_pk_bf16_f32 v59, v166, v167
    v_lshlrev_b32 v160, 16, v60
    v_lshlrev_b32 v162, 16, v61
    v_lshlrev_b32 v164, 16, v62
    v_lshlrev_b32 v166, 16, v63
    s_add_u32 m0, s75, 147456
    s_nop 0
    buffer_load_dwordx4 v254, s[8:11], s74 offen lds
    s_add_u32 s74, s74, 245760
    s_cmp_ge_u32 s74, s76
    s_cselect_b32 s46, 2457600, 0
    s_sub_u32 s74, s74, s46
    v_and_b32 v161, s92, v60
    v_and_b32 v163, s92, v61
    v_and_b32 v165, s92, v62
    v_and_b32 v167, s92, v63
    v_pk_fma_f32 v[160:161], v[160:161], v[156:157], v[158:159] op_sel_hi:[1,0,0] neg_lo:[0,0,1] neg_hi:[0,0,1]
    v_pk_fma_f32 v[162:163], v[162:163], v[156:157], v[158:159] op_sel_hi:[1,0,0] neg_lo:[0,0,1] neg_hi:[0,0,1]
    v_pk_fma_f32 v[164:165], v[164:165], v[156:157], v[158:159] op_sel_hi:[1,0,0] neg_lo:[0,0,1] neg_hi:[0,0,1]
    v_pk_fma_f32 v[166:167], v[166:167], v[156:157], v[158:159] op_sel_hi:[1,0,0] neg_lo:[0,0,1] neg_hi:[0,0,1]
    v_cvt_pk_bf16_f32 v60, v160, v161
    v_cvt_pk_bf16_f32 v61, v162, v163
    v_cvt_pk_bf16_f32 v62, v164, v165
    v_cvt_pk_bf16_f32 v63, v166, v167
    v_lshlrev_b32 v160, 16, v64
    v_lshlrev_b32 v162, 16, v65
    v_lshlrev_b32 v164, 16, v66
    v_lshlrev_b32 v166, 16, v67
    v_and_b32 v161, s92, v64
    s_add_u32 m0, s75, 0
    s_nop 0
    buffer_load_dwordx4 v250, s[8:11], s74 offen lds
    v_and_b32 v163, s92, v65
    v_and_b32 v165, s92, v66
    v_and_b32 v167, s92, v67
    v_pk_fma_f32 v[160:161], v[160:161], v[156:157], v[158:159] op_sel_hi:[1,0,0] neg_lo:[0,0,1] neg_hi:[0,0,1]
    v_pk_fma_f32 v[162:163], v[162:163], v[156:157], v[158:159] op_sel_hi:[1,0,0] neg_lo:[0,0,1] neg_hi:[0,0,1]
    v_pk_fma_f32 v[164:165], v[164:165], v[156:157], v[158:159] op_sel_hi:[1,0,0] neg_lo:[0,0,1] neg_hi:[0,0,1]
    v_pk_fma_f32 v[166:167], v[166:167], v[156:157], v[158:159] op_sel_hi:[1,0,0] neg_lo:[0,0,1] neg_hi:[0,0,1]
    v_cvt_pk_bf16_f32 v64, v160, v161
    v_cvt_pk_bf16_f32 v65, v162, v163
    v_cvt_pk_bf16_f32 v66, v164, v165
    v_cvt_pk_bf16_f32 v67, v166, v167
    v_lshlrev_b32 v160, 16, v68
    v_lshlrev_b32 v162, 16, v69
    v_lshlrev_b32 v164, 16, v70
    v_lshlrev_b32 v166, 16, v71
    v_and_b32 v161, s92, v68
    v_and_b32 v163, s92, v69
    buffer_load_dwordx4 v251, s[8:11], s74 offen offset:1024 lds
    v_and_b32 v165, s92, v70
    v_and_b32 v167, s92, v71
    v_pk_fma_f32 v[160:161], v[160:161], v[156:157], v[158:159] op_sel_hi:[1,0,0] neg_lo:[0,0,1] neg_hi:[0,0,1]
    v_pk_fma_f32 v[162:163], v[162:163], v[156:157], v[158:159] op_sel_hi:[1,0,0] neg_lo:[0,0,1] neg_hi:[0,0,1]
    v_pk_fma_f32 v[164:165], v[164:165], v[156:157], v[158:159] op_sel_hi:[1,0,0] neg_lo:[0,0,1] neg_hi:[0,0,1]
    v_pk_fma_f32 v[166:167], v[166:167], v[156:157], v[158:159] op_sel_hi:[1,0,0] neg_lo:[0,0,1] neg_hi:[0,0,1]
    v_cvt_pk_bf16_f32 v68, v160, v161
    v_cvt_pk_bf16_f32 v69, v162, v163
    v_cvt_pk_bf16_f32 v70, v164, v165
    v_cvt_pk_bf16_f32 v71, v166, v167
    v_lshlrev_b32 v160, 16, v72
    v_lshlrev_b32 v162, 16, v73
    v_lshlrev_b32 v164, 16, v74
    v_lshlrev_b32 v166, 16, v75
    v_and_b32 v161, s92, v72
    v_and_b32 v163, s92, v73
    v_and_b32 v165, s92, v74
    buffer_load_dwordx4 v252, s[8:11], s74 offen offset:2048 lds
    v_and_b32 v167, s92, v75
    v_pk_fma_f32 v[160:161], v[160:161], v[156:157], v[158:159] op_sel_hi:[1,0,0] neg_lo:[0,0,1] neg_hi:[0,0,1]
    v_pk_fma_f32 v[162:163], v[162:163], v[156:157], v[158:159] op_sel_hi:[1,0,0] neg_lo:[0,0,1] neg_hi:[0,0,1]
    v_pk_fma_f32 v[164:165], v[164:165], v[156:157], v[158:159] op_sel_hi:[1,0,0] neg_lo:[0,0,1] neg_hi:[0,0,1]
    v_pk_fma_f32 v[166:167], v[166:167], v[156:157], v[158:159] op_sel_hi:[1,0,0] neg_lo:[0,0,1] neg_hi:[0,0,1]
    v_cvt_pk_bf16_f32 v72, v160, v161
    v_cvt_pk_bf16_f32 v73, v162, v163
    v_cvt_pk_bf16_f32 v74, v164, v165
    v_cvt_pk_bf16_f32 v75, v166, v167
    v_lshlrev_b32 v160, 16, v76
    v_lshlrev_b32 v162, 16, v77
    v_lshlrev_b32 v164, 16, v78
    v_lshlrev_b32 v166, 16, v79
    v_and_b32 v161, s92, v76
    v_and_b32 v163, s92, v77
    v_and_b32 v165, s92, v78
    v_and_b32 v167, s92, v79
    buffer_load_dwordx4 v253, s[8:11], s74 offen offset:3072 lds
    v_pk_fma_f32 v[160:161], v[160:161], v[156:157], v[158:159] op_sel_hi:[1,0,0] neg_lo:[0,0,1] neg_hi:[0,0,1]
    v_pk_fma_f32 v[162:163], v[162:163], v[156:157], v[158:159] op_sel_hi:[1,0,0] neg_lo:[0,0,1] neg_hi:[0,0,1]
    v_pk_fma_f32 v[164:165], v[164:165], v[156:157], v[158:159] op_sel_hi:[1,0,0] neg_lo:[0,0,1] neg_hi:[0,0,1]
    v_pk_fma_f32 v[166:167], v[166:167], v[156:157], v[158:159] op_sel_hi:[1,0,0] neg_lo:[0,0,1] neg_hi:[0,0,1]
    v_cvt_pk_bf16_f32 v76, v160, v161
    v_cvt_pk_bf16_f32 v77, v162, v163
    v_cvt_pk_bf16_f32 v78, v164, v165
    v_cvt_pk_bf16_f32 v79, v166, v167
    v_lshlrev_b32 v160, 16, v80
    v_lshlrev_b32 v162, 16, v81
    v_lshlrev_b32 v164, 16, v82
    v_lshlrev_b32 v166, 16, v83
    v_and_b32 v161, s92, v80
    v_and_b32 v163, s92, v81
    v_and_b32 v165, s92, v82
    v_and_b32 v167, s92, v83
    v_pk_fma_f32 v[160:161], v[160:161], v[156:157], v[158:159] op_sel_hi:[1,0,0] neg_lo:[0,0,1] neg_hi:[0,0,1]
    s_add_u32 m0, s75, 4096
    s_nop 0
    buffer_load_dwordx4 v254, s[8:11], s74 offen lds
    s_add_u32 s74, s74, 245760
    s_cmp_ge_u32 s74, s76
    s_cselect_b32 s46, 2457600, 0
    s_sub_u32 s74, s74, s46
    v_pk_fma_f32 v[162:163], v[162:163], v[156:157], v[158:159] op_sel_hi:[1,0,0] neg_lo:[0,0,1] neg_hi:[0,0,1]
    v_pk_fma_f32 v[164:165], v[164:165], v[156:157], v[158:159] op_sel_hi:[1,0,0] neg_lo:[0,0,1] neg_hi:[0,0,1]
    v_pk_fma_f32 v[166:167], v[166:167], v[156:157], v[158:159] op_sel_hi:[1,0,0] neg_lo:[0,0,1] neg_hi:[0,0,1]
    v_cvt_pk_bf16_f32 v80, v160, v161
    v_cvt_pk_bf16_f32 v81, v162, v163
    v_cvt_pk_bf16_f32 v82, v164, v165
    v_cvt_pk_bf16_f32 v83, v166, v167
    v_lshlrev_b32 v160, 16, v84
    v_lshlrev_b32 v162, 16, v85
    v_lshlrev_b32 v164, 16, v86
    v_lshlrev_b32 v166, 16, v87
    v_and_b32 v161, s92, v84
    v_and_b32 v163, s92, v85
    v_and_b32 v165, s92, v86
    v_and_b32 v167, s92, v87
    v_pk_fma_f32 v[160:161], v[160:161], v[156:157], v[158:159] op_sel_hi:[1,0,0] neg_lo:[0,0,1] neg_hi:[0,0,1]
    v_pk_fma_f32 v[162:163], v[162:163], v[156:157], v[158:159] op_sel_hi:[1,0,0] neg_lo:[0,0,1] neg_hi:[0,0,1]
    s_add_u32 m0, s75, 20480
    s_nop 0
    buffer_load_dwordx4 v250, s[8:11], s74 offen lds
    v_pk_fma_f32 v[164:165], v[164:165], v[156:157], v[158:159] op_sel_hi:[1,0,0] neg_lo:[0,0,1] neg_hi:[0,0,1]
    v_pk_fma_f32 v[166:167], v[166:167], v[156:157], v[158:159] op_sel_hi:[1,0,0] neg_lo:[0,0,1] neg_hi:[0,0,1]
    v_cvt_pk_bf16_f32 v84, v160, v161
    v_cvt_pk_bf16_f32 v85, v162, v163
    v_cvt_pk_bf16_f32 v86, v164, v165
    v_cvt_pk_bf16_f32 v87, v166, v167
    v_lshlrev_b32 v160, 16, v88
    v_lshlrev_b32 v162, 16, v89
    v_lshlrev_b32 v164, 16, v90
    v_lshlrev_b32 v166, 16, v91
    v_and_b32 v161, s92, v88
    v_and_b32 v163, s92, v89
    v_and_b32 v165, s92, v90
    v_and_b32 v167, s92, v91
    v_pk_fma_f32 v[160:161], v[160:161], v[156:157], v[158:159] op_sel_hi:[1,0,0] neg_lo:[0,0,1] neg_hi:[0,0,1]
    v_pk_fma_f32 v[162:163], v[162:163], v[156:157], v[158:159] op_sel_hi:[1,0,0] neg_lo:[0,0,1] neg_hi:[0,0,1]
    v_pk_fma_f32 v[164:165], v[164:165], v[156:157], v[158:159] op_sel_hi:[1,0,0] neg_lo:[0,0,1] neg_hi:[0,0,1]
    buffer_load_dwordx4 v251, s[8:11], s74 offen offset:1024 lds
    v_pk_fma_f32 v[166:167], v[166:167], v[156:157], v[158:159] op_sel_hi:[1,0,0] neg_lo:[0,0,1] neg_hi:[0,0,1]
    v_cvt_pk_bf16_f32 v88, v160, v161
    v_cvt_pk_bf16_f32 v89, v162, v163
    v_cvt_pk_bf16_f32 v90, v164, v165
    v_cvt_pk_bf16_f32 v91, v166, v167
    v_lshlrev_b32 v160, 16, v92
    v_lshlrev_b32 v162, 16, v93
    v_lshlrev_b32 v164, 16, v94
    v_lshlrev_b32 v166, 16, v95
    v_and_b32 v161, s92, v92
    v_and_b32 v163, s92, v93
    v_and_b32 v165, s92, v94
    v_and_b32 v167, s92, v95
    v_pk_fma_f32 v[160:161], v[160:161], v[156:157], v[158:159] op_sel_hi:[1,0,0] neg_lo:[0,0,1] neg_hi:[0,0,1]
    v_pk_fma_f32 v[162:163], v[162:163], v[156:157], v[158:159] op_sel_hi:[1,0,0] neg_lo:[0,0,1] neg_hi:[0,0,1]
    v_pk_fma_f32 v[164:165], v[164:165], v[156:157], v[158:159] op_sel_hi:[1,0,0] neg_lo:[0,0,1] neg_hi:[0,0,1]
    v_pk_fma_f32 v[166:167], v[166:167], v[156:157], v[158:159] op_sel_hi:[1,0,0] neg_lo:[0,0,1] neg_hi:[0,0,1]
    buffer_load_dwordx4 v252, s[8:11], s74 offen offset:2048 lds
    v_cvt_pk_bf16_f32 v92, v160, v161
    v_cvt_pk_bf16_f32 v93, v162, v163
    v_cvt_pk_bf16_f32 v94, v164, v165
    v_cvt_pk_bf16_f32 v95, v166, v167
    s_waitcnt vmcnt(23)
    s_barrier
    ds_read_b64_tr_b16 v[152:153], v233 offset:20480
    ds_read_b64_tr_b16 v[154:155], v233 offset:21760
    ds_read_b64_tr_b16 v[172:173], v233 offset:30720
    ds_read_b64_tr_b16 v[174:175], v233 offset:32000
    ds_read_b64_tr_b16 v[156:157], v233 offset:20512
    ds_read_b64_tr_b16 v[158:159], v233 offset:21792
    ds_read_b64_tr_b16 v[176:177], v233 offset:30752
    ds_read_b64_tr_b16 v[178:179], v233 offset:32032
    ds_read_b64_tr_b16 v[160:161], v233 offset:20544
    ds_read_b64_tr_b16 v[162:163], v233 offset:21824
    ds_read_b64_tr_b16 v[180:181], v233 offset:30784
    ds_read_b64_tr_b16 v[182:183], v233 offset:32064
    ds_read_b64_tr_b16 v[164:165], v233 offset:20576
    ds_read_b64_tr_b16 v[166:167], v233 offset:21856
    ds_read_b64_tr_b16 v[184:185], v233 offset:30816
    ds_read_b64_tr_b16 v[186:187], v233 offset:32096
    ds_read_b64_tr_b16 v[168:169], v233 offset:20608
    ds_read_b64_tr_b16 v[170:171], v233 offset:21888
    ds_read_b64_tr_b16 v[188:189], v233 offset:30848
    ds_read_b64_tr_b16 v[190:191], v233 offset:32128
    s_waitcnt lgkmcnt(8)
    v_mfma_f32_16x16x32_bf16 v[96:99], v[16:19], v[152:155], v[136:139]
    ds_read_b64_tr_b16 v[192:193], v233 offset:25600
    ds_read_b64_tr_b16 v[194:195], v233 offset:26880
    v_mfma_f32_16x16x32_bf16 v[116:119], v[16:19], v[172:175], 0
    ds_read_b64_tr_b16 v[212:213], v233 offset:35840
    ds_read_b64_tr_b16 v[214:215], v233 offset:37120
    v_mfma_f32_16x16x32_bf16 v[100:103], v[16:19], v[156:159], v[136:139]
    ds_read_b64_tr_b16 v[196:197], v233 offset:25632
    ds_read_b64_tr_b16 v[198:199], v233 offset:26912
    v_mfma_f32_16x16x32_bf16 v[120:123], v[16:19], v[176:179], 0
    ds_read_b64_tr_b16 v[216:217], v233 offset:35872
    ds_read_b64_tr_b16 v[218:219], v233 offset:37152
    v_mfma_f32_16x16x32_bf16 v[104:107], v[16:19], v[160:163], v[136:139]
    buffer_load_dwordx4 v253, s[8:11], s74 offen offset:3072 lds
    ds_read_b64_tr_b16 v[200:201], v233 offset:25664
    ds_read_b64_tr_b16 v[202:203], v233 offset:26944
    v_mfma_f32_16x16x32_bf16 v[124:127], v[16:19], v[180:183], 0
    ds_read_b64_tr_b16 v[220:221], v233 offset:35904
    ds_read_b64_tr_b16 v[222:223], v233 offset:37184
    s_waitcnt lgkmcnt(12)
    v_mfma_f32_16x16x32_bf16 v[108:111], v[16:19], v[164:167], v[136:139]
    ds_read_b64_tr_b16 v[204:205], v233 offset:25696
    ds_read_b64_tr_b16 v[206:207], v233 offset:26976
    v_mfma_f32_16x16x32_bf16 v[128:131], v[16:19], v[184:187], 0
    ds_read_b64_tr_b16 v[224:225], v233 offset:35936
    ds_read_b64_tr_b16 v[226:227], v233 offset:37216
    v_mfma_f32_16x16x32_bf16 v[112:115], v[16:19], v[168:171], v[136:139]
    ds_read_b64_tr_b16 v[208:209], v233 offset:25728
    ds_read_b64_tr_b16 v[210:211], v233 offset:27008
    v_mfma_f32_16x16x32_bf16 v[132:135], v[16:19], v[188:191], 0
    s_add_u32 m0, s75, 24576
    s_nop 0
    buffer_load_dwordx4 v254, s[8:11], s74 offen lds
    s_add_u32 s74, s74, 245760
    s_cmp_ge_u32 s74, s76
    s_cselect_b32 s46, 2457600, 0
    s_sub_u32 s74, s74, s46
    ds_read_b64_tr_b16 v[228:229], v233 offset:35968
    ds_read_b64_tr_b16 v[230:231], v233 offset:37248
    s_waitcnt vmcnt(20)
    s_barrier
    s_waitcnt lgkmcnt(8)
    v_mfma_f32_16x16x32_bf16 v[96:99], v[20:23], v[192:195], v[96:99]
    ds_read_b64_tr_b16 v[152:153], v233 offset:40960
    ds_read_b64_tr_b16 v[154:155], v233 offset:42240
    v_mfma_f32_16x16x32_bf16 v[116:119], v[20:23], v[212:215], v[116:119]
    ds_read_b64_tr_b16 v[172:173], v233 offset:51200
    ds_read_b64_tr_b16 v[174:175], v233 offset:52480
    v_mfma_f32_16x16x32_bf16 v[100:103], v[20:23], v[196:199], v[100:103]
    ds_read_b64_tr_b16 v[156:157], v233 offset:40992
    ds_read_b64_tr_b16 v[158:159], v233 offset:42272
    v_mfma_f32_16x16x32_bf16 v[120:123], v[20:23], v[216:219], v[120:123]
    ds_read_b64_tr_b16 v[176:177], v233 offset:51232
    ds_read_b64_tr_b16 v[178:179], v233 offset:52512
    v_mfma_f32_16x16x32_bf16 v[104:107], v[20:23], v[200:203], v[104:107]
    s_add_u32 m0, s75, 40960
    s_nop 0
    buffer_load_dwordx4 v250, s[8:11], s74 offen lds
    ds_read_b64_tr_b16 v[160:161], v233 offset:41024
    ds_read_b64_tr_b16 v[162:163], v233 offset:42304
    v_mfma_f32_16x16x32_bf16 v[124:127], v[20:23], v[220:223], v[124:127]
    ds_read_b64_tr_b16 v[180:181], v233 offset:51264
    ds_read_b64_tr_b16 v[182:183], v233 offset:52544
    s_waitcnt lgkmcnt(12)
    v_mfma_f32_16x16x32_bf16 v[108:111], v[20:23], v[204:207], v[108:111]
    ds_read_b64_tr_b16 v[164:165], v233 offset:41056
    ds_read_b64_tr_b16 v[166:167], v233 offset:42336
    v_mfma_f32_16x16x32_bf16 v[128:131], v[20:23], v[224:227], v[128:131]
    ds_read_b64_tr_b16 v[184:185], v233 offset:51296
    ds_read_b64_tr_b16 v[186:187], v233 offset:52576
    v_mfma_f32_16x16x32_bf16 v[112:115], v[20:23], v[208:211], v[112:115]
    ds_read_b64_tr_b16 v[168:169], v233 offset:41088
    ds_read_b64_tr_b16 v[170:171], v233 offset:42368
    v_mfma_f32_16x16x32_bf16 v[132:135], v[20:23], v[228:231], v[132:135]
    buffer_load_dwordx4 v251, s[8:11], s74 offen offset:1024 lds
    ds_read_b64_tr_b16 v[188:189], v233 offset:51328
    ds_read_b64_tr_b16 v[190:191], v233 offset:52608
    s_waitcnt lgkmcnt(8)
    v_mfma_f32_16x16x32_bf16 v[96:99], v[24:27], v[152:155], v[96:99]
    ds_read_b64_tr_b16 v[192:193], v233 offset:46080
    ds_read_b64_tr_b16 v[194:195], v233 offset:47360
    v_mfma_f32_16x16x32_bf16 v[116:119], v[24:27], v[172:175], v[116:119]
    ds_read_b64_tr_b16 v[212:213], v233 offset:56320
    ds_read_b64_tr_b16 v[214:215], v233 offset:57600
    v_mfma_f32_16x16x32_bf16 v[100:103], v[24:27], v[156:159], v[100:103]
    ds_read_b64_tr_b16 v[196:197], v233 offset:46112
    ds_read_b64_tr_b16 v[198:199], v233 offset:47392
    v_mfma_f32_16x16x32_bf16 v[120:123], v[24:27], v[176:179], v[120:123]
    ds_read_b64_tr_b16 v[216:217], v233 offset:56352
    ds_read_b64_tr_b16 v[218:219], v233 offset:57632
    v_mfma_f32_16x16x32_bf16 v[104:107], v[24:27], v[160:163], v[104:107]
    ds_read_b64_tr_b16 v[200:201], v233 offset:46144
    ds_read_b64_tr_b16 v[202:203], v233 offset:47424
    v_mfma_f32_16x16x32_bf16 v[124:127], v[24:27], v[180:183], v[124:127]
    buffer_load_dwordx4 v252, s[8:11], s74 offen offset:2048 lds
    ds_read_b64_tr_b16 v[220:221], v233 offset:56384
    ds_read_b64_tr_b16 v[222:223], v233 offset:57664
    s_waitcnt lgkmcnt(12)
    v_mfma_f32_16x16x32_bf16 v[108:111], v[24:27], v[164:167], v[108:111]
    ds_read_b64_tr_b16 v[204:205], v233 offset:46176
    ds_read_b64_tr_b16 v[206:207], v233 offset:47456
    v_mfma_f32_16x16x32_bf16 v[128:131], v[24:27], v[184:187], v[128:131]
    ds_read_b64_tr_b16 v[224:225], v233 offset:56416
    ds_read_b64_tr_b16 v[226:227], v233 offset:57696
    v_mfma_f32_16x16x32_bf16 v[112:115], v[24:27], v[168:171], v[112:115]
    ds_read_b64_tr_b16 v[208:209], v233 offset:46208
    ds_read_b64_tr_b16 v[210:211], v233 offset:47488
    v_mfma_f32_16x16x32_bf16 v[132:135], v[24:27], v[188:191], v[132:135]
    ds_read_b64_tr_b16 v[228:229], v233 offset:56448
    ds_read_b64_tr_b16 v[230:231], v233 offset:57728
    s_waitcnt vmcnt(18)
    s_barrier
    s_waitcnt lgkmcnt(8)
    v_mfma_f32_16x16x32_bf16 v[96:99], v[28:31], v[192:195], v[96:99]
    buffer_load_dwordx4 v253, s[8:11], s74 offen offset:3072 lds
    ds_read_b64_tr_b16 v[152:153], v234 offset:0
    ds_read_b64_tr_b16 v[154:155], v234 offset:1280
    v_mfma_f32_16x16x32_bf16 v[116:119], v[28:31], v[212:215], v[116:119]
    ds_read_b64_tr_b16 v[172:173], v234 offset:10240
    ds_read_b64_tr_b16 v[174:175], v234 offset:11520
    v_mfma_f32_16x16x32_bf16 v[100:103], v[28:31], v[196:199], v[100:103]
    ds_read_b64_tr_b16 v[156:157], v234 offset:32
    ds_read_b64_tr_b16 v[158:159], v234 offset:1312
    v_mfma_f32_16x16x32_bf16 v[120:123], v[28:31], v[216:219], v[120:123]
    ds_read_b64_tr_b16 v[176:177], v234 offset:10272
    ds_read_b64_tr_b16 v[178:179], v234 offset:11552
    v_mfma_f32_16x16x32_bf16 v[104:107], v[28:31], v[200:203], v[104:107]
    ds_read_b64_tr_b16 v[160:161], v234 offset:64
    ds_read_b64_tr_b16 v[162:163], v234 offset:1344
    v_mfma_f32_16x16x32_bf16 v[124:127], v[28:31], v[220:223], v[124:127]
    ds_read_b64_tr_b16 v[180:181], v234 offset:10304
    ds_read_b64_tr_b16 v[182:183], v234 offset:11584
    s_waitcnt lgkmcnt(12)
    v_mfma_f32_16x16x32_bf16 v[108:111], v[28:31], v[204:207], v[108:111]
    s_add_u32 m0, s75, 45056
    s_nop 0
    buffer_load_dwordx4 v254, s[8:11], s74 offen lds
    s_add_u32 s74, s74, 245760
    s_cmp_ge_u32 s74, s76
    s_cselect_b32 s46, 2457600, 0
    s_sub_u32 s74, s74, s46
    ds_read_b64_tr_b16 v[164:165], v234 offset:96
    ds_read_b64_tr_b16 v[166:167], v234 offset:1376
    v_mfma_f32_16x16x32_bf16 v[128:131], v[28:31], v[224:227], v[128:131]
    ds_read_b64_tr_b16 v[184:185], v234 offset:10336
    ds_read_b64_tr_b16 v[186:187], v234 offset:11616
    v_mfma_f32_16x16x32_bf16 v[112:115], v[28:31], v[208:211], v[112:115]
    ds_read_b64_tr_b16 v[168:169], v234 offset:128
    ds_read_b64_tr_b16 v[170:171], v234 offset:1408
    v_mfma_f32_16x16x32_bf16 v[132:135], v[28:31], v[228:231], v[132:135]
    ds_read_b64_tr_b16 v[188:189], v234 offset:10368
    ds_read_b64_tr_b16 v[190:191], v234 offset:11648
    s_waitcnt lgkmcnt(8)
    v_mfma_f32_16x16x32_bf16 v[96:99], v[32:35], v[152:155], v[96:99]
    ds_read_b64_tr_b16 v[192:193], v234 offset:5120
    ds_read_b64_tr_b16 v[194:195], v234 offset:6400
    v_mfma_f32_16x16x32_bf16 v[116:119], v[32:35], v[172:175], v[116:119]
    s_add_u32 m0, s75, 61440
    s_nop 0
    buffer_load_dwordx4 v250, s[8:11], s74 offen lds
    ds_read_b64_tr_b16 v[212:213], v234 offset:15360
    ds_read_b64_tr_b16 v[214:215], v234 offset:16640
    v_mfma_f32_16x16x32_bf16 v[100:103], v[32:35], v[156:159], v[100:103]
    ds_read_b64_tr_b16 v[196:197], v234 offset:5152
    ds_read_b64_tr_b16 v[198:199], v234 offset:6432
    v_mfma_f32_16x16x32_bf16 v[120:123], v[32:35], v[176:179], v[120:123]
    ds_read_b64_tr_b16 v[216:217], v234 offset:15392
    ds_read_b64_tr_b16 v[218:219], v234 offset:16672
    v_mfma_f32_16x16x32_bf16 v[104:107], v[32:35], v[160:163], v[104:107]
    ds_read_b64_tr_b16 v[200:201], v234 offset:5184
    ds_read_b64_tr_b16 v[202:203], v234 offset:6464
    v_mfma_f32_16x16x32_bf16 v[124:127], v[32:35], v[180:183], v[124:127]
    ds_read_b64_tr_b16 v[220:221], v234 offset:15424
    ds_read_b64_tr_b16 v[222:223], v234 offset:16704
    s_waitcnt lgkmcnt(12)
    v_mfma_f32_16x16x32_bf16 v[108:111], v[32:35], v[164:167], v[108:111]
    buffer_load_dwordx4 v251, s[8:11], s74 offen offset:1024 lds
    ds_read_b64_tr_b16 v[204:205], v234 offset:5216
    ds_read_b64_tr_b16 v[206:207], v234 offset:6496
    v_mfma_f32_16x16x32_bf16 v[128:131], v[32:35], v[184:187], v[128:131]
    ds_read_b64_tr_b16 v[224:225], v234 offset:15456
    ds_read_b64_tr_b16 v[226:227], v234 offset:16736
    v_mfma_f32_16x16x32_bf16 v[112:115], v[32:35], v[168:171], v[112:115]
    ds_read_b64_tr_b16 v[208:209], v234 offset:5248
    ds_read_b64_tr_b16 v[210:211], v234 offset:6528
    v_mfma_f32_16x16x32_bf16 v[132:135], v[32:35], v[188:191], v[132:135]
    ds_read_b64_tr_b16 v[228:229], v234 offset:15488
    ds_read_b64_tr_b16 v[230:231], v234 offset:16768
    s_waitcnt vmcnt(17)
    s_barrier
    s_waitcnt lgkmcnt(8)
    v_mfma_f32_16x16x32_bf16 v[96:99], v[36:39], v[192:195], v[96:99]
    ds_read_b64_tr_b16 v[152:153], v234 offset:20480
    ds_read_b64_tr_b16 v[154:155], v234 offset:21760
    v_mfma_f32_16x16x32_bf16 v[116:119], v[36:39], v[212:215], v[116:119]
    ds_read_b64_tr_b16 v[172:173], v234 offset:30720
    ds_read_b64_tr_b16 v[174:175], v234 offset:32000
    v_mfma_f32_16x16x32_bf16 v[100:103], v[36:39], v[196:199], v[100:103]
    buffer_load_dwordx4 v252, s[8:11], s74 offen offset:2048 lds
    ds_read_b64_tr_b16 v[156:157], v234 offset:20512
    ds_read_b64_tr_b16 v[158:159], v234 offset:21792
    v_mfma_f32_16x16x32_bf16 v[120:123], v[36:39], v[216:219], v[120:123]
    ds_read_b64_tr_b16 v[176:177], v234 offset:30752
    ds_read_b64_tr_b16 v[178:179], v234 offset:32032
    v_mfma_f32_16x16x32_bf16 v[104:107], v[36:39], v[200:203], v[104:107]
    ds_read_b64_tr_b16 v[160:161], v234 offset:20544
    ds_read_b64_tr_b16 v[162:163], v234 offset:21824
    v_mfma_f32_16x16x32_bf16 v[124:127], v[36:39], v[220:223], v[124:127]
    ds_read_b64_tr_b16 v[180:181], v234 offset:30784
    ds_read_b64_tr_b16 v[182:183], v234 offset:32064
    s_waitcnt lgkmcnt(12)
    v_mfma_f32_16x16x32_bf16 v[108:111], v[36:39], v[204:207], v[108:111]
    ds_read_b64_tr_b16 v[164:165], v234 offset:20576
    ds_read_b64_tr_b16 v[166:167], v234 offset:21856
    v_mfma_f32_16x16x32_bf16 v[128:131], v[36:39], v[224:227], v[128:131]
    buffer_load_dwordx4 v253, s[8:11], s74 offen offset:3072 lds
    ds_read_b64_tr_b16 v[184:185], v234 offset:30816
    ds_read_b64_tr_b16 v[186:187], v234 offset:32096
    v_mfma_f32_16x16x32_bf16 v[112:115], v[36:39], v[208:211], v[112:115]
    ds_read_b64_tr_b16 v[168:169], v234 offset:20608
    ds_read_b64_tr_b16 v[170:171], v234 offset:21888
    v_mfma_f32_16x16x32_bf16 v[132:135], v[36:39], v[228:231], v[132:135]
    ds_read_b64_tr_b16 v[188:189], v234 offset:30848
    ds_read_b64_tr_b16 v[190:191], v234 offset:32128
    s_waitcnt lgkmcnt(8)
    v_mfma_f32_16x16x32_bf16 v[96:99], v[40:43], v[152:155], v[96:99]
    ds_read_b64_tr_b16 v[192:193], v234 offset:25600
    ds_read_b64_tr_b16 v[194:195], v234 offset:26880
    v_mfma_f32_16x16x32_bf16 v[116:119], v[40:43], v[172:175], v[116:119]
    ds_read_b64_tr_b16 v[212:213], v234 offset:35840
    ds_read_b64_tr_b16 v[214:215], v234 offset:37120
    v_mfma_f32_16x16x32_bf16 v[100:103], v[40:43], v[156:159], v[100:103]
    ds_read_b64_tr_b16 v[196:197], v234 offset:25632
    ds_read_b64_tr_b16 v[198:199], v234 offset:26912
    v_mfma_f32_16x16x32_bf16 v[120:123], v[40:43], v[176:179], v[120:123]
    s_add_u32 m0, s75, 65536
    s_nop 0
    buffer_load_dwordx4 v254, s[8:11], s74 offen lds
    s_add_u32 s74, s74, 245760
    s_cmp_ge_u32 s74, s76
    s_cselect_b32 s46, 2457600, 0
    s_sub_u32 s74, s74, s46
    ds_read_b64_tr_b16 v[216:217], v234 offset:35872
    ds_read_b64_tr_b16 v[218:219], v234 offset:37152
    v_mfma_f32_16x16x32_bf16 v[104:107], v[40:43], v[160:163], v[104:107]
    ds_read_b64_tr_b16 v[200:201], v234 offset:25664
    ds_read_b64_tr_b16 v[202:203], v234 offset:26944
    v_mfma_f32_16x16x32_bf16 v[124:127], v[40:43], v[180:183], v[124:127]
    ds_read_b64_tr_b16 v[220:221], v234 offset:35904
    ds_read_b64_tr_b16 v[222:223], v234 offset:37184
    s_waitcnt lgkmcnt(12)
    v_mfma_f32_16x16x32_bf16 v[108:111], v[40:43], v[164:167], v[108:111]
    ds_read_b64_tr_b16 v[204:205], v234 offset:25696
    ds_read_b64_tr_b16 v[206:207], v234 offset:26976
    v_mfma_f32_16x16x32_bf16 v[128:131], v[40:43], v[184:187], v[128:131]
    ds_read_b64_tr_b16 v[224:225], v234 offset:35936
    ds_read_b64_tr_b16 v[226:227], v234 offset:37216
    v_mfma_f32_16x16x32_bf16 v[112:115], v[40:43], v[168:171], v[112:115]
    s_add_u32 m0, s75, 81920
    s_nop 0
    buffer_load_dwordx4 v250, s[8:11], s74 offen lds
    ds_read_b64_tr_b16 v[208:209], v234 offset:25728
    ds_read_b64_tr_b16 v[210:211], v234 offset:27008
    v_mfma_f32_16x16x32_bf16 v[132:135], v[40:43], v[188:191], v[132:135]
    ds_read_b64_tr_b16 v[228:229], v234 offset:35968
    ds_read_b64_tr_b16 v[230:231], v234 offset:37248
    v_mov_b32 v2, 0
    buffer_load_dword a253, v2, s[32:35], 0 offen sc1
    s_waitcnt vmcnt(17)
    s_barrier
    s_waitcnt lgkmcnt(8)
    v_mfma_f32_16x16x32_bf16 v[96:99], v[44:47], v[192:195], v[96:99]
    ds_read_b64_tr_b16 v[152:153], v232 offset:0
    ds_read_b64_tr_b16 v[154:155], v232 offset:1280
    v_mfma_f32_16x16x32_bf16 v[116:119], v[44:47], v[212:215], v[116:119]
    ds_read_b64_tr_b16 v[172:173], v232 offset:10240
    ds_read_b64_tr_b16 v[174:175], v232 offset:11520
    v_mfma_f32_16x16x32_bf16 v[100:103], v[44:47], v[196:199], v[100:103]
    ds_read_b64_tr_b16 v[156:157], v232 offset:32
    ds_read_b64_tr_b16 v[158:159], v232 offset:1312
    v_mfma_f32_16x16x32_bf16 v[120:123], v[44:47], v[216:219], v[120:123]
    buffer_load_dwordx4 v251, s[8:11], s74 offen offset:1024 lds
    ds_read_b64_tr_b16 v[176:177], v232 offset:10272
    ds_read_b64_tr_b16 v[178:179], v232 offset:11552
    v_mfma_f32_16x16x32_bf16 v[104:107], v[44:47], v[200:203], v[104:107]
    ds_read_b64_tr_b16 v[160:161], v232 offset:64
    ds_read_b64_tr_b16 v[162:163], v232 offset:1344
    v_mfma_f32_16x16x32_bf16 v[124:127], v[44:47], v[220:223], v[124:127]
    ds_read_b64_tr_b16 v[180:181], v232 offset:10304
    ds_read_b64_tr_b16 v[182:183], v232 offset:11584
    s_waitcnt lgkmcnt(12)
    v_mfma_f32_16x16x32_bf16 v[108:111], v[44:47], v[204:207], v[108:111]
    ds_read_b64_tr_b16 v[164:165], v232 offset:96
    ds_read_b64_tr_b16 v[166:167], v232 offset:1376
    v_mfma_f32_16x16x32_bf16 v[128:131], v[44:47], v[224:227], v[128:131]
    ds_read_b64_tr_b16 v[184:185], v232 offset:10336
    ds_read_b64_tr_b16 v[186:187], v232 offset:11616
    v_mfma_f32_16x16x32_bf16 v[112:115], v[44:47], v[208:211], v[112:115]
    ds_read_b64_tr_b16 v[168:169], v232 offset:128
    ds_read_b64_tr_b16 v[170:171], v232 offset:1408
    v_mfma_f32_16x16x32_bf16 v[132:135], v[44:47], v[228:231], v[132:135]
    buffer_load_dwordx4 v252, s[8:11], s74 offen offset:2048 lds
    ds_read_b64_tr_b16 v[188:189], v232 offset:10368
    ds_read_b64_tr_b16 v[190:191], v232 offset:11648
    s_waitcnt lgkmcnt(8)
    v_mfma_f32_16x16x32_bf16 v[96:99], v[48:51], v[152:155], v[96:99]
    ds_read_b64_tr_b16 v[192:193], v232 offset:5120
    ds_read_b64_tr_b16 v[194:195], v232 offset:6400
    v_mfma_f32_16x16x32_bf16 v[116:119], v[48:51], v[172:175], v[116:119]
    ds_read_b64_tr_b16 v[212:213], v232 offset:15360
    ds_read_b64_tr_b16 v[214:215], v232 offset:16640
    v_mfma_f32_16x16x32_bf16 v[100:103], v[48:51], v[156:159], v[100:103]
    ds_read_b64_tr_b16 v[196:197], v232 offset:5152
    ds_read_b64_tr_b16 v[198:199], v232 offset:6432
    v_mfma_f32_16x16x32_bf16 v[120:123], v[48:51], v[176:179], v[120:123]
    ds_read_b64_tr_b16 v[216:217], v232 offset:15392
    ds_read_b64_tr_b16 v[218:219], v232 offset:16672
    v_mfma_f32_16x16x32_bf16 v[104:107], v[48:51], v[160:163], v[104:107]
    buffer_load_dwordx4 v253, s[8:11], s74 offen offset:3072 lds
    ds_read_b64_tr_b16 v[200:201], v232 offset:5184
    ds_read_b64_tr_b16 v[202:203], v232 offset:6464
    v_mfma_f32_16x16x32_bf16 v[124:127], v[48:51], v[180:183], v[124:127]
    ds_read_b64_tr_b16 v[220:221], v232 offset:15424
    ds_read_b64_tr_b16 v[222:223], v232 offset:16704
    s_waitcnt lgkmcnt(12)
    v_mfma_f32_16x16x32_bf16 v[108:111], v[48:51], v[164:167], v[108:111]
    ds_read_b64_tr_b16 v[204:205], v232 offset:5216
    ds_read_b64_tr_b16 v[206:207], v232 offset:6496
    v_mfma_f32_16x16x32_bf16 v[128:131], v[48:51], v[184:187], v[128:131]
    ds_read_b64_tr_b16 v[224:225], v232 offset:15456
    ds_read_b64_tr_b16 v[226:227], v232 offset:16736
    v_mfma_f32_16x16x32_bf16 v[112:115], v[48:51], v[168:171], v[112:115]
    ds_read_b64_tr_b16 v[208:209], v232 offset:5248
    ds_read_b64_tr_b16 v[210:211], v232 offset:6528
    v_mfma_f32_16x16x32_bf16 v[132:135], v[48:51], v[188:191], v[132:135]
    ds_read_b64_tr_b16 v[228:229], v232 offset:15488
    ds_read_b64_tr_b16 v[230:231], v232 offset:16768
    s_waitcnt vmcnt(15)
    s_barrier
    s_waitcnt lgkmcnt(8)
    v_mfma_f32_16x16x32_bf16 v[96:99], v[52:55], v[192:195], v[96:99]
    s_add_u32 m0, s75, 86016
    s_nop 0
    buffer_load_dwordx4 v254, s[8:11], s74 offen lds
    s_add_u32 s74, s74, 245760
    s_cmp_ge_u32 s74, s76
    s_cselect_b32 s46, 2457600, 0
    s_sub_u32 s74, s74, s46
    ds_read_b64_tr_b16 v[152:153], v232 offset:20480
    ds_read_b64_tr_b16 v[154:155], v232 offset:21760
    v_mfma_f32_16x16x32_bf16 v[116:119], v[52:55], v[212:215], v[116:119]
    ds_read_b64_tr_b16 v[172:173], v232 offset:30720
    ds_read_b64_tr_b16 v[174:175], v232 offset:32000
    v_mfma_f32_16x16x32_bf16 v[100:103], v[52:55], v[196:199], v[100:103]
    ds_read_b64_tr_b16 v[156:157], v232 offset:20512
    ds_read_b64_tr_b16 v[158:159], v232 offset:21792
    v_mfma_f32_16x16x32_bf16 v[120:123], v[52:55], v[216:219], v[120:123]
    ds_read_b64_tr_b16 v[176:177], v232 offset:30752
    ds_read_b64_tr_b16 v[178:179], v232 offset:32032
    v_mfma_f32_16x16x32_bf16 v[104:107], v[52:55], v[200:203], v[104:107]
    ds_read_b64_tr_b16 v[160:161], v232 offset:20544
    ds_read_b64_tr_b16 v[162:163], v232 offset:21824
    v_mfma_f32_16x16x32_bf16 v[124:127], v[52:55], v[220:223], v[124:127]
    ds_read_b64_tr_b16 v[180:181], v232 offset:30784
    ds_read_b64_tr_b16 v[182:183], v232 offset:32064
    s_waitcnt lgkmcnt(12)
    v_mfma_f32_16x16x32_bf16 v[108:111], v[52:55], v[204:207], v[108:111]
    s_add_u32 m0, s75, 102400
    s_nop 0
    buffer_load_dwordx4 v250, s[8:11], s74 offen lds
    ds_read_b64_tr_b16 v[164:165], v232 offset:20576
    ds_read_b64_tr_b16 v[166:167], v232 offset:21856
    v_mfma_f32_16x16x32_bf16 v[128:131], v[52:55], v[224:227], v[128:131]
    ds_read_b64_tr_b16 v[184:185], v232 offset:30816
    ds_read_b64_tr_b16 v[186:187], v232 offset:32096
    v_mfma_f32_16x16x32_bf16 v[112:115], v[52:55], v[208:211], v[112:115]
    ds_read_b64_tr_b16 v[168:169], v232 offset:20608
    ds_read_b64_tr_b16 v[170:171], v232 offset:21888
    v_mfma_f32_16x16x32_bf16 v[132:135], v[52:55], v[228:231], v[132:135]
    ds_read_b64_tr_b16 v[188:189], v232 offset:30848
    ds_read_b64_tr_b16 v[190:191], v232 offset:32128
    s_waitcnt lgkmcnt(8)
    v_mfma_f32_16x16x32_bf16 v[96:99], v[56:59], v[152:155], v[96:99]
    ds_read_b64_tr_b16 v[192:193], v232 offset:25600
    ds_read_b64_tr_b16 v[194:195], v232 offset:26880
    v_mfma_f32_16x16x32_bf16 v[116:119], v[56:59], v[172:175], v[116:119]
    buffer_load_dwordx4 v251, s[8:11], s74 offen offset:1024 lds
    ds_read_b64_tr_b16 v[212:213], v232 offset:35840
    ds_read_b64_tr_b16 v[214:215], v232 offset:37120
    v_mfma_f32_16x16x32_bf16 v[100:103], v[56:59], v[156:159], v[100:103]
    ds_read_b64_tr_b16 v[196:197], v232 offset:25632
    ds_read_b64_tr_b16 v[198:199], v232 offset:26912
    v_mfma_f32_16x16x32_bf16 v[120:123], v[56:59], v[176:179], v[120:123]
    ds_read_b64_tr_b16 v[216:217], v232 offset:35872
    ds_read_b64_tr_b16 v[218:219], v232 offset:37152
    v_mfma_f32_16x16x32_bf16 v[104:107], v[56:59], v[160:163], v[104:107]
    ds_read_b64_tr_b16 v[200:201], v232 offset:25664
    ds_read_b64_tr_b16 v[202:203], v232 offset:26944
    v_mfma_f32_16x16x32_bf16 v[124:127], v[56:59], v[180:183], v[124:127]
    ds_read_b64_tr_b16 v[220:221], v232 offset:35904
    ds_read_b64_tr_b16 v[222:223], v232 offset:37184
    s_waitcnt lgkmcnt(12)
    v_mfma_f32_16x16x32_bf16 v[108:111], v[56:59], v[164:167], v[108:111]
    ds_read_b64_tr_b16 v[204:205], v232 offset:25696
    ds_read_b64_tr_b16 v[206:207], v232 offset:26976
    v_mfma_f32_16x16x32_bf16 v[128:131], v[56:59], v[184:187], v[128:131]
    buffer_load_dwordx4 v252, s[8:11], s74 offen offset:2048 lds
    ds_read_b64_tr_b16 v[224:225], v232 offset:35936
    ds_read_b64_tr_b16 v[226:227], v232 offset:37216
    v_mfma_f32_16x16x32_bf16 v[112:115], v[56:59], v[168:171], v[112:115]
    ds_read_b64_tr_b16 v[208:209], v232 offset:25728
    ds_read_b64_tr_b16 v[210:211], v232 offset:27008
    v_mfma_f32_16x16x32_bf16 v[132:135], v[56:59], v[188:191], v[132:135]
    ds_read_b64_tr_b16 v[228:229], v232 offset:35968
    ds_read_b64_tr_b16 v[230:231], v232 offset:37248
    s_waitcnt vmcnt(14)
    s_barrier
    s_waitcnt lgkmcnt(8)
    v_mfma_f32_16x16x32_bf16 v[96:99], v[60:63], v[192:195], v[96:99]
    ds_read_b64_tr_b16 v[152:153], v232 offset:40960
    ds_read_b64_tr_b16 v[154:155], v232 offset:42240
    v_mfma_f32_16x16x32_bf16 v[116:119], v[60:63], v[212:215], v[116:119]
    ds_read_b64_tr_b16 v[172:173], v232 offset:51200
    ds_read_b64_tr_b16 v[174:175], v232 offset:52480
    v_mfma_f32_16x16x32_bf16 v[100:103], v[60:63], v[196:199], v[100:103]
    buffer_load_dwordx4 v253, s[8:11], s74 offen offset:3072 lds
    ds_read_b64_tr_b16 v[156:157], v232 offset:40992
    ds_read_b64_tr_b16 v[158:159], v232 offset:42272
    v_mfma_f32_16x16x32_bf16 v[120:123], v[60:63], v[216:219], v[120:123]
    ds_read_b64_tr_b16 v[176:177], v232 offset:51232
    ds_read_b64_tr_b16 v[178:179], v232 offset:52512
    v_mfma_f32_16x16x32_bf16 v[104:107], v[60:63], v[200:203], v[104:107]
    ds_read_b64_tr_b16 v[160:161], v232 offset:41024
    ds_read_b64_tr_b16 v[162:163], v232 offset:42304
    v_mfma_f32_16x16x32_bf16 v[124:127], v[60:63], v[220:223], v[124:127]
    ds_read_b64_tr_b16 v[180:181], v232 offset:51264
    ds_read_b64_tr_b16 v[182:183], v232 offset:52544
    s_waitcnt lgkmcnt(12)
    v_mfma_f32_16x16x32_bf16 v[108:111], v[60:63], v[204:207], v[108:111]
    ds_read_b64_tr_b16 v[164:165], v232 offset:41056
    ds_read_b64_tr_b16 v[166:167], v232 offset:42336
    v_mfma_f32_16x16x32_bf16 v[128:131], v[60:63], v[224:227], v[128:131]
    ds_read_b64_tr_b16 v[184:185], v232 offset:51296
    ds_read_b64_tr_b16 v[186:187], v232 offset:52576
    v_mfma_f32_16x16x32_bf16 v[112:115], v[60:63], v[208:211], v[112:115]
    s_add_u32 m0, s75, 106496
    s_nop 0
    buffer_load_dwordx4 v254, s[8:11], s74 offen lds
    ds_read_b64_tr_b16 v[168:169], v232 offset:41088
    ds_read_b64_tr_b16 v[170:171], v232 offset:42368
    v_mfma_f32_16x16x32_bf16 v[132:135], v[60:63], v[228:231], v[132:135]
    ds_read_b64_tr_b16 v[188:189], v232 offset:51328
    ds_read_b64_tr_b16 v[190:191], v232 offset:52608
    s_waitcnt lgkmcnt(8)
    v_mfma_f32_16x16x32_bf16 v[96:99], v[64:67], v[152:155], v[96:99]
    ds_read_b64_tr_b16 v[192:193], v232 offset:46080
    ds_read_b64_tr_b16 v[194:195], v232 offset:47360
    v_mfma_f32_16x16x32_bf16 v[116:119], v[64:67], v[172:175], v[116:119]
    ds_read_b64_tr_b16 v[212:213], v232 offset:56320
    ds_read_b64_tr_b16 v[214:215], v232 offset:57600
    v_mfma_f32_16x16x32_bf16 v[100:103], v[64:67], v[156:159], v[100:103]
    ds_read_b64_tr_b16 v[196:197], v232 offset:46112
    ds_read_b64_tr_b16 v[198:199], v232 offset:47392
    v_mfma_f32_16x16x32_bf16 v[120:123], v[64:67], v[176:179], v[120:123]
    s_add_u32 m0, s75, 122880
    s_nop 0
    buffer_load_dwordx4 v250, s[8:11], s73 offen lds
    ds_read_b64_tr_b16 v[216:217], v232 offset:56352
    ds_read_b64_tr_b16 v[218:219], v232 offset:57632
    v_mfma_f32_16x16x32_bf16 v[104:107], v[64:67], v[160:163], v[104:107]
    ds_read_b64_tr_b16 v[200:201], v232 offset:46144
    ds_read_b64_tr_b16 v[202:203], v232 offset:47424
    v_mfma_f32_16x16x32_bf16 v[124:127], v[64:67], v[180:183], v[124:127]
    ds_read_b64_tr_b16 v[220:221], v232 offset:56384
    ds_read_b64_tr_b16 v[222:223], v232 offset:57664
    s_waitcnt lgkmcnt(12)
    v_mfma_f32_16x16x32_bf16 v[108:111], v[64:67], v[164:167], v[108:111]
    ds_read_b64_tr_b16 v[204:205], v232 offset:46176
    ds_read_b64_tr_b16 v[206:207], v232 offset:47456
    v_mfma_f32_16x16x32_bf16 v[128:131], v[64:67], v[184:187], v[128:131]
    ds_read_b64_tr_b16 v[224:225], v232 offset:56416
    ds_read_b64_tr_b16 v[226:227], v232 offset:57696
    v_mfma_f32_16x16x32_bf16 v[112:115], v[64:67], v[168:171], v[112:115]
    buffer_load_dwordx4 v251, s[8:11], s73 offen offset:1024 lds
    ds_read_b64_tr_b16 v[208:209], v232 offset:46208
    ds_read_b64_tr_b16 v[210:211], v232 offset:47488
    v_mfma_f32_16x16x32_bf16 v[132:135], v[64:67], v[188:191], v[132:135]
    ds_read_b64_tr_b16 v[228:229], v232 offset:56448
    ds_read_b64_tr_b16 v[230:231], v232 offset:57728
    s_waitcnt vmcnt(13)
    s_barrier
    s_waitcnt lgkmcnt(8)
    v_mfma_f32_16x16x32_bf16 v[96:99], v[68:71], v[192:195], v[96:99]
    ds_read_b64_tr_b16 v[152:153], v233 offset:0
    ds_read_b64_tr_b16 v[154:155], v233 offset:1280
    v_mfma_f32_16x16x32_bf16 v[116:119], v[68:71], v[212:215], v[116:119]
    ds_read_b64_tr_b16 v[172:173], v233 offset:10240
    ds_read_b64_tr_b16 v[174:175], v233 offset:11520
    v_mfma_f32_16x16x32_bf16 v[100:103], v[68:71], v[196:199], v[100:103]
    ds_read_b64_tr_b16 v[156:157], v233 offset:32
    ds_read_b64_tr_b16 v[158:159], v233 offset:1312
    v_mfma_f32_16x16x32_bf16 v[120:123], v[68:71], v[216:219], v[120:123]
    ds_read_b64_tr_b16 v[176:177], v233 offset:10272
    ds_read_b64_tr_b16 v[178:179], v233 offset:11552
    v_mfma_f32_16x16x32_bf16 v[104:107], v[68:71], v[200:203], v[104:107]
    buffer_load_dwordx4 v252, s[8:11], s73 offen offset:2048 lds
    ds_read_b64_tr_b16 v[160:161], v233 offset:64
    ds_read_b64_tr_b16 v[162:163], v233 offset:1344
    v_mfma_f32_16x16x32_bf16 v[124:127], v[68:71], v[220:223], v[124:127]
    ds_read_b64_tr_b16 v[180:181], v233 offset:10304
    ds_read_b64_tr_b16 v[182:183], v233 offset:11584
    s_waitcnt lgkmcnt(12)
    v_mfma_f32_16x16x32_bf16 v[108:111], v[68:71], v[204:207], v[108:111]
    ds_read_b64_tr_b16 v[164:165], v233 offset:96
    ds_read_b64_tr_b16 v[166:167], v233 offset:1376
    v_mfma_f32_16x16x32_bf16 v[128:131], v[68:71], v[224:227], v[128:131]
    ds_read_b64_tr_b16 v[184:185], v233 offset:10336
    ds_read_b64_tr_b16 v[186:187], v233 offset:11616
    v_mfma_f32_16x16x32_bf16 v[112:115], v[68:71], v[208:211], v[112:115]
    ds_read_b64_tr_b16 v[168:169], v233 offset:128
    ds_read_b64_tr_b16 v[170:171], v233 offset:1408
    v_mfma_f32_16x16x32_bf16 v[132:135], v[68:71], v[228:231], v[132:135]
    buffer_load_dwordx4 v253, s[8:11], s73 offen offset:3072 lds
    ds_read_b64_tr_b16 v[188:189], v233 offset:10368
    ds_read_b64_tr_b16 v[190:191], v233 offset:11648
    s_waitcnt lgkmcnt(8)
    v_mfma_f32_16x16x32_bf16 v[96:99], v[72:75], v[152:155], v[96:99]
    ds_read_b64_tr_b16 v[192:193], v233 offset:5120
    ds_read_b64_tr_b16 v[194:195], v233 offset:6400
    v_mfma_f32_16x16x32_bf16 v[116:119], v[72:75], v[172:175], v[116:119]
    ds_read_b64_tr_b16 v[212:213], v233 offset:15360
    ds_read_b64_tr_b16 v[214:215], v233 offset:16640
    v_mfma_f32_16x16x32_bf16 v[100:103], v[72:75], v[156:159], v[100:103]
    ds_read_b64_tr_b16 v[196:197], v233 offset:5152
    ds_read_b64_tr_b16 v[198:199], v233 offset:6432
    v_mfma_f32_16x16x32_bf16 v[120:123], v[72:75], v[176:179], v[120:123]
    ds_read_b64_tr_b16 v[216:217], v233 offset:15392
    ds_read_b64_tr_b16 v[218:219], v233 offset:16672
    v_mfma_f32_16x16x32_bf16 v[104:107], v[72:75], v[160:163], v[104:107]
    ds_read_b64_tr_b16 v[200:201], v233 offset:5184
    ds_read_b64_tr_b16 v[202:203], v233 offset:6464
    v_mfma_f32_16x16x32_bf16 v[124:127], v[72:75], v[180:183], v[124:127]
    s_add_u32 m0, s75, 126976
    s_nop 0
    buffer_load_dwordx4 v254, s[8:11], s73 offen lds
    s_add_u32 s73, s73, 491520
    s_cmp_ge_u32 s73, s77
    s_cselect_b32 s46, 2457600, 0
    s_sub_u32 s73, s73, s46
    ds_read_b64_tr_b16 v[220:221], v233 offset:15424
    ds_read_b64_tr_b16 v[222:223], v233 offset:16704
    s_waitcnt lgkmcnt(12)
    v_mfma_f32_16x16x32_bf16 v[108:111], v[72:75], v[164:167], v[108:111]
    ds_read_b64_tr_b16 v[204:205], v233 offset:5216
    ds_read_b64_tr_b16 v[206:207], v233 offset:6496
    v_mfma_f32_16x16x32_bf16 v[128:131], v[72:75], v[184:187], v[128:131]
    ds_read_b64_tr_b16 v[224:225], v233 offset:15456
    ds_read_b64_tr_b16 v[226:227], v233 offset:16736
    v_mfma_f32_16x16x32_bf16 v[112:115], v[72:75], v[168:171], v[112:115]
    ds_read_b64_tr_b16 v[208:209], v233 offset:5248
    ds_read_b64_tr_b16 v[210:211], v233 offset:6528
    v_mfma_f32_16x16x32_bf16 v[132:135], v[72:75], v[188:191], v[132:135]
    ds_read_b64_tr_b16 v[228:229], v233 offset:15488
    ds_read_b64_tr_b16 v[230:231], v233 offset:16768
    s_waitcnt vmcnt(10)
    s_barrier
    s_waitcnt lgkmcnt(8)
    v_mfma_f32_16x16x32_bf16 v[96:99], v[76:79], v[192:195], v[96:99]
    s_add_u32 m0, s75, 143360
    s_nop 0
    buffer_load_dwordx4 v250, s[8:11], s73 offen lds
    ds_read_b64_tr_b16 v[152:153], v233 offset:20480
    ds_read_b64_tr_b16 v[154:155], v233 offset:21760
    v_mfma_f32_16x16x32_bf16 v[116:119], v[76:79], v[212:215], v[116:119]
    ds_read_b64_tr_b16 v[172:173], v233 offset:30720
    ds_read_b64_tr_b16 v[174:175], v233 offset:32000
    v_mfma_f32_16x16x32_bf16 v[100:103], v[76:79], v[196:199], v[100:103]
    ds_read_b64_tr_b16 v[156:157], v233 offset:20512
    ds_read_b64_tr_b16 v[158:159], v233 offset:21792
    v_mfma_f32_16x16x32_bf16 v[120:123], v[76:79], v[216:219], v[120:123]
    ds_read_b64_tr_b16 v[176:177], v233 offset:30752
    ds_read_b64_tr_b16 v[178:179], v233 offset:32032
    v_mfma_f32_16x16x32_bf16 v[104:107], v[76:79], v[200:203], v[104:107]
    ds_read_b64_tr_b16 v[160:161], v233 offset:20544
    ds_read_b64_tr_b16 v[162:163], v233 offset:21824
    v_mfma_f32_16x16x32_bf16 v[124:127], v[76:79], v[220:223], v[124:127]
    ds_read_b64_tr_b16 v[180:181], v233 offset:30784
    ds_read_b64_tr_b16 v[182:183], v233 offset:32064
    s_waitcnt lgkmcnt(12)
    v_mfma_f32_16x16x32_bf16 v[108:111], v[76:79], v[204:207], v[108:111]
    buffer_load_dwordx4 v251, s[8:11], s73 offen offset:1024 lds
    ds_read_b64_tr_b16 v[164:165], v233 offset:20576
    ds_read_b64_tr_b16 v[166:167], v233 offset:21856
    v_mfma_f32_16x16x32_bf16 v[128:131], v[76:79], v[224:227], v[128:131]
    ds_read_b64_tr_b16 v[184:185], v233 offset:30816
    ds_read_b64_tr_b16 v[186:187], v233 offset:32096
    v_mfma_f32_16x16x32_bf16 v[112:115], v[76:79], v[208:211], v[112:115]
    ds_read_b64_tr_b16 v[168:169], v233 offset:20608
    ds_read_b64_tr_b16 v[170:171], v233 offset:21888
    v_mfma_f32_16x16x32_bf16 v[132:135], v[76:79], v[228:231], v[132:135]
    ds_read_b64_tr_b16 v[188:189], v233 offset:30848
    ds_read_b64_tr_b16 v[190:191], v233 offset:32128
    s_waitcnt lgkmcnt(8)
    v_mfma_f32_16x16x32_bf16 v[96:99], v[80:83], v[152:155], v[96:99]
    ds_read_b64_tr_b16 v[192:193], v233 offset:25600
    ds_read_b64_tr_b16 v[194:195], v233 offset:26880
    v_mfma_f32_16x16x32_bf16 v[116:119], v[80:83], v[172:175], v[116:119]
    buffer_load_dwordx4 v252, s[8:11], s73 offen offset:2048 lds
    ds_read_b64_tr_b16 v[212:213], v233 offset:35840
    ds_read_b64_tr_b16 v[214:215], v233 offset:37120
    v_mfma_f32_16x16x32_bf16 v[100:103], v[80:83], v[156:159], v[100:103]
    ds_read_b64_tr_b16 v[196:197], v233 offset:25632
    ds_read_b64_tr_b16 v[198:199], v233 offset:26912
    v_mfma_f32_16x16x32_bf16 v[120:123], v[80:83], v[176:179], v[120:123]
    ds_read_b64_tr_b16 v[216:217], v233 offset:35872
    ds_read_b64_tr_b16 v[218:219], v233 offset:37152
    v_mfma_f32_16x16x32_bf16 v[104:107], v[80:83], v[160:163], v[104:107]
    ds_read_b64_tr_b16 v[200:201], v233 offset:25664
    ds_read_b64_tr_b16 v[202:203], v233 offset:26944
    v_mfma_f32_16x16x32_bf16 v[124:127], v[80:83], v[180:183], v[124:127]
    ds_read_b64_tr_b16 v[220:221], v233 offset:35904
    ds_read_b64_tr_b16 v[222:223], v233 offset:37184
    s_waitcnt lgkmcnt(12)
    v_mfma_f32_16x16x32_bf16 v[108:111], v[80:83], v[164:167], v[108:111]
    ds_read_b64_tr_b16 v[204:205], v233 offset:25696
    ds_read_b64_tr_b16 v[206:207], v233 offset:26976
    v_mfma_f32_16x16x32_bf16 v[128:131], v[80:83], v[184:187], v[128:131]
    buffer_load_dwordx4 v253, s[8:11], s73 offen offset:3072 lds
    ds_read_b64_tr_b16 v[224:225], v233 offset:35936
    ds_read_b64_tr_b16 v[226:227], v233 offset:37216
    v_mfma_f32_16x16x32_bf16 v[112:115], v[80:83], v[168:171], v[112:115]
    ds_read_b64_tr_b16 v[208:209], v233 offset:25728
    ds_read_b64_tr_b16 v[210:211], v233 offset:27008
    v_mfma_f32_16x16x32_bf16 v[132:135], v[80:83], v[188:191], v[132:135]
    ds_read_b64_tr_b16 v[228:229], v233 offset:35968
    ds_read_b64_tr_b16 v[230:231], v233 offset:37248
    s_waitcnt vmcnt(9)
    s_barrier
    s_waitcnt lgkmcnt(8)
    v_mfma_f32_16x16x32_bf16 v[96:99], v[84:87], v[192:195], v[96:99]
    ds_read_b64_tr_b16 v[152:153], v233 offset:40960
    ds_read_b64_tr_b16 v[154:155], v233 offset:42240
    v_mfma_f32_16x16x32_bf16 v[116:119], v[84:87], v[212:215], v[116:119]
    ds_read_b64_tr_b16 v[172:173], v233 offset:51200
    ds_read_b64_tr_b16 v[174:175], v233 offset:52480
    v_mfma_f32_16x16x32_bf16 v[100:103], v[84:87], v[196:199], v[100:103]
    s_add_u32 m0, s75, 147456
    s_nop 0
    buffer_load_dwordx4 v254, s[8:11], s73 offen lds
    s_add_u32 s73, s73, 491520
    s_cmp_ge_u32 s73, s77
    s_cselect_b32 s46, 2457600, 0
    s_sub_u32 s73, s73, s46
    ds_read_b64_tr_b16 v[156:157], v233 offset:40992
    ds_read_b64_tr_b16 v[158:159], v233 offset:42272
    v_mfma_f32_16x16x32_bf16 v[120:123], v[84:87], v[216:219], v[120:123]
    ds_read_b64_tr_b16 v[176:177], v233 offset:51232
    ds_read_b64_tr_b16 v[178:179], v233 offset:52512
    v_mfma_f32_16x16x32_bf16 v[104:107], v[84:87], v[200:203], v[104:107]
    ds_read_b64_tr_b16 v[160:161], v233 offset:41024
    ds_read_b64_tr_b16 v[162:163], v233 offset:42304
    v_mfma_f32_16x16x32_bf16 v[124:127], v[84:87], v[220:223], v[124:127]
    ds_read_b64_tr_b16 v[180:181], v233 offset:51264
    ds_read_b64_tr_b16 v[182:183], v233 offset:52544
    s_waitcnt lgkmcnt(12)
    v_mfma_f32_16x16x32_bf16 v[108:111], v[84:87], v[204:207], v[108:111]
    ds_read_b64_tr_b16 v[164:165], v233 offset:41056
    ds_read_b64_tr_b16 v[166:167], v233 offset:42336
    v_mfma_f32_16x16x32_bf16 v[128:131], v[84:87], v[224:227], v[128:131]
    s_add_u32 m0, s75, 0
    s_nop 0
    buffer_load_dwordx4 v250, s[8:11], s73 offen lds
    ds_read_b64_tr_b16 v[184:185], v233 offset:51296
    ds_read_b64_tr_b16 v[186:187], v233 offset:52576
    v_mfma_f32_16x16x32_bf16 v[112:115], v[84:87], v[208:211], v[112:115]
    ds_read_b64_tr_b16 v[168:169], v233 offset:41088
    ds_read_b64_tr_b16 v[170:171], v233 offset:42368
    v_mfma_f32_16x16x32_bf16 v[132:135], v[84:87], v[228:231], v[132:135]
    ds_read_b64_tr_b16 v[188:189], v233 offset:51328
    ds_read_b64_tr_b16 v[190:191], v233 offset:52608
    s_waitcnt lgkmcnt(8)
    v_mfma_f32_16x16x32_bf16 v[96:99], v[88:91], v[152:155], v[96:99]
    ds_read_b64_tr_b16 v[192:193], v233 offset:46080
    ds_read_b64_tr_b16 v[194:195], v233 offset:47360
    v_mfma_f32_16x16x32_bf16 v[116:119], v[88:91], v[172:175], v[116:119]
    ds_read_b64_tr_b16 v[212:213], v233 offset:56320
    ds_read_b64_tr_b16 v[214:215], v233 offset:57600
    v_mfma_f32_16x16x32_bf16 v[100:103], v[88:91], v[156:159], v[100:103]
    buffer_load_dwordx4 v251, s[8:11], s73 offen offset:1024 lds
    ds_read_b64_tr_b16 v[196:197], v233 offset:46112
    ds_read_b64_tr_b16 v[198:199], v233 offset:47392
    v_mfma_f32_16x16x32_bf16 v[120:123], v[88:91], v[176:179], v[120:123]
    ds_read_b64_tr_b16 v[216:217], v233 offset:56352
    ds_read_b64_tr_b16 v[218:219], v233 offset:57632
    v_mfma_f32_16x16x32_bf16 v[104:107], v[88:91], v[160:163], v[104:107]
    ds_read_b64_tr_b16 v[200:201], v233 offset:46144
    ds_read_b64_tr_b16 v[202:203], v233 offset:47424
    v_mfma_f32_16x16x32_bf16 v[124:127], v[88:91], v[180:183], v[124:127]
    ds_read_b64_tr_b16 v[220:221], v233 offset:56384
    ds_read_b64_tr_b16 v[222:223], v233 offset:57664
    s_waitcnt lgkmcnt(12)
    v_mfma_f32_16x16x32_bf16 v[108:111], v[88:91], v[164:167], v[108:111]
    ds_read_b64_tr_b16 v[204:205], v233 offset:46176
    ds_read_b64_tr_b16 v[206:207], v233 offset:47456
    v_mfma_f32_16x16x32_bf16 v[128:131], v[88:91], v[184:187], v[128:131]
    ds_read_b64_tr_b16 v[224:225], v233 offset:56416
    ds_read_b64_tr_b16 v[226:227], v233 offset:57696
    v_mfma_f32_16x16x32_bf16 v[112:115], v[88:91], v[168:171], v[112:115]
    buffer_load_dwordx4 v252, s[8:11], s73 offen offset:2048 lds
    ds_read_b64_tr_b16 v[208:209], v233 offset:46208
    ds_read_b64_tr_b16 v[210:211], v233 offset:47488
    v_mfma_f32_16x16x32_bf16 v[132:135], v[88:91], v[188:191], v[132:135]
    ds_read_b64_tr_b16 v[228:229], v233 offset:56448
    ds_read_b64_tr_b16 v[230:231], v233 offset:57728
    s_barrier
    s_waitcnt lgkmcnt(8)
    v_mfma_f32_16x16x32_bf16 v[96:99], v[92:95], v[192:195], v[96:99]
    v_mfma_f32_16x16x32_bf16 v[116:119], v[92:95], v[212:215], v[116:119]
    v_mfma_f32_16x16x32_bf16 v[100:103], v[92:95], v[196:199], v[100:103]
    v_mfma_f32_16x16x32_bf16 v[120:123], v[92:95], v[216:219], v[120:123]
    buffer_load_dwordx4 v253, s[8:11], s73 offen offset:3072 lds
    v_mfma_f32_16x16x32_bf16 v[104:107], v[92:95], v[200:203], v[104:107]
    v_mfma_f32_16x16x32_bf16 v[124:127], v[92:95], v[220:223], v[124:127]
    s_waitcnt lgkmcnt(0)
    v_mfma_f32_16x16x32_bf16 v[108:111], v[92:95], v[204:207], v[108:111]
    v_mfma_f32_16x16x32_bf16 v[128:131], v[92:95], v[224:227], v[128:131]
    v_mfma_f32_16x16x32_bf16 v[112:115], v[92:95], v[208:211], v[112:115]
    v_mfma_f32_16x16x32_bf16 v[132:135], v[92:95], v[228:231], v[132:135]
    s_add_u32 m0, s75, 4096
    s_nop 0
    buffer_load_dwordx4 v254, s[8:11], s73 offen lds
    s_add_u32 s73, s73, 491520
    s_cmp_ge_u32 s73, s77
    s_cselect_b32 s46, 2457600, 0
    s_sub_u32 s73, s73, s46
    s_lshr_b32 s67, s60, 1
    s_lshl_b32 s67, s67, 10
    s_add_u32 s66, s67, 81920
    v_lshl_add_u32 v5, v1, 4, s66
    ds_write_b128 v5, v[148:151]
    s_and_b32 s68, s60, 1
    s_lshl_b32 s68, s68, 3
    s_add_u32 s67, s67, s68
    s_add_u32 s67, s67, 61440
    v_lshl_add_u32 v152, v1, 4, s67
    s_mov_b32 s90, 1069066811
    s_mov_b32 s91, 1069066811
    s_mov_b32 s92, 0x358637bd
    v_cvt_pk_bf16_f32 v166, v116, v117
    v_cvt_pk_bf16_f32 v167, v118, v119
    ds_write_b64 v152, v[166:167] offset:10240
    v_pk_mul_f32 v[160:161], v[96:97], s[90:91]
    v_pk_mul_f32 v[162:163], v[98:99], s[90:91]
    v_exp_f32 v160, v160 clamp
    v_exp_f32 v161, v161 clamp
    v_exp_f32 v162, v162 clamp
    v_exp_f32 v163, v163 clamp
    v_max_f32 v96, s92, v96
    v_max_f32 v97, s92, v97
    v_max_f32 v98, s92, v98
    v_max_f32 v99, s92, v99
    v_pk_add_f32 v[96:97], v[96:97], v[160:161]
    s_add_u32 m0, s75, 20480
    s_nop 0
    buffer_load_dwordx4 v250, s[8:11], s73 offen lds
    v_pk_add_f32 v[98:99], v[98:99], v[162:163]
    v_cvt_pk_bf16_f32 v164, v96, v97
    v_cvt_pk_bf16_f32 v165, v98, v99
    ds_write_b64 v152, v[164:165] offset:0
    v_cvt_pk_bf16_f32 v170, v120, v121
    v_cvt_pk_bf16_f32 v171, v122, v123
    ds_write_b64 v152, v[170:171] offset:12288
    v_pk_mul_f32 v[160:161], v[100:101], s[90:91]
    v_pk_mul_f32 v[162:163], v[102:103], s[90:91]
    v_exp_f32 v160, v160 clamp
    v_exp_f32 v161, v161 clamp
    v_exp_f32 v162, v162 clamp
    v_exp_f32 v163, v163 clamp
    v_max_f32 v100, s92, v100
    buffer_load_dwordx4 v251, s[8:11], s73 offen offset:1024 lds
    v_max_f32 v101, s92, v101
    v_max_f32 v102, s92, v102
    v_max_f32 v103, s92, v103
    v_pk_add_f32 v[100:101], v[100:101], v[160:161]
    v_pk_add_f32 v[102:103], v[102:103], v[162:163]
    v_cvt_pk_bf16_f32 v168, v100, v101
    v_cvt_pk_bf16_f32 v169, v102, v103
    ds_write_b64 v152, v[168:169] offset:2048
    v_cvt_pk_bf16_f32 v166, v124, v125
    v_cvt_pk_bf16_f32 v167, v126, v127
    ds_write_b64 v152, v[166:167] offset:14336
    v_pk_mul_f32 v[160:161], v[104:105], s[90:91]
    v_pk_mul_f32 v[162:163], v[106:107], s[90:91]
    v_exp_f32 v160, v160 clamp
    v_exp_f32 v161, v161 clamp
    v_exp_f32 v162, v162 clamp
    buffer_load_dwordx4 v252, s[8:11], s73 offen offset:2048 lds
    v_exp_f32 v163, v163 clamp
    v_max_f32 v104, s92, v104
    v_max_f32 v105, s92, v105
    v_max_f32 v106, s92, v106
    v_max_f32 v107, s92, v107
    v_pk_add_f32 v[104:105], v[104:105], v[160:161]
    v_pk_add_f32 v[106:107], v[106:107], v[162:163]
    v_cvt_pk_bf16_f32 v164, v104, v105
    v_cvt_pk_bf16_f32 v165, v106, v107
    ds_write_b64 v152, v[164:165] offset:4096
    v_cvt_pk_bf16_f32 v170, v128, v129
    v_cvt_pk_bf16_f32 v171, v130, v131
    ds_write_b64 v152, v[170:171] offset:16384
    v_pk_mul_f32 v[160:161], v[108:109], s[90:91]
    v_pk_mul_f32 v[162:163], v[110:111], s[90:91]
    v_exp_f32 v160, v160 clamp
    buffer_load_dwordx4 v253, s[8:11], s73 offen offset:3072 lds
    v_exp_f32 v161, v161 clamp
    v_exp_f32 v162, v162 clamp
    v_exp_f32 v163, v163 clamp
    v_max_f32 v108, s92, v108
    v_max_f32 v109, s92, v109
    v_max_f32 v110, s92, v110
    v_max_f32 v111, s92, v111
    v_pk_add_f32 v[108:109], v[108:109], v[160:161]
    v_pk_add_f32 v[110:111], v[110:111], v[162:163]
    v_cvt_pk_bf16_f32 v168, v108, v109
    v_cvt_pk_bf16_f32 v169, v110, v111
    ds_write_b64 v152, v[168:169] offset:6144
    v_cvt_pk_bf16_f32 v166, v132, v133
    v_cvt_pk_bf16_f32 v167, v134, v135
    ds_write_b64 v152, v[166:167] offset:18432
    s_add_u32 m0, s75, 24576
    s_nop 0
    buffer_load_dwordx4 v254, s[8:11], s73 offen lds
    s_add_u32 s73, s73, 491520
    s_cmp_ge_u32 s73, s77
    s_cselect_b32 s46, 2457600, 0
    s_sub_u32 s73, s73, s46
    v_pk_mul_f32 v[160:161], v[112:113], s[90:91]
    v_pk_mul_f32 v[162:163], v[114:115], s[90:91]
    v_exp_f32 v160, v160 clamp
    v_exp_f32 v161, v161 clamp
    v_exp_f32 v162, v162 clamp
    v_exp_f32 v163, v163 clamp
    v_max_f32 v112, s92, v112
    v_max_f32 v113, s92, v113
    v_max_f32 v114, s92, v114
    v_max_f32 v115, s92, v115
    v_pk_add_f32 v[112:113], v[112:113], v[160:161]
    v_pk_add_f32 v[114:115], v[114:115], v[162:163]
    v_cvt_pk_bf16_f32 v164, v112, v113
    v_cvt_pk_bf16_f32 v165, v114, v115
    s_add_u32 m0, s75, 40960
    s_nop 0
    buffer_load_dwordx4 v250, s[8:11], s73 offen lds
    ds_write_b64 v152, v[164:165] offset:8192
    s_add_u32 s20, s58, 1048576
    s_addc_u32 s21, s59, 0
    s_mov_b32 s22, 4718592
    s_mov_b32 s23, 0x20000
    s_lshl_b32 s70, s62, 5
    s_add_u32 s70, s70, s61
    s_mul_i32 s70, s70, 18432
    v_lshlrev_b32 v2, 4, v1
    s_mul_i32 s67, s60, 3
    s_mov_b32 s92, 3678999104
    s_mov_b32 s93, 2311240
    s_lshr_b64 s[92:93], s[92:93], s67
    s_mov_b32 s90, 443064840
    s_mov_b32 s91, 2995911
    s_lshr_b64 s[90:91], s[90:91], s67
    s_and_b32 s68, s92, 7
    s_and_b32 s69, s90, 7
    s_lshl_b32 s68, s68, 11
    s_lshl_b32 s69, s69, 11
    s_add_u32 s68, s68, 61440
    s_add_u32 s69, s69, 71680
    v_add_u32 v172, s68, v2
    v_add_u32 v173, s69, v2
    s_lshr_b64 s[92:93], s[92:93], 12
    s_lshr_b64 s[90:91], s[90:91], 12
    s_and_b32 s68, s92, 7
    s_and_b32 s69, s90, 7
    s_lshl_b32 s68, s68, 11
    s_lshl_b32 s69, s69, 11
    s_add_u32 s68, s68, 61440
    s_add_u32 s69, s69, 71680
    v_add_u32 v174, s68, v2
    v_add_u32 v175, s69, v2
    s_lshr_b64 s[92:93], s[92:93], 12
    s_lshr_b64 s[90:91], s[90:91], 12
    s_and_b32 s68, s92, 7
    s_and_b32 s69, s90, 7
    s_lshl_b32 s68, s68, 11
    s_lshl_b32 s69, s69, 11
    s_add_u32 s68, s68, 61440
    s_add_u32 s69, s69, 71680
    v_add_u32 v176, s68, v2
    v_add_u32 v177, s69, v2
    s_lshr_b64 s[92:93], s[92:93], 12
    s_lshr_b64 s[90:91], s[90:91], 12
    s_and_b32 s68, s92, 7
    s_and_b32 s69, s90, 7
    s_lshl_b32 s68, s68, 11
    s_lshl_b32 s69, s69, 11
    s_add_u32 s68, s68, 61440
    s_add_u32 s69, s69, 71680
    v_add_u32 v178, s68, v2
    v_add_u32 v179, s69, v2
    s_lshr_b64 s[92:93], s[92:93], 12
    s_lshr_b64 s[90:91], s[90:91], 12
    s_and_b32 s68, s92, 7
    s_and_b32 s69, s90, 7
    s_lshl_b32 s68, s68, 11
    s_lshl_b32 s69, s69, 11
    s_add_u32 s68, s68, 61440
    s_add_u32 s69, s69, 71680
    v_add_u32 v180, s68, v2
    v_add_u32 v181, s69, v2
    s_waitcnt lgkmcnt(0)
    s_barrier
    ds_read_b128 v[184:187], v172
    ds_read_b128 v[188:191], v173
    ds_read_b128 v[192:195], v172 offset:1024
    ds_read_b128 v[196:199], v173 offset:1024
    ds_read_b128 v[200:203], v174
    ds_read_b128 v[204:207], v175
    ds_read_b128 v[208:211], v174 offset:1024
    ds_read_b128 v[212:215], v175 offset:1024
    ds_read_b128 v[216:219], v176
    ds_read_b128 v[220:223], v177
    ds_read_b128 v[224:227], v176 offset:1024
    ds_read_b128 v[228:231], v177 offset:1024
    s_lshl_b32 s66, s60, 10
    s_add_u32 s66, s66, s70
    s_waitcnt lgkmcnt(8)
    v_mfma_f32_16x16x32_bf16 v[96:99], v[184:187], v[188:191], 0
    v_mfma_f32_16x16x32_bf16 v[96:99], v[192:195], v[196:199], v[96:99]
    ds_read_b128 v[184:187], v178
    ds_read_b128 v[188:191], v179
    ds_read_b128 v[192:195], v178 offset:1024
    ds_read_b128 v[196:199], v179 offset:1024
    s_waitcnt lgkmcnt(8)
    v_mfma_f32_16x16x32_bf16 v[100:103], v[200:203], v[204:207], 0
    v_mfma_f32_16x16x32_bf16 v[100:103], v[208:211], v[212:215], v[100:103]
    ds_read_b128 v[200:203], v180
    ds_read_b128 v[204:207], v181
    ds_read_b128 v[208:211], v180 offset:1024
    ds_read_b128 v[212:215], v181 offset:1024
    s_waitcnt lgkmcnt(8)
    v_mfma_f32_16x16x32_bf16 v[104:107], v[216:219], v[220:223], 0
    v_mfma_f32_16x16x32_bf16 v[104:107], v[224:227], v[228:231], v[104:107]
    s_waitcnt lgkmcnt(4)
    v_mfma_f32_16x16x32_bf16 v[108:111], v[184:187], v[188:191], 0
    v_mfma_f32_16x16x32_bf16 v[108:111], v[192:195], v[196:199], v[108:111]
    s_waitcnt lgkmcnt(0)
    v_mfma_f32_16x16x32_bf16 v[112:115], v[200:203], v[204:207], 0
    v_mfma_f32_16x16x32_bf16 v[112:115], v[208:211], v[212:215], v[112:115]
    buffer_store_dwordx4 v[96:99], v2, s[20:23], s66 offen sc1
    s_add_u32 s66, s66, 4096
    buffer_store_dwordx4 v[100:103], v2, s[20:23], s66 offen sc1
    s_add_u32 s66, s66, 4096
    buffer_store_dwordx4 v[104:107], v2, s[20:23], s66 offen sc1
    s_add_u32 s66, s66, 4096
    buffer_store_dwordx4 v[108:111], v2, s[20:23], s66 offen sc1
    s_add_u32 s66, s66, 4096
    s_cmp_lt_u32 s60, 2
    s_cselect_b32 s66, s66, 2146435072
    buffer_store_dwordx4 v[112:115], v2, s[20:23], s66 offen sc1
    s_waitcnt vmcnt(16)
    s_barrier
    ds_read_b64_tr_b16 v[152:153], v234 offset:0
    ds_read_b64_tr_b16 v[154:155], v234 offset:1280
    ds_read_b64_tr_b16 v[156:157], v234 offset:32
    ds_read_b64_tr_b16 v[158:159], v234 offset:1312
    ds_read_b64_tr_b16 v[160:161], v234 offset:64
    ds_read_b64_tr_b16 v[162:163], v234 offset:1344
    ds_read_b64_tr_b16 v[164:165], v234 offset:96
    ds_read_b64_tr_b16 v[166:167], v234 offset:1376
    ds_read_b64_tr_b16 v[168:169], v234 offset:128
    ds_read_b64_tr_b16 v[170:171], v234 offset:1408
    s_mul_i32 s67, s65, 26
    s_lshr_b32 s67, s67, 8
    s_mul_i32 s68, s67, 10
    s_sub_u32 s94, s65, s68
    s_mul_i32 s68, s64, 3
    s_cmp_eq_u32 s64, 7
    s_cselect_b32 s69, 1, 0
    s_sub_u32 s68, s68, s69
    s_add_u32 s95, s68, s67
    s_cmp_ge_u32 s64, 6
    s_cselect_b32 s69, 2, 3
    s_cmp_lt_u32 s67, s69
    s_cselect_b32 s96, 1, 0
    s_lshr_b32 s66, s64, 2
    s_lshl_b32 s66, s66, 2
    s_and_b32 s67, s65, 3
    s_add_u32 s97, s66, s67
    s_and_b32 s66, s64, 3
    s_lshr_b32 s67, s65, 2
    s_mul_i32 s68, s66, 7
    s_add_u32 s98, s68, s67
    s_cmp_eq_u32 s66, 3
    s_cselect_b32 s68, 6, 7
    s_cmp_lt_u32 s67, s68
    s_cselect_b32 s99, 1, 0
    s_waitcnt lgkmcnt(4)
    v_mfma_f32_16x16x32_bf16 v[116:119], v[152:155], v[16:19], v[136:139]
    ds_read_b64_tr_b16 v[172:173], v234 offset:5120
    ds_read_b64_tr_b16 v[174:175], v234 offset:6400
    v_mfma_f32_16x16x32_bf16 v[120:123], v[156:159], v[16:19], v[136:139]
    ds_read_b64_tr_b16 v[176:177], v234 offset:5152
    ds_read_b64_tr_b16 v[178:179], v234 offset:6432
    v_mfma_f32_16x16x32_bf16 v[124:127], v[160:163], v[16:19], v[136:139]
    ds_read_b64_tr_b16 v[180:181], v234 offset:5184
    ds_read_b64_tr_b16 v[182:183], v234 offset:6464
    s_waitcnt lgkmcnt(6)
    v_mfma_f32_16x16x32_bf16 v[128:131], v[164:167], v[16:19], v[136:139]
    ds_read_b64_tr_b16 v[184:185], v234 offset:5216
    ds_read_b64_tr_b16 v[186:187], v234 offset:6496
    v_mfma_f32_16x16x32_bf16 v[132:135], v[168:171], v[16:19], v[136:139]
    ds_read_b64_tr_b16 v[188:189], v234 offset:5248
    ds_read_b64_tr_b16 v[190:191], v234 offset:6528
    s_waitcnt lgkmcnt(4)
    v_mfma_f32_16x16x32_bf16 v[116:119], v[172:175], v[20:23], v[116:119]
    buffer_load_dwordx4 v251, s[8:11], s73 offen offset:1024 lds
    ds_read_b64_tr_b16 v[152:153], v234 offset:10240
    ds_read_b64_tr_b16 v[154:155], v234 offset:11520
    v_mfma_f32_16x16x32_bf16 v[120:123], v[176:179], v[20:23], v[120:123]
    ds_read_b64_tr_b16 v[156:157], v234 offset:10272
    ds_read_b64_tr_b16 v[158:159], v234 offset:11552
    v_mfma_f32_16x16x32_bf16 v[124:127], v[180:183], v[20:23], v[124:127]
    ds_read_b64_tr_b16 v[160:161], v234 offset:10304
    ds_read_b64_tr_b16 v[162:163], v234 offset:11584
    s_waitcnt lgkmcnt(6)
    v_mfma_f32_16x16x32_bf16 v[128:131], v[184:187], v[20:23], v[128:131]
    ds_read_b64_tr_b16 v[164:165], v234 offset:10336
    ds_read_b64_tr_b16 v[166:167], v234 offset:11616
    v_mfma_f32_16x16x32_bf16 v[132:135], v[188:191], v[20:23], v[132:135]
    ds_read_b64_tr_b16 v[168:169], v234 offset:10368
    ds_read_b64_tr_b16 v[170:171], v234 offset:11648
    s_waitcnt lgkmcnt(4)
    v_mfma_f32_16x16x32_bf16 v[116:119], v[152:155], v[24:27], v[116:119]
    buffer_load_dwordx4 v252, s[8:11], s73 offen offset:2048 lds
    ds_read_b64_tr_b16 v[172:173], v234 offset:15360
    ds_read_b64_tr_b16 v[174:175], v234 offset:16640
    v_mfma_f32_16x16x32_bf16 v[120:123], v[156:159], v[24:27], v[120:123]
    ds_read_b64_tr_b16 v[176:177], v234 offset:15392
    ds_read_b64_tr_b16 v[178:179], v234 offset:16672
    v_mfma_f32_16x16x32_bf16 v[124:127], v[160:163], v[24:27], v[124:127]
    ds_read_b64_tr_b16 v[180:181], v234 offset:15424
    ds_read_b64_tr_b16 v[182:183], v234 offset:16704
    s_waitcnt lgkmcnt(6)
    v_mfma_f32_16x16x32_bf16 v[128:131], v[164:167], v[24:27], v[128:131]
    ds_read_b64_tr_b16 v[184:185], v234 offset:15456
    ds_read_b64_tr_b16 v[186:187], v234 offset:16736
    v_mfma_f32_16x16x32_bf16 v[132:135], v[168:171], v[24:27], v[132:135]
    ds_read_b64_tr_b16 v[188:189], v234 offset:15488
    ds_read_b64_tr_b16 v[190:191], v234 offset:16768
    s_waitcnt lgkmcnt(4)
    v_mfma_f32_16x16x32_bf16 v[116:119], v[172:175], v[28:31], v[116:119]
    buffer_load_dwordx4 v253, s[8:11], s73 offen offset:3072 lds
    ds_read_b64_tr_b16 v[152:153], v234 offset:20480
    ds_read_b64_tr_b16 v[154:155], v234 offset:21760
    v_mfma_f32_16x16x32_bf16 v[120:123], v[176:179], v[28:31], v[120:123]
    ds_read_b64_tr_b16 v[156:157], v234 offset:20512
    ds_read_b64_tr_b16 v[158:159], v234 offset:21792
    v_mfma_f32_16x16x32_bf16 v[124:127], v[180:183], v[28:31], v[124:127]
    ds_read_b64_tr_b16 v[160:161], v234 offset:20544
    ds_read_b64_tr_b16 v[162:163], v234 offset:21824
    s_waitcnt lgkmcnt(6)
    v_mfma_f32_16x16x32_bf16 v[128:131], v[184:187], v[28:31], v[128:131]
    ds_read_b64_tr_b16 v[164:165], v234 offset:20576
    ds_read_b64_tr_b16 v[166:167], v234 offset:21856
    v_mfma_f32_16x16x32_bf16 v[132:135], v[188:191], v[28:31], v[132:135]
    ds_read_b64_tr_b16 v[168:169], v234 offset:20608
    ds_read_b64_tr_b16 v[170:171], v234 offset:21888
    s_waitcnt vmcnt(3)
    s_barrier
    v_accvgpr_read_b32 v2, a253
    s_nop 0
    v_readfirstlane_b32 s66, v2
    s_nop 4
    s_cmp_ge_u32 s66, 32
    s_cbranch_scc1 L_zok_3
    s_cmp_lg_u32 s60, 0
    s_cbranch_scc1 L_pskip_4
    v_mov_b32 v2, 0
    s_mov_b64 exec, 1
    s_mov_b32 s71, 0
L_poll_5:
    buffer_load_dword v3, v2, s[32:35], 0 offen sc1
    s_add_u32 s71, s71, 1
    s_waitcnt vmcnt(0)
    v_cmp_gt_u32 vcc, 32, v3
    s_nop 4
    s_cbranch_vccz L_got_6
    s_cmp_lt_u32 s71, 0x40000
    s_cbranch_scc1 L_poll_5
L_got_6:
    s_mov_b64 exec, -1
L_pskip_4:
L_zok_3:
    s_add_u32 s66, s62, 0
    s_cmp_lg_u32 s60, 0
    s_cbranch_scc1 L_sig_7
    s_lshl_b32 s71, s66, 7
    v_mov_b32 v2, s71
    v_mov_b32 v3, 1
    s_mov_b64 exec, 1
    buffer_atomic_add v3, v2, s[24:27], 0 offen sc1
    s_mov_b64 exec, -1
L_sig_7:
    s_waitcnt lgkmcnt(4)
    v_mfma_f32_16x16x32_bf16 v[116:119], v[152:155], v[32:35], v[116:119]
    s_add_u32 m0, s75, 45056
    s_nop 0
    buffer_load_dwordx4 v254, s[8:11], s73 offen lds
    ds_read_b64_tr_b16 v[172:173], v234 offset:25600
    ds_read_b64_tr_b16 v[174:175], v234 offset:26880
    v_mfma_f32_16x16x32_bf16 v[120:123], v[156:159], v[32:35], v[120:123]
    ds_read_b64_tr_b16 v[176:177], v234 offset:25632
    ds_read_b64_tr_b16 v[178:179], v234 offset:26912
    v_mfma_f32_16x16x32_bf16 v[124:127], v[160:163], v[32:35], v[124:127]
    ds_read_b64_tr_b16 v[180:181], v234 offset:25664
    ds_read_b64_tr_b16 v[182:183], v234 offset:26944
    s_waitcnt lgkmcnt(6)
    v_mfma_f32_16x16x32_bf16 v[128:131], v[164:167], v[32:35], v[128:131]
    ds_read_b64_tr_b16 v[184:185], v234 offset:25696
    ds_read_b64_tr_b16 v[186:187], v234 offset:26976
    v_mfma_f32_16x16x32_bf16 v[132:135], v[168:171], v[32:35], v[132:135]
    ds_read_b64_tr_b16 v[188:189], v234 offset:25728
    ds_read_b64_tr_b16 v[190:191], v234 offset:27008
    s_waitcnt lgkmcnt(4)
    v_mfma_f32_16x16x32_bf16 v[116:119], v[172:175], v[36:39], v[116:119]
    ds_read_b64_tr_b16 v[152:153], v234 offset:30720
    ds_read_b64_tr_b16 v[154:155], v234 offset:32000
    v_mfma_f32_16x16x32_bf16 v[120:123], v[176:179], v[36:39], v[120:123]
    ds_read_b64_tr_b16 v[156:157], v234 offset:30752
    ds_read_b64_tr_b16 v[158:159], v234 offset:32032
    v_mfma_f32_16x16x32_bf16 v[124:127], v[180:183], v[36:39], v[124:127]
    ds_read_b64_tr_b16 v[160:161], v234 offset:30784
    ds_read_b64_tr_b16 v[162:163], v234 offset:32064
    s_waitcnt lgkmcnt(6)
    v_mfma_f32_16x16x32_bf16 v[128:131], v[184:187], v[36:39], v[128:131]
    ds_read_b64_tr_b16 v[164:165], v234 offset:30816
    ds_read_b64_tr_b16 v[166:167], v234 offset:32096
    v_mfma_f32_16x16x32_bf16 v[132:135], v[188:191], v[36:39], v[132:135]
    ds_read_b64_tr_b16 v[168:169], v234 offset:30848
    ds_read_b64_tr_b16 v[170:171], v234 offset:32128
    s_waitcnt lgkmcnt(4)
    v_mfma_f32_16x16x32_bf16 v[116:119], v[152:155], v[40:43], v[116:119]
    ds_read_b64_tr_b16 v[172:173], v234 offset:35840
    ds_read_b64_tr_b16 v[174:175], v234 offset:37120
    v_mfma_f32_16x16x32_bf16 v[120:123], v[156:159], v[40:43], v[120:123]
    ds_read_b64_tr_b16 v[176:177], v234 offset:35872
    ds_read_b64_tr_b16 v[178:179], v234 offset:37152
    v_mfma_f32_16x16x32_bf16 v[124:127], v[160:163], v[40:43], v[124:127]
    ds_read_b64_tr_b16 v[180:181], v234 offset:35904
    ds_read_b64_tr_b16 v[182:183], v234 offset:37184
    s_waitcnt lgkmcnt(6)
    v_mfma_f32_16x16x32_bf16 v[128:131], v[164:167], v[40:43], v[128:131]
    ds_read_b64_tr_b16 v[184:185], v234 offset:35936
    ds_read_b64_tr_b16 v[186:187], v234 offset:37216
    v_mfma_f32_16x16x32_bf16 v[132:135], v[168:171], v[40:43], v[132:135]
    ds_read_b64_tr_b16 v[188:189], v234 offset:35968
    ds_read_b64_tr_b16 v[190:191], v234 offset:37248
    s_waitcnt vmcnt(15) lgkmcnt(0)
    s_barrier
    s_waitcnt lgkmcnt(4)
    v_mfma_f32_16x16x32_bf16 v[116:119], v[172:175], v[44:47], v[116:119]
    v_lshrrev_b32 v2, 3, v1
    v_bfe_u32 v3, v1, 4, 2
    v_lshlrev_b32 v3, 1, v3
    v_and_b32 v4, 7, v1
    v_xor_b32 v3, v3, v4
    v_lshlrev_b32 v3, 4, v3
    v_mul_u32_u24 v2, 1280, v2
    v_add_u32 v252, v2, v3
    v_add_u32 v253, 9216, v252
    v_add_u32 v254, 18432, v252
    v_add_u32 v255, 27648, v252
    s_mov_b32 s12, s44
    s_mov_b32 s13, s45
    s_mov_b32 s14, 819200
    s_mov_b32 s15, 0x20000
    s_mul_i32 s46, s60, 204800
    s_lshl_b32 s47, s94, 7
    s_add_u32 s46, s46, s47
    s_cmp_eq_u32 s96, 0
    s_cselect_b32 s46, 2146435072, s46
    s_add_u32 s47, s60, 4
    s_mul_i32 s47, s47, 20480
    s_add_u32 m0, s47, 0
    s_nop 0
    buffer_load_dwordx4 v252, s[12:15], s46 offen lds
    ds_read_b64_tr_b16 v[152:153], v232 offset:0
    ds_read_b64_tr_b16 v[154:155], v232 offset:1280
    v_mfma_f32_16x16x32_bf16 v[120:123], v[176:179], v[44:47], v[120:123]
    ds_read_b64_tr_b16 v[156:157], v232 offset:32
    ds_read_b64_tr_b16 v[158:159], v232 offset:1312
    v_mfma_f32_16x16x32_bf16 v[124:127], v[180:183], v[44:47], v[124:127]
    ds_read_b64_tr_b16 v[160:161], v232 offset:64
    ds_read_b64_tr_b16 v[162:163], v232 offset:1344
    s_waitcnt lgkmcnt(6)
    v_mfma_f32_16x16x32_bf16 v[128:131], v[184:187], v[44:47], v[128:131]
    buffer_load_dwordx4 v253, s[12:15], s46 offen offset:1024 lds
    ds_read_b64_tr_b16 v[164:165], v232 offset:96
    ds_read_b64_tr_b16 v[166:167], v232 offset:1376
    v_mfma_f32_16x16x32_bf16 v[132:135], v[188:191], v[44:47], v[132:135]
    ds_read_b64_tr_b16 v[168:169], v232 offset:128
    ds_read_b64_tr_b16 v[170:171], v232 offset:1408
    s_waitcnt lgkmcnt(4)
    v_mfma_f32_16x16x32_bf16 v[116:119], v[152:155], v[48:51], v[116:119]
    ds_read_b64_tr_b16 v[172:173], v232 offset:5120
    ds_read_b64_tr_b16 v[174:175], v232 offset:6400
    v_mfma_f32_16x16x32_bf16 v[120:123], v[156:159], v[48:51], v[120:123]
    ds_read_b64_tr_b16 v[176:177], v232 offset:5152
    ds_read_b64_tr_b16 v[178:179], v232 offset:6432
    v_mfma_f32_16x16x32_bf16 v[124:127], v[160:163], v[48:51], v[124:127]
    buffer_load_dwordx4 v254, s[12:15], s46 offen offset:2048 lds
    ds_read_b64_tr_b16 v[180:181], v232 offset:5184
    ds_read_b64_tr_b16 v[182:183], v232 offset:6464
    s_waitcnt lgkmcnt(6)
    v_mfma_f32_16x16x32_bf16 v[128:131], v[164:167], v[48:51], v[128:131]
    ds_read_b64_tr_b16 v[184:185], v232 offset:5216
    ds_read_b64_tr_b16 v[186:187], v232 offset:6496
    v_mfma_f32_16x16x32_bf16 v[132:135], v[168:171], v[48:51], v[132:135]
    ds_read_b64_tr_b16 v[188:189], v232 offset:5248
    ds_read_b64_tr_b16 v[190:191], v232 offset:6528
    s_waitcnt lgkmcnt(4)
    v_mfma_f32_16x16x32_bf16 v[116:119], v[172:175], v[52:55], v[116:119]
    buffer_load_dwordx4 v255, s[12:15], s46 offen offset:3072 lds
    s_add_u32 s46, s46, 40960
    ds_read_b64_tr_b16 v[152:153], v232 offset:10240
    ds_read_b64_tr_b16 v[154:155], v232 offset:11520
    v_mfma_f32_16x16x32_bf16 v[120:123], v[176:179], v[52:55], v[120:123]
    ds_read_b64_tr_b16 v[156:157], v232 offset:10272
    ds_read_b64_tr_b16 v[158:159], v232 offset:11552
    v_mfma_f32_16x16x32_bf16 v[124:127], v[180:183], v[52:55], v[124:127]
    ds_read_b64_tr_b16 v[160:161], v232 offset:10304
    ds_read_b64_tr_b16 v[162:163], v232 offset:11584
    s_waitcnt lgkmcnt(6)
    v_mfma_f32_16x16x32_bf16 v[128:131], v[184:187], v[52:55], v[128:131]
    s_add_u32 m0, s47, 4096
    s_nop 0
    buffer_load_dwordx4 v252, s[12:15], s46 offen lds
    ds_read_b64_tr_b16 v[164:165], v232 offset:10336
    ds_read_b64_tr_b16 v[166:167], v232 offset:11616
    v_mfma_f32_16x16x32_bf16 v[132:135], v[188:191], v[52:55], v[132:135]
    ds_read_b64_tr_b16 v[168:169], v232 offset:10368
    ds_read_b64_tr_b16 v[170:171], v232 offset:11648
    s_waitcnt lgkmcnt(4)
    v_mfma_f32_16x16x32_bf16 v[116:119], v[152:155], v[56:59], v[116:119]
    ds_read_b64_tr_b16 v[172:173], v232 offset:15360
    ds_read_b64_tr_b16 v[174:175], v232 offset:16640
    v_mfma_f32_16x16x32_bf16 v[120:123], v[156:159], v[56:59], v[120:123]
    buffer_load_dwordx4 v253, s[12:15], s46 offen offset:1024 lds
    ds_read_b64_tr_b16 v[176:177], v232 offset:15392
    ds_read_b64_tr_b16 v[178:179], v232 offset:16672
    v_mfma_f32_16x16x32_bf16 v[124:127], v[160:163], v[56:59], v[124:127]
    ds_read_b64_tr_b16 v[180:181], v232 offset:15424
    ds_read_b64_tr_b16 v[182:183], v232 offset:16704
    s_waitcnt lgkmcnt(6)
    v_mfma_f32_16x16x32_bf16 v[128:131], v[164:167], v[56:59], v[128:131]
    ds_read_b64_tr_b16 v[184:185], v232 offset:15456
    ds_read_b64_tr_b16 v[186:187], v232 offset:16736
    v_mfma_f32_16x16x32_bf16 v[132:135], v[168:171], v[56:59], v[132:135]
    ds_read_b64_tr_b16 v[188:189], v232 offset:15488
    ds_read_b64_tr_b16 v[190:191], v232 offset:16768
    s_waitcnt vmcnt(16)
    s_barrier
    s_waitcnt lgkmcnt(4)
    v_mfma_f32_16x16x32_bf16 v[116:119], v[172:175], v[60:63], v[116:119]
    buffer_load_dwordx4 v254, s[12:15], s46 offen offset:2048 lds
    ds_read_b64_tr_b16 v[152:153], v232 offset:20480
    ds_read_b64_tr_b16 v[154:155], v232 offset:21760
    v_mfma_f32_16x16x32_bf16 v[120:123], v[176:179], v[60:63], v[120:123]
    ds_read_b64_tr_b16 v[156:157], v232 offset:20512
    ds_read_b64_tr_b16 v[158:159], v232 offset:21792
    v_mfma_f32_16x16x32_bf16 v[124:127], v[180:183], v[60:63], v[124:127]
    ds_read_b64_tr_b16 v[160:161], v232 offset:20544
    ds_read_b64_tr_b16 v[162:163], v232 offset:21824
    s_waitcnt lgkmcnt(6)
    v_mfma_f32_16x16x32_bf16 v[128:131], v[184:187], v[60:63], v[128:131]
    buffer_load_dwordx4 v255, s[12:15], s46 offen offset:3072 lds
    s_add_u32 s46, s46, 40960
    ds_read_b64_tr_b16 v[164:165], v232 offset:20576
    ds_read_b64_tr_b16 v[166:167], v232 offset:21856
    v_mfma_f32_16x16x32_bf16 v[132:135], v[188:191], v[60:63], v[132:135]
    ds_read_b64_tr_b16 v[168:169], v232 offset:20608
    ds_read_b64_tr_b16 v[170:171], v232 offset:21888
    s_waitcnt lgkmcnt(4)
    v_mfma_f32_16x16x32_bf16 v[116:119], v[152:155], v[64:67], v[116:119]
    ds_read_b64_tr_b16 v[172:173], v232 offset:25600
    ds_read_b64_tr_b16 v[174:175], v232 offset:26880
    v_mfma_f32_16x16x32_bf16 v[120:123], v[156:159], v[64:67], v[120:123]
    s_add_u32 m0, s47, 8192
    s_nop 0
    buffer_load_dwordx4 v252, s[12:15], s46 offen lds
    ds_read_b64_tr_b16 v[176:177], v232 offset:25632
    ds_read_b64_tr_b16 v[178:179], v232 offset:26912
    v_mfma_f32_16x16x32_bf16 v[124:127], v[160:163], v[64:67], v[124:127]
    ds_read_b64_tr_b16 v[180:181], v232 offset:25664
    ds_read_b64_tr_b16 v[182:183], v232 offset:26944
    s_waitcnt lgkmcnt(6)
    v_mfma_f32_16x16x32_bf16 v[128:131], v[164:167], v[64:67], v[128:131]
    ds_read_b64_tr_b16 v[184:185], v232 offset:25696
    ds_read_b64_tr_b16 v[186:187], v232 offset:26976
    v_mfma_f32_16x16x32_bf16 v[132:135], v[168:171], v[64:67], v[132:135]
    buffer_load_dwordx4 v253, s[12:15], s46 offen offset:1024 lds
    ds_read_b64_tr_b16 v[188:189], v232 offset:25728
    ds_read_b64_tr_b16 v[190:191], v232 offset:27008
    s_waitcnt lgkmcnt(4)
    v_mfma_f32_16x16x32_bf16 v[116:119], v[172:175], v[68:71], v[116:119]
    ds_read_b64_tr_b16 v[152:153], v232 offset:30720
    ds_read_b64_tr_b16 v[154:155], v232 offset:32000
    v_mfma_f32_16x16x32_bf16 v[120:123], v[176:179], v[68:71], v[120:123]
    ds_read_b64_tr_b16 v[156:157], v232 offset:30752
    ds_read_b64_tr_b16 v[158:159], v232 offset:32032
    v_mfma_f32_16x16x32_bf16 v[124:127], v[180:183], v[68:71], v[124:127]
    buffer_load_dwordx4 v254, s[12:15], s46 offen offset:2048 lds
    ds_read_b64_tr_b16 v[160:161], v232 offset:30784
    ds_read_b64_tr_b16 v[162:163], v232 offset:32064
    s_waitcnt lgkmcnt(6)
    v_mfma_f32_16x16x32_bf16 v[128:131], v[184:187], v[68:71], v[128:131]
    ds_read_b64_tr_b16 v[164:165], v232 offset:30816
    ds_read_b64_tr_b16 v[166:167], v232 offset:32096
    v_mfma_f32_16x16x32_bf16 v[132:135], v[188:191], v[68:71], v[132:135]
    ds_read_b64_tr_b16 v[168:169], v232 offset:30848
    ds_read_b64_tr_b16 v[170:171], v232 offset:32128
    s_waitcnt lgkmcnt(4)
    v_mfma_f32_16x16x32_bf16 v[116:119], v[152:155], v[72:75], v[116:119]
    buffer_load_dwordx4 v255, s[12:15], s46 offen offset:3072 lds
    s_add_u32 s46, s46, 40960
    ds_read_b64_tr_b16 v[172:173], v232 offset:35840
    ds_read_b64_tr_b16 v[174:175], v232 offset:37120
    v_mfma_f32_16x16x32_bf16 v[120:123], v[156:159], v[72:75], v[120:123]
    ds_read_b64_tr_b16 v[176:177], v232 offset:35872
    ds_read_b64_tr_b16 v[178:179], v232 offset:37152
    v_mfma_f32_16x16x32_bf16 v[124:127], v[160:163], v[72:75], v[124:127]
    ds_read_b64_tr_b16 v[180:181], v232 offset:35904
    ds_read_b64_tr_b16 v[182:183], v232 offset:37184
    s_waitcnt lgkmcnt(6)
    v_mfma_f32_16x16x32_bf16 v[128:131], v[164:167], v[72:75], v[128:131]
    s_add_u32 m0, s47, 12288
    s_nop 0
    buffer_load_dwordx4 v252, s[12:15], s46 offen lds
    ds_read_b64_tr_b16 v[184:185], v232 offset:35936
    ds_read_b64_tr_b16 v[186:187], v232 offset:37216
    v_mfma_f32_16x16x32_bf16 v[132:135], v[168:171], v[72:75], v[132:135]
    ds_read_b64_tr_b16 v[188:189], v232 offset:35968
    ds_read_b64_tr_b16 v[190:191], v232 offset:37248
    s_waitcnt vmcnt(13)
    s_barrier
    s_waitcnt lgkmcnt(4)
    v_mfma_f32_16x16x32_bf16 v[116:119], v[172:175], v[76:79], v[116:119]
    ds_read_b64_tr_b16 v[152:153], v232 offset:40960
    ds_read_b64_tr_b16 v[154:155], v232 offset:42240
    v_mfma_f32_16x16x32_bf16 v[120:123], v[176:179], v[76:79], v[120:123]
    buffer_load_dwordx4 v253, s[12:15], s46 offen offset:1024 lds
    ds_read_b64_tr_b16 v[156:157], v232 offset:40992
    ds_read_b64_tr_b16 v[158:159], v232 offset:42272
    v_mfma_f32_16x16x32_bf16 v[124:127], v[180:183], v[76:79], v[124:127]
    ds_read_b64_tr_b16 v[160:161], v232 offset:41024
    ds_read_b64_tr_b16 v[162:163], v232 offset:42304
    s_waitcnt lgkmcnt(6)
    v_mfma_f32_16x16x32_bf16 v[128:131], v[184:187], v[76:79], v[128:131]
    ds_read_b64_tr_b16 v[164:165], v232 offset:41056
    ds_read_b64_tr_b16 v[166:167], v232 offset:42336
    v_mfma_f32_16x16x32_bf16 v[132:135], v[188:191], v[76:79], v[132:135]
    ds_read_b64_tr_b16 v[168:169], v232 offset:41088
    ds_read_b64_tr_b16 v[170:171], v232 offset:42368
    s_waitcnt lgkmcnt(4)
    v_mfma_f32_16x16x32_bf16 v[116:119], v[152:155], v[80:83], v[116:119]
    buffer_load_dwordx4 v254, s[12:15], s46 offen offset:2048 lds
    ds_read_b64_tr_b16 v[172:173], v232 offset:46080
    ds_read_b64_tr_b16 v[174:175], v232 offset:47360
    v_mfma_f32_16x16x32_bf16 v[120:123], v[156:159], v[80:83], v[120:123]
    ds_read_b64_tr_b16 v[176:177], v232 offset:46112
    ds_read_b64_tr_b16 v[178:179], v232 offset:47392
    v_mfma_f32_16x16x32_bf16 v[124:127], v[160:163], v[80:83], v[124:127]
    ds_read_b64_tr_b16 v[180:181], v232 offset:46144
    ds_read_b64_tr_b16 v[182:183], v232 offset:47424
    s_waitcnt lgkmcnt(6)
    v_mfma_f32_16x16x32_bf16 v[128:131], v[164:167], v[80:83], v[128:131]
    buffer_load_dwordx4 v255, s[12:15], s46 offen offset:3072 lds
    s_add_u32 s46, s46, 40960
    ds_read_b64_tr_b16 v[184:185], v232 offset:46176
    ds_read_b64_tr_b16 v[186:187], v232 offset:47456
    v_mfma_f32_16x16x32_bf16 v[132:135], v[168:171], v[80:83], v[132:135]
    ds_read_b64_tr_b16 v[188:189], v232 offset:46208
    ds_read_b64_tr_b16 v[190:191], v232 offset:47488
    s_waitcnt lgkmcnt(4)
    v_mfma_f32_16x16x32_bf16 v[116:119], v[172:175], v[84:87], v[116:119]
    ds_read_b64_tr_b16 v[152:153], v232 offset:51200
    ds_read_b64_tr_b16 v[154:155], v232 offset:52480
    v_mfma_f32_16x16x32_bf16 v[120:123], v[176:179], v[84:87], v[120:123]
    s_add_u32 m0, s47, 16384
    s_nop 0
    buffer_load_dwordx4 v252, s[12:15], s46 offen lds
    ds_read_b64_tr_b16 v[156:157], v232 offset:51232
    ds_read_b64_tr_b16 v[158:159], v232 offset:52512
    v_mfma_f32_16x16x32_bf16 v[124:127], v[180:183], v[84:87], v[124:127]
    ds_read_b64_tr_b16 v[160:161], v232 offset:51264
    ds_read_b64_tr_b16 v[162:163], v232 offset:52544
    s_waitcnt lgkmcnt(6)
    v_mfma_f32_16x16x32_bf16 v[128:131], v[184:187], v[84:87], v[128:131]
    ds_read_b64_tr_b16 v[164:165], v232 offset:51296
    ds_read_b64_tr_b16 v[166:167], v232 offset:52576
    v_mfma_f32_16x16x32_bf16 v[132:135], v[188:191], v[84:87], v[132:135]
    buffer_load_dwordx4 v253, s[12:15], s46 offen offset:1024 lds
    ds_read_b64_tr_b16 v[168:169], v232 offset:51328
    ds_read_b64_tr_b16 v[170:171], v232 offset:52608
    s_waitcnt lgkmcnt(4)
    v_mfma_f32_16x16x32_bf16 v[116:119], v[152:155], v[88:91], v[116:119]
    ds_read_b64_tr_b16 v[172:173], v232 offset:56320
    ds_read_b64_tr_b16 v[174:175], v232 offset:57600
    v_mfma_f32_16x16x32_bf16 v[120:123], v[156:159], v[88:91], v[120:123]
    ds_read_b64_tr_b16 v[176:177], v232 offset:56352
    ds_read_b64_tr_b16 v[178:179], v232 offset:57632
    v_mfma_f32_16x16x32_bf16 v[124:127], v[160:163], v[88:91], v[124:127]
    buffer_load_dwordx4 v254, s[12:15], s46 offen offset:2048 lds
    ds_read_b64_tr_b16 v[180:181], v232 offset:56384
    ds_read_b64_tr_b16 v[182:183], v232 offset:57664
    s_waitcnt lgkmcnt(6)
    v_mfma_f32_16x16x32_bf16 v[128:131], v[164:167], v[88:91], v[128:131]
    ds_read_b64_tr_b16 v[184:185], v232 offset:56416
    ds_read_b64_tr_b16 v[186:187], v232 offset:57696
    v_mfma_f32_16x16x32_bf16 v[132:135], v[168:171], v[88:91], v[132:135]
    ds_read_b64_tr_b16 v[188:189], v232 offset:56448
    ds_read_b64_tr_b16 v[190:191], v232 offset:57728
    s_waitcnt lgkmcnt(4)
    v_mfma_f32_16x16x32_bf16 v[116:119], v[172:175], v[92:95], v[116:119]
    buffer_load_dwordx4 v255, s[12:15], s46 offen offset:3072 lds
    s_add_u32 s46, s46, 40960
    v_mfma_f32_16x16x32_bf16 v[120:123], v[176:179], v[92:95], v[120:123]
    v_mfma_f32_16x16x32_bf16 v[124:127], v[180:183], v[92:95], v[124:127]
    s_waitcnt lgkmcnt(0)
    v_mfma_f32_16x16x32_bf16 v[128:131], v[184:187], v[92:95], v[128:131]
    v_mfma_f32_16x16x32_bf16 v[132:135], v[188:191], v[92:95], v[132:135]
    s_min_u32 s69, s61, 17
    s_min_u32 s66, s61, 13
    s_mul_i32 s66, s66, 3
    s_mov_b32 s92, 3678999104
    s_mov_b32 s93, 72
    s_lshr_b64 s[92:93], s[92:93], s66
    s_and_b32 s67, s92, 7
    s_mov_b32 s92, 443064840
    s_mov_b32 s93, 71
    s_lshr_b64 s[92:93], s[92:93], s66
    s_and_b32 s68, s92, 7
    s_add_u32 s16, s58, 1048576
    s_addc_u32 s17, s59, 0
    s_mov_b32 s18, 4718592
    s_mov_b32 s19, 0x20000
    s_lshl_b32 s70, s62, 5
    s_lshl_b32 s66, s60, 3
    s_add_u32 s70, s70, s66
    s_mul_i32 s70, s70, 18
    s_add_u32 s70, s70, s69
    s_lshl_b32 s74, s70, 10
    s_mov_b32 s92, 3277
    v_and_b32 v3, 15, v1
    s_lshl_b32 s66, s68, 4
    v_add_u32 v3, s66, v3
    v_mul_lo_u32 v3, v3, s92
    v_lshrrev_b32 v3, 16, v3
    v_lshrrev_b32 v4, 4, v1
    s_lshl_b32 s66, s67, 4
    v_lshl_add_u32 v4, v4, 2, s66
    v_add_u32 v5, 0, v4
    v_mul_lo_u32 v5, v5, s92
    v_lshrrev_b32 v5, 16, v5
    v_cmp_eq_u32 s[82:83], v5, v3
    v_add_u32 v5, 1, v4
    v_mul_lo_u32 v5, v5, s92
    v_lshrrev_b32 v5, 16, v5
    v_cmp_eq_u32 s[84:85], v5, v3
    v_add_u32 v5, 2, v4
    v_mul_lo_u32 v5, v5, s92
    v_lshrrev_b32 v5, 16, v5
    v_cmp_eq_u32 s[86:87], v5, v3
    v_add_u32 v5, 3, v4
    v_mul_lo_u32 v5, v5, s92
    v_lshrrev_b32 v5, 16, v5
    v_cmp_eq_u32 s[88:89], v5, v3
    s_cmp_ge_u32 s61, 13
    s_cselect_b64 s[82:83], -1, s[82:83]
    s_cselect_b64 s[84:85], -1, s[84:85]
    s_cselect_b64 s[86:87], -1, s[86:87]
    s_nop 0
    s_cselect_b64 s[88:89], -1, s[88:89]
    s_cmp_lg_u32 s60, 0
    s_cbranch_scc1 L_pskip_8
    s_add_u32 s66, s62, 0
    s_lshl_b32 s66, s66, 7
    v_mov_b32 v2, s66
    s_mov_b64 exec, 1
    s_mov_b32 s71, 0
L_poll_9:
    buffer_load_dword v3, v2, s[24:27], 0 offen sc1
    s_add_u32 s71, s71, 1
    s_waitcnt vmcnt(0)
    v_cmp_gt_u32 vcc, 32, v3
    s_nop 4
    s_cbranch_vccz L_got_10
    s_cmp_lt_u32 s71, 0x40000
    s_cbranch_scc1 L_poll_9
L_got_10:
    s_mov_b64 exec, -1
L_pskip_8:
    s_barrier
    v_lshlrev_b32 v6, 4, v1
    buffer_load_dwordx4 v[164:167], v6, s[16:19], s74 offen sc1
    s_add_u32 s74, s74, 18432
    buffer_load_dwordx4 v[168:171], v6, s[16:19], s74 offen sc1
    s_add_u32 s74, s74, 18432
    buffer_load_dwordx4 v[172:175], v6, s[16:19], s74 offen sc1
    s_add_u32 s74, s74, 18432
    buffer_load_dwordx4 v[176:179], v6, s[16:19], s74 offen sc1
    s_add_u32 s74, s74, 18432
    buffer_load_dwordx4 v[180:183], v6, s[16:19], s74 offen sc1
    s_add_u32 s74, s74, 18432
    buffer_load_dwordx4 v[184:187], v6, s[16:19], s74 offen sc1
    s_add_u32 s74, s74, 18432
    buffer_load_dwordx4 v[188:191], v6, s[16:19], s74 offen sc1
    s_add_u32 s74, s74, 18432
    buffer_load_dwordx4 v[192:195], v6, s[16:19], s74 offen sc1
    s_mov_b32 s90, 1069066811
    s_mov_b32 s91, 1069066811
    s_mov_b32 s92, 0x358637bd
    v_pk_mul_f32 v[200:201], v[116:117], s[90:91]
    v_pk_mul_f32 v[202:203], v[118:119], s[90:91]
    v_exp_f32 v200, v200 clamp
    v_exp_f32 v201, v201 clamp
    v_exp_f32 v202, v202 clamp
    v_exp_f32 v203, v203 clamp
    v_max_f32 v116, s92, v116
    v_max_f32 v117, s92, v117
    v_max_f32 v118, s92, v118
    v_max_f32 v119, s92, v119
    v_pk_add_f32 v[116:117], v[116:117], v[200:201]
    v_pk_add_f32 v[118:119], v[118:119], v[202:203]
    v_cvt_pk_bf16_f32 v232, v116, v117
    v_cvt_pk_bf16_f32 v233, v118, v119
    v_pk_mul_f32 v[204:205], v[120:121], s[90:91]
    v_pk_mul_f32 v[206:207], v[122:123], s[90:91]
    v_exp_f32 v204, v204 clamp
    v_exp_f32 v205, v205 clamp
    v_exp_f32 v206, v206 clamp
    v_exp_f32 v207, v207 clamp
    v_max_f32 v120, s92, v120
    v_max_f32 v121, s92, v121
    v_max_f32 v122, s92, v122
    v_max_f32 v123, s92, v123
    v_pk_add_f32 v[120:121], v[120:121], v[204:205]
    v_pk_add_f32 v[122:123], v[122:123], v[206:207]
    v_cvt_pk_bf16_f32 v234, v120, v121
    v_cvt_pk_bf16_f32 v235, v122, v123
    v_pk_mul_f32 v[200:201], v[124:125], s[90:91]
    v_pk_mul_f32 v[202:203], v[126:127], s[90:91]
    v_exp_f32 v200, v200 clamp
    v_exp_f32 v201, v201 clamp
    v_exp_f32 v202, v202 clamp
    v_exp_f32 v203, v203 clamp
    v_max_f32 v124, s92, v124
    v_max_f32 v125, s92, v125
    v_max_f32 v126, s92, v126
    v_max_f32 v127, s92, v127
    v_pk_add_f32 v[124:125], v[124:125], v[200:201]
    v_pk_add_f32 v[126:127], v[126:127], v[202:203]
    v_cvt_pk_bf16_f32 v236, v124, v125
    v_cvt_pk_bf16_f32 v237, v126, v127
    v_pk_mul_f32 v[204:205], v[128:129], s[90:91]
    v_pk_mul_f32 v[206:207], v[130:131], s[90:91]
    v_exp_f32 v204, v204 clamp
    v_exp_f32 v205, v205 clamp
    v_exp_f32 v206, v206 clamp
    v_exp_f32 v207, v207 clamp
    v_max_f32 v128, s92, v128
    v_max_f32 v129, s92, v129
    v_max_f32 v130, s92, v130
    v_max_f32 v131, s92, v131
    v_pk_add_f32 v[128:129], v[128:129], v[204:205]
    v_pk_add_f32 v[130:131], v[130:131], v[206:207]
    v_cvt_pk_bf16_f32 v238, v128, v129
    v_cvt_pk_bf16_f32 v239, v130, v131
    v_pk_mul_f32 v[200:201], v[132:133], s[90:91]
    v_pk_mul_f32 v[202:203], v[134:135], s[90:91]
    v_exp_f32 v200, v200 clamp
    v_exp_f32 v201, v201 clamp
    v_exp_f32 v202, v202 clamp
    v_exp_f32 v203, v203 clamp
    v_max_f32 v132, s92, v132
    v_max_f32 v133, s92, v133
    v_max_f32 v134, s92, v134
    v_max_f32 v135, s92, v135
    v_pk_add_f32 v[132:133], v[132:133], v[200:201]
    v_pk_add_f32 v[134:135], v[134:135], v[202:203]
    v_cvt_pk_bf16_f32 v240, v132, v133
    v_cvt_pk_bf16_f32 v241, v134, v135
    v_mov_b32 v242, 0
    v_mov_b32 v243, 0
    s_waitcnt vmcnt(0)
    v_pk_add_f32 v[164:165], v[164:165], v[180:181]
    v_pk_add_f32 v[166:167], v[166:167], v[182:183]
    v_pk_add_f32 v[168:169], v[168:169], v[184:185]
    v_pk_add_f32 v[170:171], v[170:171], v[186:187]
    v_pk_add_f32 v[172:173], v[172:173], v[188:189]
    v_pk_add_f32 v[174:175], v[174:175], v[190:191]
    v_pk_add_f32 v[176:177], v[176:177], v[192:193]
    v_pk_add_f32 v[178:179], v[178:179], v[194:195]
    v_pk_add_f32 v[164:165], v[164:165], v[172:173]
    v_pk_add_f32 v[166:167], v[166:167], v[174:175]
    v_pk_add_f32 v[168:169], v[168:169], v[176:177]
    v_pk_add_f32 v[170:171], v[170:171], v[178:179]
    v_pk_add_f32 v[164:165], v[164:165], v[168:169]
    v_pk_add_f32 v[166:167], v[166:167], v[170:171]
    s_lshl_b32 s66, s60, 10
    s_add_u32 s66, s66, 73728
    v_add_u32 v3, s66, v6
    ds_write_b128 v3, v[164:167]
    s_waitcnt lgkmcnt(0)
    s_barrier
    s_cmp_lg_u32 s60, 0
    s_cbranch_scc1 L_red_11
    v_add_u32 v3, 73728, v6
    ds_read_b128 v[164:167], v3 offset:0
    ds_read_b128 v[168:171], v3 offset:1024
    ds_read_b128 v[172:175], v3 offset:2048
    ds_read_b128 v[176:179], v3 offset:3072
    s_add_u32 s20, s58, 65536
    s_addc_u32 s21, s59, 0
    s_mov_b32 s22, 131072
    s_mov_b32 s23, 0x20000
    s_lshl_b32 s66, s62, 14
    s_lshl_b32 s67, s61, 9
    s_add_u32 s66, s66, s67
    s_cmp_lt_u32 s61, 18
    s_cselect_b32 s66, s66, 2146435072
    v_lshlrev_b32 v5, 3, v1
    s_waitcnt lgkmcnt(0)
    v_pk_add_f32 v[164:165], v[164:165], v[168:169]
    v_pk_add_f32 v[172:173], v[172:173], v[176:177]
    v_pk_add_f32 v[166:167], v[166:167], v[170:171]
    v_pk_add_f32 v[174:175], v[174:175], v[178:179]
    v_pk_add_f32 v[164:165], v[164:165], v[172:173]
    v_pk_add_f32 v[166:167], v[166:167], v[174:175]
    v_cndmask_b32 v164, 0, v164, s[82:83]
    v_cndmask_b32 v165, 0, v165, s[84:85]
    v_cndmask_b32 v166, 0, v166, s[86:87]
    v_cndmask_b32 v167, 0, v167, s[88:89]
    v_cvt_pk_bf16_f32 v164, v164, v165
    v_cvt_pk_bf16_f32 v165, v166, v167
    buffer_store_dwordx2 v[164:165], v5, s[20:23], s66 offen sc1
    s_waitcnt vmcnt(0)
    s_add_u32 s66, s62, 8
    s_cmp_lg_u32 s60, 0
    s_cbranch_scc1 L_sig_12
    s_lshl_b32 s71, s66, 7
    v_mov_b32 v4, s71
    v_mov_b32 v5, 1
    s_mov_b64 exec, 1
    buffer_atomic_add v5, v4, s[24:27], 0 offen sc1
    s_mov_b64 exec, -1
L_sig_12:
L_red_11:
    v_lshrrev_b32 v2, 3, v1
    v_bfe_u32 v3, v1, 4, 2
    v_lshlrev_b32 v3, 1, v3
    v_and_b32 v4, 7, v1
    v_xor_b32 v3, v3, v4
    v_lshlrev_b32 v3, 4, v3
    v_mul_u32_u24 v2, 3456, v2
    v_add_u32 v8, v2, v3
    s_mov_b32 s8, s48
    s_mov_b32 s9, s49
    s_mov_b32 s10, 2211840
    s_mov_b32 s11, 0x20000
    s_sub_u32 s12, s50, 1024
    s_subb_u32 s13, s51, 0
    s_mov_b32 s14, 2212864
    s_mov_b32 s15, 0x20000
    s_lshl_b32 s46, s60, 3
    s_add_u32 s46, s46, 0
    s_mul_i32 s46, s46, 3456
    s_lshl_b32 s47, s98, 7
    s_add_u32 s46, s46, s47
    s_cmp_eq_u32 s99, 0
    s_cselect_b32 s46, 2146435072, s46
    s_lshl_b32 s47, s60, 11
    s_add_u32 m0, s47, 0
    s_nop 0
    buffer_load_dwordx4 v8, s[8:11], s46 offen lds
    buffer_load_dwordx4 v8, s[12:15], s46 offen offset:1024 lds
    s_add_u32 s46, s46, 110592
    s_add_u32 m0, s47, 8192
    s_nop 0
    buffer_load_dwordx4 v8, s[8:11], s46 offen lds
    buffer_load_dwordx4 v8, s[12:15], s46 offen offset:1024 lds
    s_add_u32 s46, s46, 110592
    s_add_u32 m0, s47, 16384
    s_nop 0
    buffer_load_dwordx4 v8, s[8:11], s46 offen lds
    buffer_load_dwordx4 v8, s[12:15], s46 offen offset:1024 lds
    s_add_u32 s46, s46, 110592
    s_add_u32 m0, s47, 24576
    s_nop 0
    buffer_load_dwordx4 v8, s[8:11], s46 offen lds
    buffer_load_dwordx4 v8, s[12:15], s46 offen offset:1024 lds
    s_add_u32 s46, s46, 110592
    s_add_u32 m0, s47, 32768
    s_nop 0
    buffer_load_dwordx4 v8, s[8:11], s46 offen lds
    buffer_load_dwordx4 v8, s[12:15], s46 offen offset:1024 lds
    s_add_u32 s46, s46, 110592
    s_add_u32 m0, s47, 40960
    s_nop 0
    buffer_load_dwordx4 v8, s[8:11], s46 offen lds
    buffer_load_dwordx4 v8, s[12:15], s46 offen offset:1024 lds
    s_add_u32 s46, s46, 110592
    s_add_u32 m0, s47, 49152
    s_nop 0
    buffer_load_dwordx4 v8, s[8:11], s46 offen lds
    buffer_load_dwordx4 v8, s[12:15], s46 offen offset:1024 lds
    s_add_u32 s46, s46, 110592
    s_add_u32 m0, s47, 57344
    s_nop 0
    buffer_load_dwordx4 v8, s[8:11], s46 offen lds
    buffer_load_dwordx4 v8, s[12:15], s46 offen offset:1024 lds
    s_add_u32 s46, s46, 110592
    s_add_u32 m0, s47, 65536
    s_nop 0
    buffer_load_dwordx4 v8, s[8:11], s46 offen lds
    buffer_load_dwordx4 v8, s[12:15], s46 offen offset:1024 lds
    s_add_u32 s46, s46, 110592
    s_add_u32 s66, s60, 4
    s_mul_i32 s66, s66, 20480
    s_and_b32 s67, s60, 1
    s_lshl_b32 s67, s67, 1
    v_bfe_u32 v2, v1, 2, 2
    v_lshrrev_b32 v3, 4, v1
    v_lshl_add_u32 v2, v3, 2, v2
    v_bfe_u32 v3, v2, 1, 2
    v_and_b32 v4, 3, v1
    v_lshlrev_b32 v4, 3, v4
    v_lshl_add_u32 v2, v2, 7, v4
    v_add_u32 v2, s66, v2
    v_xor_b32 v3, s67, v3
    v_xor_b32 v4, 0, v3
    v_lshl_add_u32 v244, v4, 5, v2
    v_xor_b32 v4, 1, v3
    v_lshl_add_u32 v245, v4, 5, v2
    v_xor_b32 v4, 2, v3
    v_lshl_add_u32 v246, v4, 5, v2
    v_xor_b32 v4, 3, v3
    v_lshl_add_u32 v247, v4, 5, v2
    ds_read_b64_tr_b16 a[0:1], v244 offset:0
    ds_read_b64_tr_b16 a[2:3], v244 offset:2048
    ds_read_b64_tr_b16 a[4:5], v245 offset:0
    ds_read_b64_tr_b16 a[6:7], v245 offset:2048
    ds_read_b64_tr_b16 a[8:9], v246 offset:0
    ds_read_b64_tr_b16 a[10:11], v246 offset:2048
    ds_read_b64_tr_b16 a[12:13], v247 offset:0
    ds_read_b64_tr_b16 a[14:15], v247 offset:2048
    ds_read_b64_tr_b16 a[16:17], v244 offset:4096
    ds_read_b64_tr_b16 a[18:19], v244 offset:6144
    ds_read_b64_tr_b16 a[20:21], v245 offset:4096
    ds_read_b64_tr_b16 a[22:23], v245 offset:6144
    ds_read_b64_tr_b16 a[24:25], v246 offset:4096
    ds_read_b64_tr_b16 a[26:27], v246 offset:6144
    ds_read_b64_tr_b16 a[28:29], v247 offset:4096
    ds_read_b64_tr_b16 a[30:31], v247 offset:6144
    ds_read_b64_tr_b16 a[32:33], v244 offset:10240
    ds_read_b64_tr_b16 a[34:35], v244 offset:12288
    ds_read_b64_tr_b16 a[36:37], v245 offset:10240
    ds_read_b64_tr_b16 a[38:39], v245 offset:12288
    ds_read_b64_tr_b16 a[40:41], v246 offset:10240
    ds_read_b64_tr_b16 a[42:43], v246 offset:12288
    ds_read_b64_tr_b16 a[44:45], v247 offset:10240
    ds_read_b64_tr_b16 a[46:47], v247 offset:12288
    ds_read_b64_tr_b16 a[48:49], v244 offset:14336
    ds_read_b64_tr_b16 a[50:51], v244 offset:16384
    ds_read_b64_tr_b16 a[52:53], v245 offset:14336
    ds_read_b64_tr_b16 a[54:55], v245 offset:16384
    ds_read_b64_tr_b16 a[56:57], v246 offset:14336
    ds_read_b64_tr_b16 a[58:59], v246 offset:16384
    ds_read_b64_tr_b16 a[60:61], v247 offset:14336
    ds_read_b64_tr_b16 a[62:63], v247 offset:16384
    ds_read_b64_tr_b16 a[64:65], v244 offset:8192
    ds_read_b64_tr_b16 a[66:67], v244 offset:18432
    ds_read_b64_tr_b16 a[68:69], v245 offset:8192
    ds_read_b64_tr_b16 a[70:71], v245 offset:18432
    ds_read_b64_tr_b16 a[72:73], v246 offset:8192
    ds_read_b64_tr_b16 a[74:75], v246 offset:18432
    ds_read_b64_tr_b16 a[76:77], v247 offset:8192
    ds_read_b64_tr_b16 a[78:79], v247 offset:18432
    s_waitcnt vmcnt(0) lgkmcnt(0)
    s_barrier
    v_bfe_u32 v2, v1, 2, 2
    v_lshrrev_b32 v3, 4, v1
    v_lshl_add_u32 v2, v3, 2, v2
    v_bfe_u32 v3, v2, 1, 2
    v_xor_b32 v3, s60, v3
    v_and_b32 v4, 3, v1
    v_lshlrev_b32 v4, 3, v4
    v_and_b32 v5, 7, v2
    v_lshl_add_u32 v4, v5, 7, v4
    v_lshrrev_b32 v5, 3, v2
    v_lshl_add_u32 v2, v5, 11, v4
    v_lshl_add_u32 v6, v3, 5, v2
    v_mov_b32 v196, 0x3f803f80
    v_mov_b32 v197, 0x3f803f80
    v_mov_b32 v198, 0x3f803f80
    v_mov_b32 v199, 0x3f803f80
    ds_read_b64_tr_b16 v[200:201], v6 offset:0
    ds_read_b64_tr_b16 v[202:203], v6 offset:4096
    ds_read_b64_tr_b16 v[204:205], v6 offset:1024
    ds_read_b64_tr_b16 v[206:207], v6 offset:5120
    ds_read_b64_tr_b16 v[208:209], v6 offset:8192
    ds_read_b64_tr_b16 v[210:211], v6 offset:12288
    ds_read_b64_tr_b16 v[212:213], v6 offset:9216
    ds_read_b64_tr_b16 v[214:215], v6 offset:13312
    ds_read_b64_tr_b16 v[216:217], v6 offset:16384
    ds_read_b64_tr_b16 v[218:219], v6 offset:20480
    ds_read_b64_tr_b16 v[220:221], v6 offset:17408
    ds_read_b64_tr_b16 v[222:223], v6 offset:21504
    s_waitcnt lgkmcnt(8)
    v_mfma_f32_16x16x32_bf16 a[232:235], v[200:203], v[196:199], 0
    v_mfma_f32_16x16x32_bf16 a[236:239], v[204:207], v[196:199], 0
    ds_read_b64_tr_b16 v[200:201], v6 offset:24576
    ds_read_b64_tr_b16 v[202:203], v6 offset:28672
    ds_read_b64_tr_b16 v[204:205], v6 offset:25600
    ds_read_b64_tr_b16 v[206:207], v6 offset:29696
    s_waitcnt lgkmcnt(8)
    v_mfma_f32_16x16x32_bf16 a[232:235], v[208:211], v[196:199], a[232:235]
    v_mfma_f32_16x16x32_bf16 a[236:239], v[212:215], v[196:199], a[236:239]
    ds_read_b64_tr_b16 v[208:209], v6 offset:32768
    ds_read_b64_tr_b16 v[210:211], v6 offset:36864
    ds_read_b64_tr_b16 v[212:213], v6 offset:33792
    ds_read_b64_tr_b16 v[214:215], v6 offset:37888
    s_waitcnt lgkmcnt(8)
    v_mfma_f32_16x16x32_bf16 a[232:235], v[216:219], v[196:199], a[232:235]
    v_mfma_f32_16x16x32_bf16 a[236:239], v[220:223], v[196:199], a[236:239]
    ds_read_b64_tr_b16 v[216:217], v6 offset:40960
    ds_read_b64_tr_b16 v[218:219], v6 offset:45056
    ds_read_b64_tr_b16 v[220:221], v6 offset:41984
    ds_read_b64_tr_b16 v[222:223], v6 offset:46080
    s_waitcnt lgkmcnt(8)
    v_mfma_f32_16x16x32_bf16 a[232:235], v[200:203], v[196:199], a[232:235]
    v_mfma_f32_16x16x32_bf16 a[236:239], v[204:207], v[196:199], a[236:239]
    ds_read_b64_tr_b16 v[200:201], v6 offset:49152
    ds_read_b64_tr_b16 v[202:203], v6 offset:53248
    ds_read_b64_tr_b16 v[204:205], v6 offset:50176
    ds_read_b64_tr_b16 v[206:207], v6 offset:54272
    s_waitcnt lgkmcnt(8)
    v_mfma_f32_16x16x32_bf16 a[232:235], v[208:211], v[196:199], a[232:235]
    v_mfma_f32_16x16x32_bf16 a[236:239], v[212:215], v[196:199], a[236:239]
    v_add_u32 v6, 57344, v6
    ds_read_b64_tr_b16 v[208:209], v6 offset:0
    ds_read_b64_tr_b16 v[210:211], v6 offset:4096
    ds_read_b64_tr_b16 v[212:213], v6 offset:1024
    ds_read_b64_tr_b16 v[214:215], v6 offset:5120
    s_waitcnt lgkmcnt(8)
    v_mfma_f32_16x16x32_bf16 a[232:235], v[216:219], v[196:199], a[232:235]
    v_mfma_f32_16x16x32_bf16 a[236:239], v[220:223], v[196:199], a[236:239]
    ds_read_b64_tr_b16 v[216:217], v6 offset:8192
    ds_read_b64_tr_b16 v[218:219], v6 offset:12288
    ds_read_b64_tr_b16 v[220:221], v6 offset:9216
    ds_read_b64_tr_b16 v[222:223], v6 offset:13312
    s_waitcnt lgkmcnt(8)
    v_mfma_f32_16x16x32_bf16 a[232:235], v[200:203], v[196:199], a[232:235]
    v_mfma_f32_16x16x32_bf16 a[236:239], v[204:207], v[196:199], a[236:239]
    s_waitcnt lgkmcnt(4)
    v_mfma_f32_16x16x32_bf16 a[232:235], v[208:211], v[196:199], a[232:235]
    v_mfma_f32_16x16x32_bf16 a[236:239], v[212:215], v[196:199], a[236:239]
    s_waitcnt lgkmcnt(0)
    v_mfma_f32_16x16x32_bf16 a[232:235], v[216:219], v[196:199], a[232:235]
    v_mfma_f32_16x16x32_bf16 a[236:239], v[220:223], v[196:199], a[236:239]
    v_and_b32 v2, 15, v1
    v_lshrrev_b32 v3, 4, v1
    s_mov_b32 s92, 3277
    v_add_u32 v4, 0, v2
    v_mul_lo_u32 v4, v4, s92
    v_lshrrev_b32 v150, 16, v4
    v_lshl_add_u32 v4, v3, 2, 0
    v_mul_lo_u32 v4, v4, s92
    v_lshrrev_b32 v155, 16, v4
    v_add_u32 v4, 16, v2
    v_mul_lo_u32 v4, v4, s92
    v_lshrrev_b32 v151, 16, v4
    v_lshl_add_u32 v4, v3, 2, 16
    v_mul_lo_u32 v4, v4, s92
    v_lshrrev_b32 v156, 16, v4
    v_add_u32 v4, 32, v2
    v_mul_lo_u32 v4, v4, s92
    v_lshrrev_b32 v152, 16, v4
    v_lshl_add_u32 v4, v3, 2, 32
    v_mul_lo_u32 v4, v4, s92
    v_lshrrev_b32 v157, 16, v4
    v_add_u32 v4, 48, v2
    v_mul_lo_u32 v4, v4, s92
    v_lshrrev_b32 v153, 16, v4
    v_lshl_add_u32 v4, v3, 2, 48
    v_mul_lo_u32 v4, v4, s92
    v_lshrrev_b32 v158, 16, v4
    v_add_u32 v4, 64, v2
    v_mul_lo_u32 v4, v4, s92
    v_lshrrev_b32 v154, 16, v4
    v_lshl_add_u32 v4, v3, 2, 64
    v_mul_lo_u32 v4, v4, s92
    v_lshrrev_b32 v159, 16, v4
    v_cmp_eq_u32 vcc, v155, v150
    s_nop 1
    v_cndmask_b32 v136, 0, -1, vcc
    v_cmp_eq_u32 vcc, v155, v151
    s_nop 1
    v_cndmask_b32 v137, 0, -1, vcc
    v_cmp_eq_u32 vcc, v156, v150
    s_nop 1
    v_cndmask_b32 v138, 0, -1, vcc
    v_cmp_eq_u32 vcc, v156, v151
    s_nop 1
    v_cndmask_b32 v139, 0, -1, vcc
    v_cmp_eq_u32 vcc, v156, v152
    s_nop 1
    v_cndmask_b32 v140, 0, -1, vcc
    v_cmp_eq_u32 vcc, v157, v151
    s_nop 1
    v_cndmask_b32 v141, 0, -1, vcc
    v_cmp_eq_u32 vcc, v157, v152
    s_nop 1
    v_cndmask_b32 v142, 0, -1, vcc
    v_cmp_eq_u32 vcc, v157, v153
    s_nop 1
    v_cndmask_b32 v143, 0, -1, vcc
    v_cmp_eq_u32 vcc, v158, v152
    s_nop 1
    v_cndmask_b32 v144, 0, -1, vcc
    v_cmp_eq_u32 vcc, v158, v153
    s_nop 1
    v_cndmask_b32 v145, 0, -1, vcc
    v_cmp_eq_u32 vcc, v158, v154
    s_nop 1
    v_cndmask_b32 v146, 0, -1, vcc
    v_cmp_eq_u32 vcc, v159, v153
    s_nop 1
    v_cndmask_b32 v147, 0, -1, vcc
    v_cmp_eq_u32 vcc, v159, v154
    s_nop 1
    v_cndmask_b32 v148, 0, -1, vcc
    v_mov_b32 v174, 0
    v_mov_b32 v175, 0
    v_mov_b32 v182, 0
    v_mov_b32 v183, 0
    v_mov_b32 v190, 0
    v_mov_b32 v191, 0
    s_add_u32 s16, s58, 65536
    s_addc_u32 s17, s59, 0
    s_mov_b32 s18, 131072
    s_mov_b32 s19, 0x20000
    v_lshlrev_b32 v6, 4, v1
    s_waitcnt lgkmcnt(0)
    s_cmp_lg_u32 s60, 0
    s_cbranch_scc1 L_pskip_13
    s_add_u32 s66, s62, 8
    s_lshl_b32 s66, s66, 7
    v_mov_b32 v2, s66
    s_mov_b64 exec, 1
    s_mov_b32 s71, 0
L_poll_14:
    buffer_load_dword v3, v2, s[24:27], 0 offen sc1
    s_add_u32 s71, s71, 1
    s_waitcnt vmcnt(0)
    v_cmp_gt_u32 vcc, 32, v3
    s_nop 4
    s_cbranch_vccz L_got_15
    s_cmp_lt_u32 s71, 0x40000
    s_cbranch_scc1 L_poll_14
L_got_15:
    s_mov_b64 exec, -1
L_pskip_13:
    s_barrier
    v_lshlrev_b32 v5, 3, v1
    s_lshl_b32 s66, s62, 14
    s_add_u32 s67, s66, 4096
    s_add_u32 s68, s66, 8192
    buffer_load_dwordx2 v[200:201], v5, s[16:19], s67 offen offset:2560 sc1
    buffer_load_dwordx2 v[202:203], v5, s[16:19], s67 offen offset:3072 sc1
    buffer_load_dwordx2 v[204:205], v5, s[16:19], s67 offen offset:3584 sc1
    buffer_load_dwordx2 v[206:207], v5, s[16:19], s68 offen offset:0 sc1
    buffer_load_dwordx2 v[208:209], v5, s[16:19], s68 offen offset:512 sc1
    buffer_load_dwordx2 v[164:165], v5, s[16:19], s66 offen offset:0 sc1
    buffer_load_dwordx2 v[166:167], v5, s[16:19], s66 offen offset:1024 sc1
    buffer_load_dwordx2 v[168:169], v5, s[16:19], s66 offen offset:512 sc1
    buffer_load_dwordx2 v[170:171], v5, s[16:19], s66 offen offset:1536 sc1
    buffer_load_dwordx2 v[172:173], v5, s[16:19], s66 offen offset:2560 sc1
    buffer_load_dwordx2 v[176:177], v5, s[16:19], s66 offen offset:2048 sc1
    buffer_load_dwordx2 v[178:179], v5, s[16:19], s66 offen offset:3072 sc1
    buffer_load_dwordx2 v[180:181], v5, s[16:19], s67 offen offset:0 sc1
    buffer_load_dwordx2 v[184:185], v5, s[16:19], s66 offen offset:3584 sc1
    buffer_load_dwordx2 v[186:187], v5, s[16:19], s67 offen offset:512 sc1
    buffer_load_dwordx2 v[188:189], v5, s[16:19], s67 offen offset:1536 sc1
    buffer_load_dwordx2 v[192:193], v5, s[16:19], s67 offen offset:1024 sc1
    buffer_load_dwordx2 v[194:195], v5, s[16:19], s67 offen offset:2048 sc1
    s_add_u32 s20, s58, 6291456
    s_addc_u32 s21, s59, 0
    s_mov_b32 s22, 2621440
    s_mov_b32 s23, 0x20000
    s_lshl_b32 s66, s61, 2
    s_add_u32 s66, s66, s60
    s_mul_i32 s66, s66, 20480
    s_lshr_b32 s67, s62, 1
    s_mul_i32 s67, s67, 5120
    s_add_u32 s66, s66, s67
    s_and_b32 s67, s62, 1
    s_lshl_b32 s68, s67, 11
    s_add_u32 s68, s68, s66
    s_lshl_b32 s69, s67, 9
    s_add_u32 s69, s69, s66
    s_add_u32 s69, s69, 4096
    s_mov_b32 s92, 0x358637bd
    s_mov_b32 s93, 0x358637bd
    s_waitcnt vmcnt(13)
    v_and_b32 v212, v200, v136
    v_and_b32 v213, v201, v136
    v_and_b32 v214, v202, v138
    v_and_b32 v215, v203, v138
    s_nop 0
    s_nop 0
    v_mfma_f32_16x16x32_bf16 v[116:119], v[212:215], v[232:235], 0
    v_and_b32 v216, v200, v137
    v_and_b32 v217, v201, v137
    v_and_b32 v218, v202, v139
    v_and_b32 v219, v203, v139
    s_nop 0
    s_nop 0
    v_mfma_f32_16x16x32_bf16 v[120:123], v[216:219], v[232:235], 0
    v_and_b32 v212, v204, v141
    v_and_b32 v213, v205, v141
    v_mov_b32 v214, 0
    v_mov_b32 v215, 0
    s_nop 0
    s_nop 0
    v_mfma_f32_16x16x32_bf16 v[120:123], v[212:215], v[236:239], v[120:123]
    v_and_b32 v216, v202, v140
    v_and_b32 v217, v203, v140
    v_and_b32 v218, v204, v142
    v_and_b32 v219, v205, v142
    s_nop 0
    s_nop 0
    v_mfma_f32_16x16x32_bf16 v[124:127], v[216:219], v[234:237], 0
    v_and_b32 v212, v206, v144
    v_and_b32 v213, v207, v144
    v_mov_b32 v214, 0
    v_mov_b32 v215, 0
    s_nop 0
    s_nop 0
    v_mfma_f32_16x16x32_bf16 v[124:127], v[212:215], v[238:241], v[124:127]
    v_and_b32 v216, v204, v143
    v_and_b32 v217, v205, v143
    v_and_b32 v218, v206, v145
    v_and_b32 v219, v207, v145
    s_nop 0
    s_nop 0
    v_mfma_f32_16x16x32_bf16 v[128:131], v[216:219], v[236:239], 0
    v_and_b32 v212, v208, v147
    v_and_b32 v213, v209, v147
    v_mov_b32 v214, 0
    v_mov_b32 v215, 0
    s_nop 0
    s_nop 0
    v_mfma_f32_16x16x32_bf16 v[128:131], v[212:215], v[240:243], v[128:131]
    v_and_b32 v216, v206, v146
    v_and_b32 v217, v207, v146
    v_and_b32 v218, v208, v148
    v_and_b32 v219, v209, v148
    s_nop 0
    s_nop 0
    v_mfma_f32_16x16x32_bf16 v[132:135], v[216:219], v[238:241], 0
    s_waitcnt vmcnt(11)
    v_mfma_f32_16x16x32_bf16 v[96:99], v[164:167], v[232:235], 0
    s_waitcnt vmcnt(9)
    v_mfma_f32_16x16x32_bf16 v[100:103], v[168:171], v[232:235], 0
    s_waitcnt vmcnt(8)
    v_mfma_f32_16x16x32_bf16 v[100:103], v[172:175], v[236:239], v[100:103]
    s_waitcnt vmcnt(6)
    v_mfma_f32_16x16x32_bf16 v[104:107], v[176:179], v[234:237], 0
    s_waitcnt vmcnt(5)
    v_mfma_f32_16x16x32_bf16 v[104:107], v[180:183], v[238:241], v[104:107]
    s_waitcnt vmcnt(3)
    v_mfma_f32_16x16x32_bf16 v[108:111], v[184:187], v[236:239], 0
    s_waitcnt vmcnt(2)
    v_mfma_f32_16x16x32_bf16 v[108:111], v[188:191], v[240:243], v[108:111]
    s_waitcnt vmcnt(0)
    v_mfma_f32_16x16x32_bf16 v[112:115], v[192:195], v[238:241], 0
    v_pk_add_f32 v[116:117], v[116:117], s[92:93]
    v_pk_add_f32 v[118:119], v[118:119], s[92:93]
    v_pk_add_f32 v[120:121], v[120:121], s[92:93]
    v_pk_add_f32 v[122:123], v[122:123], s[92:93]
    v_pk_add_f32 v[124:125], v[124:125], s[92:93]
    v_pk_add_f32 v[126:127], v[126:127], s[92:93]
    v_pk_add_f32 v[128:129], v[128:129], s[92:93]
    v_pk_add_f32 v[130:131], v[130:131], s[92:93]
    v_pk_add_f32 v[132:133], v[132:133], s[92:93]
    v_pk_add_f32 v[134:135], v[134:135], s[92:93]
    v_rcp_f32 v116, v116
    v_rcp_f32 v117, v117
    v_rcp_f32 v118, v118
    v_rcp_f32 v119, v119
    v_rcp_f32 v120, v120
    v_rcp_f32 v121, v121
    v_rcp_f32 v122, v122
    v_rcp_f32 v123, v123
    v_rcp_f32 v124, v124
    v_rcp_f32 v125, v125
    v_rcp_f32 v126, v126
    v_rcp_f32 v127, v127
    v_rcp_f32 v128, v128
    v_rcp_f32 v129, v129
    v_rcp_f32 v130, v130
    v_rcp_f32 v131, v131
    v_rcp_f32 v132, v132
    v_rcp_f32 v133, v133
    v_rcp_f32 v134, v134
    v_rcp_f32 v135, v135
    v_pk_mul_f32 v[96:97], v[96:97], v[116:117]
    v_pk_mul_f32 v[98:99], v[98:99], v[118:119]
    v_cvt_pk_bf16_f32 v164, v96, v97
    v_cvt_pk_bf16_f32 v165, v98, v99
    v_pk_mul_f32 v[100:101], v[100:101], v[120:121]
    v_pk_mul_f32 v[102:103], v[102:103], v[122:123]
    v_cvt_pk_bf16_f32 v166, v100, v101
    v_cvt_pk_bf16_f32 v167, v102, v103
    buffer_store_dwordx4 v[164:167], v6, s[20:23], s68 offen sc1
    v_pk_mul_f32 v[104:105], v[104:105], v[124:125]
    v_pk_mul_f32 v[106:107], v[106:107], v[126:127]
    v_cvt_pk_bf16_f32 v168, v104, v105
    v_cvt_pk_bf16_f32 v169, v106, v107
    v_pk_mul_f32 v[108:109], v[108:109], v[128:129]
    v_pk_mul_f32 v[110:111], v[110:111], v[130:131]
    v_cvt_pk_bf16_f32 v170, v108, v109
    v_cvt_pk_bf16_f32 v171, v110, v111
    buffer_store_dwordx4 v[168:171], v6, s[20:23], s68 offen offset:1024 sc1
    v_pk_mul_f32 v[112:113], v[112:113], v[132:133]
    v_pk_mul_f32 v[114:115], v[114:115], v[134:135]
    v_cvt_pk_bf16_f32 v172, v112, v113
    v_cvt_pk_bf16_f32 v173, v114, v115
    buffer_store_dwordx2 v[172:173], v5, s[20:23], s69 offen sc1
    s_waitcnt vmcnt(0)
    s_barrier
    s_add_u32 s66, s61, 16
    s_cmp_lg_u32 s60, 0
    s_cbranch_scc1 L_sig_16
    s_lshl_b32 s71, s66, 7
    v_mov_b32 v4, s71
    v_mov_b32 v5, 1
    s_mov_b64 exec, 1
    buffer_atomic_add v5, v4, s[24:27], 0 offen sc1
    s_mov_b64 exec, -1
L_sig_16:
    s_lshl_b32 s46, s60, 3
    s_add_u32 s46, s46, 288
    s_mul_i32 s46, s46, 3456
    s_lshl_b32 s47, s98, 7
    s_add_u32 s46, s46, s47
    s_cmp_eq_u32 s99, 0
    s_cselect_b32 s46, 2146435072, s46
    s_lshl_b32 s47, s60, 11
    s_add_u32 m0, s47, 73728
    s_nop 0
    buffer_load_dwordx4 v8, s[8:11], s46 offen lds
    buffer_load_dwordx4 v8, s[12:15], s46 offen offset:1024 lds
    s_add_u32 s46, s46, 110592
    s_add_u32 m0, s47, 81920
    s_nop 0
    buffer_load_dwordx4 v8, s[8:11], s46 offen lds
    buffer_load_dwordx4 v8, s[12:15], s46 offen offset:1024 lds
    s_add_u32 s46, s46, 110592
    s_cmp_eq_u32 s96, 0
    s_cbranch_scc1 L_p3end_17
    v_and_b32 v2, 15, v1
    v_mul_u32_u24 v2, 1280, v2
    v_lshrrev_b32 v3, 4, v1
    v_lshl_add_u32 v15, v3, 3, v2
    s_lshr_b32 s66, s60, 1
    s_mul_i32 s66, s66, 3
    s_mul_i32 s67, s95, 6
    s_add_u32 s100, s66, s67
    s_mul_i32 s66, s100, 20480
    s_lshl_b32 s67, s94, 7
    s_add_u32 s66, s66, s67
    s_and_b32 s67, s60, 1
    s_lshl_b32 s67, s67, 6
    s_add_u32 s101, s66, s67
    s_add_u32 s66, s101, 2048
    buffer_load_dwordx2 v[112:113], v15, s[4:7], s66 offen offset:0
    buffer_load_dwordx2 v[114:115], v15, s[4:7], s66 offen offset:32
    s_add_u32 s66, s66, 20480
    buffer_load_dwordx2 v[116:117], v15, s[4:7], s66 offen offset:0
    buffer_load_dwordx2 v[118:119], v15, s[4:7], s66 offen offset:32
    s_add_u32 s66, s66, 20480
    buffer_load_dwordx2 v[120:121], v15, s[4:7], s66 offen offset:0
    buffer_load_dwordx2 v[122:123], v15, s[4:7], s66 offen offset:32
    s_xor_b32 s66, s60, 1
    s_mul_i32 s66, s66, 18432
    s_add_u32 s66, s66, 90112
    v_lshl_add_u32 v124, v1, 4, s66
    s_xor_b32 s66, s60, 2
    s_mul_i32 s66, s66, 18432
    s_add_u32 s66, s66, 96256
    v_lshl_add_u32 v125, v1, 4, s66
    s_xor_b32 s66, s60, 3
    s_mul_i32 s66, s66, 18432
    s_add_u32 s66, s66, 102400
    v_lshl_add_u32 v126, v1, 4, s66
    s_mul_i32 s66, s60, 18432
    s_add_u32 s66, s66, 90112
    v_lshl_add_u32 v127, v1, 4, s66
    s_add_u32 s16, s58, 6291456
    s_addc_u32 s17, s59, 0
    s_mov_b32 s18, 2621440
    s_mov_b32 s19, 0x20000
    v_lshlrev_b32 v2, 4, v1
    s_lshr_b32 s66, s60, 1
    s_mul_i32 s66, s66, 61440
    s_add_u32 s67, s66, 0
    v_add_u32 v128, s67, v2
    s_add_u32 s67, s66, 20480
    v_add_u32 v129, s67, v2
    s_add_u32 s67, s66, 40960
    v_add_u32 v130, s67, v2
    s_sub_u32 s67, 61440, s66
    s_cmp_ge_u32 s67, 61440
    v_add_u32 v131, s67, v2
    s_sub_u32 s67, 81920, s66
    s_cmp_ge_u32 s67, 61440
    v_add_u32 v132, s67, v2
    s_sub_u32 s67, 102400, s66
    s_cmp_ge_u32 s67, 61440
    v_add_u32 v133, s67, v2
    s_mul_i32 s74, s95, 122880
    s_mul_i32 s67, s60, 5120
    s_add_u32 s74, s74, s67
    s_cmp_lg_u32 s60, 0
    s_cbranch_scc1 L_pskip_18
    s_mul_i32 s66, s95, 3
    s_lshr_b32 s66, s66, 1
    v_add_u32 v2, s66, v1
    v_min_u32 v2, 31, v2
    v_add_u32 v2, 16, v2
    v_lshlrev_b32 v2, 7, v2
    s_mov_b64 exec, 3
    s_mov_b32 s71, 0
L_poll_19:
    buffer_load_dword v3, v2, s[24:27], 0 offen sc1
    s_add_u32 s71, s71, 1
    s_waitcnt vmcnt(0)
    v_cmp_gt_u32 vcc, 8, v3
    s_nop 4
    s_cbranch_vccz L_got_20
    s_cmp_lt_u32 s71, 0x40000
    s_cbranch_scc1 L_poll_19
L_got_20:
    s_mov_b64 exec, -1
L_pskip_18:
    s_barrier
    s_add_u32 s47, s74, 4096
    v_lshlrev_b32 v3, 3, v1
    v_lshlrev_b32 v4, 4, v1
    v_sub_u32 v3, v3, v4
    v_add_u32 v208, v128, v3
    v_add_u32 v209, v129, v3
    v_add_u32 v210, v130, v3
    v_add_u32 v211, v131, v3
    v_add_u32 v212, v132, v3
    v_add_u32 v213, v133, v3
    buffer_load_dwordx4 a[140:143], v131, s[16:19], s74 offen offset:0 sc1
    buffer_load_dwordx4 a[144:147], v131, s[16:19], s74 offen offset:1024 sc1
    buffer_load_dwordx4 a[148:151], v131, s[16:19], s74 offen offset:2048 sc1
    buffer_load_dwordx4 a[152:155], v131, s[16:19], s74 offen offset:3072 sc1
    buffer_load_dwordx2 a[156:157], v211, s[16:19], s47 offen offset:0 sc1
    buffer_load_dwordx2 a[158:159], v211, s[16:19], s47 offen offset:512 sc1
    buffer_load_dwordx4 a[160:163], v132, s[16:19], s74 offen offset:0 sc1
    buffer_load_dwordx4 a[164:167], v132, s[16:19], s74 offen offset:1024 sc1
    buffer_load_dwordx4 a[168:171], v132, s[16:19], s74 offen offset:2048 sc1
    buffer_load_dwordx4 a[172:175], v132, s[16:19], s74 offen offset:3072 sc1
    buffer_load_dwordx2 a[176:177], v212, s[16:19], s47 offen offset:0 sc1
    buffer_load_dwordx2 a[178:179], v212, s[16:19], s47 offen offset:512 sc1
    buffer_load_dwordx4 a[180:183], v133, s[16:19], s74 offen offset:0 sc1
    buffer_load_dwordx4 a[184:187], v133, s[16:19], s74 offen offset:1024 sc1
    buffer_load_dwordx4 a[188:191], v133, s[16:19], s74 offen offset:2048 sc1
    buffer_load_dwordx4 a[192:195], v133, s[16:19], s74 offen offset:3072 sc1
    buffer_load_dwordx2 a[196:197], v213, s[16:19], s47 offen offset:0 sc1
    buffer_load_dwordx2 a[198:199], v213, s[16:19], s47 offen offset:512 sc1
    buffer_load_dwordx4 a[80:83], v128, s[16:19], s74 offen offset:0 sc1
    buffer_load_dwordx4 a[84:87], v128, s[16:19], s74 offen offset:1024 sc1
    buffer_load_dwordx4 a[88:91], v128, s[16:19], s74 offen offset:2048 sc1
    buffer_load_dwordx4 a[92:95], v128, s[16:19], s74 offen offset:3072 sc1
    buffer_load_dwordx2 a[96:97], v208, s[16:19], s47 offen offset:0 sc1
    buffer_load_dwordx2 a[98:99], v208, s[16:19], s47 offen offset:512 sc1
    buffer_load_dwordx4 a[100:103], v129, s[16:19], s74 offen offset:0 sc1
    buffer_load_dwordx4 a[104:107], v129, s[16:19], s74 offen offset:1024 sc1
    buffer_load_dwordx4 a[108:111], v129, s[16:19], s74 offen offset:2048 sc1
    buffer_load_dwordx4 a[112:115], v129, s[16:19], s74 offen offset:3072 sc1
    buffer_load_dwordx2 a[116:117], v209, s[16:19], s47 offen offset:0 sc1
    buffer_load_dwordx2 a[118:119], v209, s[16:19], s47 offen offset:512 sc1
    buffer_load_dwordx4 a[120:123], v130, s[16:19], s74 offen offset:0 sc1
    buffer_load_dwordx4 a[124:127], v130, s[16:19], s74 offen offset:1024 sc1
    buffer_load_dwordx4 a[128:131], v130, s[16:19], s74 offen offset:2048 sc1
    buffer_load_dwordx4 a[132:135], v130, s[16:19], s74 offen offset:3072 sc1
    buffer_load_dwordx2 a[136:137], v210, s[16:19], s47 offen offset:0 sc1
    buffer_load_dwordx2 a[138:139], v210, s[16:19], s47 offen offset:512 sc1
    s_waitcnt vmcnt(30)
    v_mfma_f32_16x16x32_bf16 v[64:67], a[0:3], a[140:143], 0
    v_mfma_f32_16x16x32_bf16 v[68:71], a[4:7], a[140:143], 0
    v_mfma_f32_16x16x32_bf16 v[72:75], a[8:11], a[140:143], 0
    v_mfma_f32_16x16x32_bf16 v[76:79], a[12:15], a[140:143], 0
    v_mfma_f32_16x16x32_bf16 v[64:67], a[16:19], a[144:147], v[64:67]
    v_mfma_f32_16x16x32_bf16 v[68:71], a[20:23], a[144:147], v[68:71]
    v_mfma_f32_16x16x32_bf16 v[72:75], a[24:27], a[144:147], v[72:75]
    v_mfma_f32_16x16x32_bf16 v[76:79], a[28:31], a[144:147], v[76:79]
    v_mfma_f32_16x16x32_bf16 v[64:67], a[32:35], a[148:151], v[64:67]
    v_mfma_f32_16x16x32_bf16 v[68:71], a[36:39], a[148:151], v[68:71]
    v_mfma_f32_16x16x32_bf16 v[72:75], a[40:43], a[148:151], v[72:75]
    v_mfma_f32_16x16x32_bf16 v[76:79], a[44:47], a[148:151], v[76:79]
    v_mfma_f32_16x16x32_bf16 v[64:67], a[48:51], a[152:155], v[64:67]
    v_mfma_f32_16x16x32_bf16 v[68:71], a[52:55], a[152:155], v[68:71]
    v_mfma_f32_16x16x32_bf16 v[72:75], a[56:59], a[152:155], v[72:75]
    v_mfma_f32_16x16x32_bf16 v[76:79], a[60:63], a[152:155], v[76:79]
    v_mfma_f32_16x16x32_bf16 v[64:67], a[64:67], a[156:159], v[64:67]
    v_mfma_f32_16x16x32_bf16 v[68:71], a[68:71], a[156:159], v[68:71]
    v_mfma_f32_16x16x32_bf16 v[72:75], a[72:75], a[156:159], v[72:75]
    v_mfma_f32_16x16x32_bf16 v[76:79], a[76:79], a[156:159], v[76:79]
    s_waitcnt vmcnt(24)
    v_mfma_f32_16x16x32_bf16 v[80:83], a[0:3], a[160:163], 0
    v_mfma_f32_16x16x32_bf16 v[84:87], a[4:7], a[160:163], 0
    v_mfma_f32_16x16x32_bf16 v[88:91], a[8:11], a[160:163], 0
    v_mfma_f32_16x16x32_bf16 v[92:95], a[12:15], a[160:163], 0
    v_mfma_f32_16x16x32_bf16 v[80:83], a[16:19], a[164:167], v[80:83]
    v_mfma_f32_16x16x32_bf16 v[84:87], a[20:23], a[164:167], v[84:87]
    v_mfma_f32_16x16x32_bf16 v[88:91], a[24:27], a[164:167], v[88:91]
    v_mfma_f32_16x16x32_bf16 v[92:95], a[28:31], a[164:167], v[92:95]
    v_mfma_f32_16x16x32_bf16 v[80:83], a[32:35], a[168:171], v[80:83]
    v_mfma_f32_16x16x32_bf16 v[84:87], a[36:39], a[168:171], v[84:87]
    v_mfma_f32_16x16x32_bf16 v[88:91], a[40:43], a[168:171], v[88:91]
    v_mfma_f32_16x16x32_bf16 v[92:95], a[44:47], a[168:171], v[92:95]
    v_mfma_f32_16x16x32_bf16 v[80:83], a[48:51], a[172:175], v[80:83]
    v_mfma_f32_16x16x32_bf16 v[84:87], a[52:55], a[172:175], v[84:87]
    v_mfma_f32_16x16x32_bf16 v[88:91], a[56:59], a[172:175], v[88:91]
    v_mfma_f32_16x16x32_bf16 v[92:95], a[60:63], a[172:175], v[92:95]
    v_mfma_f32_16x16x32_bf16 v[80:83], a[64:67], a[176:179], v[80:83]
    v_mfma_f32_16x16x32_bf16 v[84:87], a[68:71], a[176:179], v[84:87]
    v_mfma_f32_16x16x32_bf16 v[88:91], a[72:75], a[176:179], v[88:91]
    v_mfma_f32_16x16x32_bf16 v[92:95], a[76:79], a[176:179], v[92:95]
    s_waitcnt vmcnt(18)
    v_mfma_f32_16x16x32_bf16 v[96:99], a[0:3], a[180:183], 0
    v_mfma_f32_16x16x32_bf16 v[100:103], a[4:7], a[180:183], 0
    v_mfma_f32_16x16x32_bf16 v[104:107], a[8:11], a[180:183], 0
    v_mfma_f32_16x16x32_bf16 v[108:111], a[12:15], a[180:183], 0
    v_mfma_f32_16x16x32_bf16 v[96:99], a[16:19], a[184:187], v[96:99]
    v_mfma_f32_16x16x32_bf16 v[100:103], a[20:23], a[184:187], v[100:103]
    v_mfma_f32_16x16x32_bf16 v[104:107], a[24:27], a[184:187], v[104:107]
    v_mfma_f32_16x16x32_bf16 v[108:111], a[28:31], a[184:187], v[108:111]
    v_mfma_f32_16x16x32_bf16 v[96:99], a[32:35], a[188:191], v[96:99]
    v_mfma_f32_16x16x32_bf16 v[100:103], a[36:39], a[188:191], v[100:103]
    v_mfma_f32_16x16x32_bf16 v[104:107], a[40:43], a[188:191], v[104:107]
    v_mfma_f32_16x16x32_bf16 v[108:111], a[44:47], a[188:191], v[108:111]
    v_mfma_f32_16x16x32_bf16 v[96:99], a[48:51], a[192:195], v[96:99]
    v_mfma_f32_16x16x32_bf16 v[100:103], a[52:55], a[192:195], v[100:103]
    v_mfma_f32_16x16x32_bf16 v[104:107], a[56:59], a[192:195], v[104:107]
    v_mfma_f32_16x16x32_bf16 v[108:111], a[60:63], a[192:195], v[108:111]
    v_mfma_f32_16x16x32_bf16 v[96:99], a[64:67], a[196:199], v[96:99]
    v_mfma_f32_16x16x32_bf16 v[100:103], a[68:71], a[196:199], v[100:103]
    v_mfma_f32_16x16x32_bf16 v[104:107], a[72:75], a[196:199], v[104:107]
    v_mfma_f32_16x16x32_bf16 v[108:111], a[76:79], a[196:199], v[108:111]
    s_waitcnt vmcnt(12)
    v_mfma_f32_16x16x32_bf16 v[24:27], a[8:11], a[80:83], 0
    v_mfma_f32_16x16x32_bf16 v[28:31], a[12:15], a[80:83], 0
    v_mfma_f32_16x16x32_bf16 v[24:27], a[24:27], a[84:87], v[24:27]
    v_mfma_f32_16x16x32_bf16 v[28:31], a[28:31], a[84:87], v[28:31]
    v_mfma_f32_16x16x32_bf16 v[24:27], a[40:43], a[88:91], v[24:27]
    v_mfma_f32_16x16x32_bf16 v[28:31], a[44:47], a[88:91], v[28:31]
    v_mfma_f32_16x16x32_bf16 v[24:27], a[56:59], a[92:95], v[24:27]
    v_mfma_f32_16x16x32_bf16 v[28:31], a[60:63], a[92:95], v[28:31]
    v_mfma_f32_16x16x32_bf16 v[24:27], a[72:75], a[96:99], v[24:27]
    ds_write_b128 v125, v[64:67] offset:0
    v_mfma_f32_16x16x32_bf16 v[28:31], a[76:79], a[96:99], v[28:31]
    s_waitcnt vmcnt(6)
    ds_write_b128 v125, v[68:71] offset:1024
    v_mfma_f32_16x16x32_bf16 v[40:43], a[8:11], a[100:103], 0
    v_mfma_f32_16x16x32_bf16 v[44:47], a[12:15], a[100:103], 0
    ds_write_b128 v126, v[72:75] offset:0
    v_mfma_f32_16x16x32_bf16 v[40:43], a[24:27], a[104:107], v[40:43]
    v_mfma_f32_16x16x32_bf16 v[44:47], a[28:31], a[104:107], v[44:47]
    ds_write_b128 v126, v[76:79] offset:1024
    v_mfma_f32_16x16x32_bf16 v[40:43], a[40:43], a[108:111], v[40:43]
    v_mfma_f32_16x16x32_bf16 v[44:47], a[44:47], a[108:111], v[44:47]
    ds_write_b128 v125, v[80:83] offset:2048
    v_mfma_f32_16x16x32_bf16 v[40:43], a[56:59], a[112:115], v[40:43]
    v_mfma_f32_16x16x32_bf16 v[44:47], a[60:63], a[112:115], v[44:47]
    ds_write_b128 v125, v[84:87] offset:3072
    v_mfma_f32_16x16x32_bf16 v[40:43], a[72:75], a[116:119], v[40:43]
    v_mfma_f32_16x16x32_bf16 v[44:47], a[76:79], a[116:119], v[44:47]
    ds_write_b128 v126, v[88:91] offset:2048
    s_waitcnt vmcnt(0)
    v_mfma_f32_16x16x32_bf16 v[56:59], a[8:11], a[120:123], 0
    ds_write_b128 v126, v[92:95] offset:3072
    v_mfma_f32_16x16x32_bf16 v[60:63], a[12:15], a[120:123], 0
    v_mfma_f32_16x16x32_bf16 v[56:59], a[24:27], a[124:127], v[56:59]
    ds_write_b128 v125, v[96:99] offset:4096
    v_mfma_f32_16x16x32_bf16 v[60:63], a[28:31], a[124:127], v[60:63]
    v_mfma_f32_16x16x32_bf16 v[56:59], a[40:43], a[128:131], v[56:59]
    ds_write_b128 v125, v[100:103] offset:5120
    v_mfma_f32_16x16x32_bf16 v[60:63], a[44:47], a[128:131], v[60:63]
    v_mfma_f32_16x16x32_bf16 v[56:59], a[56:59], a[132:135], v[56:59]
    ds_write_b128 v126, v[104:107] offset:4096
    v_mfma_f32_16x16x32_bf16 v[60:63], a[60:63], a[132:135], v[60:63]
    v_mfma_f32_16x16x32_bf16 v[56:59], a[72:75], a[136:139], v[56:59]
    ds_write_b128 v126, v[108:111] offset:5120
    v_mfma_f32_16x16x32_bf16 v[60:63], a[76:79], a[136:139], v[60:63]
    v_mfma_f32_16x16x32_bf16 v[16:19], a[0:3], a[80:83], 0
    v_mfma_f32_16x16x32_bf16 v[20:23], a[4:7], a[80:83], 0
    v_mfma_f32_16x16x32_bf16 v[16:19], a[16:19], a[84:87], v[16:19]
    v_mfma_f32_16x16x32_bf16 v[20:23], a[20:23], a[84:87], v[20:23]
    v_mfma_f32_16x16x32_bf16 v[16:19], a[32:35], a[88:91], v[16:19]
    v_mfma_f32_16x16x32_bf16 v[20:23], a[36:39], a[88:91], v[20:23]
    v_mfma_f32_16x16x32_bf16 v[16:19], a[48:51], a[92:95], v[16:19]
    v_mfma_f32_16x16x32_bf16 v[20:23], a[52:55], a[92:95], v[20:23]
    ds_write_b128 v124, v[24:27] offset:0
    v_mfma_f32_16x16x32_bf16 v[16:19], a[64:67], a[96:99], v[16:19]
    v_mfma_f32_16x16x32_bf16 v[20:23], a[68:71], a[96:99], v[20:23]
    v_mfma_f32_16x16x32_bf16 v[32:35], a[0:3], a[100:103], 0
    ds_write_b128 v124, v[28:31] offset:1024
    v_mfma_f32_16x16x32_bf16 v[36:39], a[4:7], a[100:103], 0
    v_mfma_f32_16x16x32_bf16 v[32:35], a[16:19], a[104:107], v[32:35]
    v_mfma_f32_16x16x32_bf16 v[36:39], a[20:23], a[104:107], v[36:39]
    ds_write_b128 v124, v[40:43] offset:2048
    v_mfma_f32_16x16x32_bf16 v[32:35], a[32:35], a[108:111], v[32:35]
    v_mfma_f32_16x16x32_bf16 v[36:39], a[36:39], a[108:111], v[36:39]
    v_mfma_f32_16x16x32_bf16 v[32:35], a[48:51], a[112:115], v[32:35]
    ds_write_b128 v124, v[44:47] offset:3072
    v_mfma_f32_16x16x32_bf16 v[36:39], a[52:55], a[112:115], v[36:39]
    v_mfma_f32_16x16x32_bf16 v[32:35], a[64:67], a[116:119], v[32:35]
    v_mfma_f32_16x16x32_bf16 v[36:39], a[68:71], a[116:119], v[36:39]
    ds_write_b128 v124, v[56:59] offset:4096
    v_mfma_f32_16x16x32_bf16 v[48:51], a[0:3], a[120:123], 0
    v_mfma_f32_16x16x32_bf16 v[52:55], a[4:7], a[120:123], 0
    v_mfma_f32_16x16x32_bf16 v[48:51], a[16:19], a[124:127], v[48:51]
    ds_write_b128 v124, v[60:63] offset:5120
    v_mfma_f32_16x16x32_bf16 v[52:55], a[20:23], a[124:127], v[52:55]
    v_mfma_f32_16x16x32_bf16 v[48:51], a[32:35], a[128:131], v[48:51]
    v_mfma_f32_16x16x32_bf16 v[52:55], a[36:39], a[128:131], v[52:55]
    v_mfma_f32_16x16x32_bf16 v[48:51], a[48:51], a[132:135], v[48:51]
    v_mfma_f32_16x16x32_bf16 v[52:55], a[52:55], a[132:135], v[52:55]
    v_mfma_f32_16x16x32_bf16 v[48:51], a[64:67], a[136:139], v[48:51]
    v_mfma_f32_16x16x32_bf16 v[52:55], a[68:71], a[136:139], v[52:55]
    s_waitcnt lgkmcnt(0)
    s_barrier
    ds_read_b128 v[136:139], v127 offset:0
    ds_read_b128 v[140:143], v127 offset:1024
    ds_read_b128 v[144:147], v127 offset:2048
    ds_read_b128 v[148:151], v127 offset:3072
    ds_read_b128 v[152:155], v127 offset:4096
    ds_read_b128 v[156:159], v127 offset:5120
    ds_read_b128 v[160:163], v127 offset:6144
    ds_read_b128 v[164:167], v127 offset:7168
    ds_read_b128 v[168:171], v127 offset:8192
    ds_read_b128 v[172:175], v127 offset:9216
    ds_read_b128 v[176:179], v127 offset:10240
    ds_read_b128 v[180:183], v127 offset:11264
    ds_read_b128 v[184:187], v127 offset:12288
    ds_read_b128 v[188:191], v127 offset:13312
    ds_read_b128 v[192:195], v127 offset:14336
    ds_read_b128 v[196:199], v127 offset:15360
    ds_read_b128 v[200:203], v127 offset:16384
    ds_read_b128 v[204:207], v127 offset:17408
    s_waitcnt lgkmcnt(12)
    v_pk_add_f32 v[16:17], v[16:17], v[136:137]
    v_pk_add_f32 v[18:19], v[18:19], v[138:139]
    v_pk_add_f32 v[20:21], v[20:21], v[140:141]
    v_pk_add_f32 v[22:23], v[22:23], v[142:143]
    v_pk_add_f32 v[32:33], v[32:33], v[144:145]
    v_pk_add_f32 v[34:35], v[34:35], v[146:147]
    v_pk_add_f32 v[36:37], v[36:37], v[148:149]
    v_pk_add_f32 v[38:39], v[38:39], v[150:151]
    v_pk_add_f32 v[48:49], v[48:49], v[152:153]
    v_pk_add_f32 v[50:51], v[50:51], v[154:155]
    v_pk_add_f32 v[52:53], v[52:53], v[156:157]
    v_pk_add_f32 v[54:55], v[54:55], v[158:159]
    s_waitcnt lgkmcnt(6)
    v_pk_add_f32 v[16:17], v[16:17], v[160:161]
    v_pk_add_f32 v[18:19], v[18:19], v[162:163]
    v_pk_add_f32 v[20:21], v[20:21], v[164:165]
    v_pk_add_f32 v[22:23], v[22:23], v[166:167]
    v_pk_add_f32 v[32:33], v[32:33], v[168:169]
    v_pk_add_f32 v[34:35], v[34:35], v[170:171]
    v_pk_add_f32 v[36:37], v[36:37], v[172:173]
    v_pk_add_f32 v[38:39], v[38:39], v[174:175]
    v_pk_add_f32 v[48:49], v[48:49], v[176:177]
    v_pk_add_f32 v[50:51], v[50:51], v[178:179]
    v_pk_add_f32 v[52:53], v[52:53], v[180:181]
    v_pk_add_f32 v[54:55], v[54:55], v[182:183]
    s_waitcnt lgkmcnt(0)
    v_pk_add_f32 v[16:17], v[16:17], v[184:185]
    v_pk_add_f32 v[18:19], v[18:19], v[186:187]
    v_pk_add_f32 v[20:21], v[20:21], v[188:189]
    v_pk_add_f32 v[22:23], v[22:23], v[190:191]
    v_pk_add_f32 v[32:33], v[32:33], v[192:193]
    v_pk_add_f32 v[34:35], v[34:35], v[194:195]
    v_pk_add_f32 v[36:37], v[36:37], v[196:197]
    v_pk_add_f32 v[38:39], v[38:39], v[198:199]
    v_pk_add_f32 v[48:49], v[48:49], v[200:201]
    v_pk_add_f32 v[50:51], v[50:51], v[202:203]
    v_pk_add_f32 v[52:53], v[52:53], v[204:205]
    v_pk_add_f32 v[54:55], v[54:55], v[206:207]
    s_add_u32 s20, s58, 9437184
    s_addc_u32 s21, s59, 0
    s_mov_b32 s22, 2621440
    s_mov_b32 s23, 0x20000
    s_mul_i32 s66, s100, 20
    s_lshl_b32 s67, s94, 1
    s_add_u32 s66, s66, s67
    s_and_b32 s67, s60, 1
    s_add_u32 s66, s66, s67
    s_lshl_b32 s67, s66, 10
    s_lshl_b32 s68, s100, 7
    s_add_u32 s68, s68, 16384
    s_cmp_lt_u32 s100, 128
    s_cselect_b32 s68, s68, 2146435072
    v_lshlrev_b32 v4, 4, v1
    v_and_b32 v5, 15, v1
    v_lshlrev_b32 v5, 3, v5
    v_bfe_u32 v6, v1, 4, 1
    v_cmp_eq_u32 s[82:83], 1, v6
    v_lshl_add_u32 v5, v6, 2, v5
    v_lshlrev_b32 v136, 16, v112
    v_and_b32 v137, 0xffff0000, v112
    v_pk_add_f32 v[16:17], v[16:17], v[136:137]
    v_lshlrev_b32 v136, 16, v113
    v_and_b32 v137, 0xffff0000, v113
    v_pk_add_f32 v[18:19], v[18:19], v[136:137]
    v_lshlrev_b32 v136, 16, v114
    v_and_b32 v137, 0xffff0000, v114
    v_pk_add_f32 v[20:21], v[20:21], v[136:137]
    v_lshlrev_b32 v136, 16, v115
    v_and_b32 v137, 0xffff0000, v115
    v_pk_add_f32 v[22:23], v[22:23], v[136:137]
    v_cvt_pk_bf16_f32 v148, v16, v17
    v_cvt_pk_bf16_f32 v149, v18, v19
    v_cvt_pk_bf16_f32 v150, v20, v21
    v_cvt_pk_bf16_f32 v151, v22, v23
    buffer_store_dwordx4 v[148:151], v4, s[20:23], s67 offen sc1
    s_add_u32 s67, s67, 20480
    v_lshlrev_b32 v136, 16, v116
    v_and_b32 v137, 0xffff0000, v116
    v_pk_add_f32 v[32:33], v[32:33], v[136:137]
    v_lshlrev_b32 v136, 16, v117
    v_and_b32 v137, 0xffff0000, v117
    v_pk_add_f32 v[34:35], v[34:35], v[136:137]
    v_lshlrev_b32 v136, 16, v118
    v_and_b32 v137, 0xffff0000, v118
    v_pk_add_f32 v[36:37], v[36:37], v[136:137]
    v_lshlrev_b32 v136, 16, v119
    v_and_b32 v137, 0xffff0000, v119
    v_pk_add_f32 v[38:39], v[38:39], v[136:137]
    v_cvt_pk_bf16_f32 v152, v32, v33
    v_cvt_pk_bf16_f32 v153, v34, v35
    v_cvt_pk_bf16_f32 v154, v36, v37
    v_cvt_pk_bf16_f32 v155, v38, v39
    buffer_store_dwordx4 v[152:155], v4, s[20:23], s67 offen sc1
    s_add_u32 s67, s67, 20480
    v_lshlrev_b32 v136, 16, v120
    v_and_b32 v137, 0xffff0000, v120
    v_pk_add_f32 v[48:49], v[48:49], v[136:137]
    v_lshlrev_b32 v136, 16, v121
    v_and_b32 v137, 0xffff0000, v121
    v_pk_add_f32 v[50:51], v[50:51], v[136:137]
    v_lshlrev_b32 v136, 16, v122
    v_and_b32 v137, 0xffff0000, v122
    v_pk_add_f32 v[52:53], v[52:53], v[136:137]
    v_lshlrev_b32 v136, 16, v123
    v_and_b32 v137, 0xffff0000, v123
    v_pk_add_f32 v[54:55], v[54:55], v[136:137]
    v_cvt_pk_bf16_f32 v156, v48, v49
    v_cvt_pk_bf16_f32 v157, v50, v51
    v_cvt_pk_bf16_f32 v158, v52, v53
    v_cvt_pk_bf16_f32 v159, v54, v55
    buffer_store_dwordx4 v[156:159], v4, s[20:23], s67 offen sc1
    v_pk_mul_f32 v[138:139], v[16:17], v[16:17]
    v_pk_add_f32 v[136:137], v[16:17], v[18:19]
    v_pk_fma_f32 v[138:139], v[18:19], v[18:19], v[138:139]
    v_pk_add_f32 v[136:137], v[136:137], v[20:21]
    v_pk_fma_f32 v[138:139], v[20:21], v[20:21], v[138:139]
    v_pk_add_f32 v[136:137], v[136:137], v[22:23]
    v_pk_fma_f32 v[138:139], v[22:23], v[22:23], v[138:139]
    v_add_f32 v136, v136, v137
    v_add_f32 v137, v138, v139
    v_mov_b32 v138, v136
    v_mov_b32 v139, v137
    s_nop 0
    v_permlane16_swap_b32 v136, v138
    v_permlane16_swap_b32 v137, v139
    v_pk_add_f32 v[136:137], v[136:137], v[138:139]
    v_mov_b32 v138, v136
    v_mov_b32 v139, v137
    s_nop 0
    v_permlane32_swap_b32 v136, v138
    v_permlane32_swap_b32 v137, v139
    v_pk_add_f32 v[136:137], v[136:137], v[138:139]
    v_cndmask_b32 v140, v136, v137, s[82:83]
    s_mov_b64 exec, 0xffffffff
    buffer_atomic_add_f32 v140, v5, s[24:27], s68 offen sc1
    s_mov_b64 exec, -1
    s_add_u32 s68, s68, 128
    s_cmp_lt_u32 s68, 32768
    s_cselect_b32 s68, s68, 2146435072
    v_pk_mul_f32 v[138:139], v[32:33], v[32:33]
    v_pk_add_f32 v[136:137], v[32:33], v[34:35]
    v_pk_fma_f32 v[138:139], v[34:35], v[34:35], v[138:139]
    v_pk_add_f32 v[136:137], v[136:137], v[36:37]
    v_pk_fma_f32 v[138:139], v[36:37], v[36:37], v[138:139]
    v_pk_add_f32 v[136:137], v[136:137], v[38:39]
    v_pk_fma_f32 v[138:139], v[38:39], v[38:39], v[138:139]
    v_add_f32 v136, v136, v137
    v_add_f32 v137, v138, v139
    v_mov_b32 v138, v136
    v_mov_b32 v139, v137
    s_nop 0
    v_permlane16_swap_b32 v136, v138
    v_permlane16_swap_b32 v137, v139
    v_pk_add_f32 v[136:137], v[136:137], v[138:139]
    v_mov_b32 v138, v136
    v_mov_b32 v139, v137
    s_nop 0
    v_permlane32_swap_b32 v136, v138
    v_permlane32_swap_b32 v137, v139
    v_pk_add_f32 v[136:137], v[136:137], v[138:139]
    v_cndmask_b32 v141, v136, v137, s[82:83]
    s_mov_b64 exec, 0xffffffff
    buffer_atomic_add_f32 v141, v5, s[24:27], s68 offen sc1
    s_mov_b64 exec, -1
    s_add_u32 s68, s68, 128
    s_cmp_lt_u32 s68, 32768
    s_cselect_b32 s68, s68, 2146435072
    v_pk_mul_f32 v[138:139], v[48:49], v[48:49]
    v_pk_add_f32 v[136:137], v[48:49], v[50:51]
    v_pk_fma_f32 v[138:139], v[50:51], v[50:51], v[138:139]
    v_pk_add_f32 v[136:137], v[136:137], v[52:53]
    v_pk_fma_f32 v[138:139], v[52:53], v[52:53], v[138:139]
    v_pk_add_f32 v[136:137], v[136:137], v[54:55]
    v_pk_fma_f32 v[138:139], v[54:55], v[54:55], v[138:139]
    v_add_f32 v136, v136, v137
    v_add_f32 v137, v138, v139
    v_mov_b32 v138, v136
    v_mov_b32 v139, v137
    s_nop 0
    v_permlane16_swap_b32 v136, v138
    v_permlane16_swap_b32 v137, v139
    v_pk_add_f32 v[136:137], v[136:137], v[138:139]
    v_mov_b32 v138, v136
    v_mov_b32 v139, v137
    s_nop 0
    v_permlane32_swap_b32 v136, v138
    v_permlane32_swap_b32 v137, v139
    v_pk_add_f32 v[136:137], v[136:137], v[138:139]
    v_cndmask_b32 v142, v136, v137, s[82:83]
    s_mov_b64 exec, 0xffffffff
    buffer_atomic_add_f32 v142, v5, s[24:27], s68 offen sc1
    s_mov_b64 exec, -1
    v_accvgpr_write_b32 a240, v148
    v_accvgpr_write_b32 a241, v149
    v_accvgpr_write_b32 a242, v150
    v_accvgpr_write_b32 a243, v151
    v_accvgpr_write_b32 a244, v152
    v_accvgpr_write_b32 a245, v153
    v_accvgpr_write_b32 a246, v154
    v_accvgpr_write_b32 a247, v155
    v_accvgpr_write_b32 a248, v156
    v_accvgpr_write_b32 a249, v157
    v_accvgpr_write_b32 a250, v158
    v_accvgpr_write_b32 a251, v159
    s_waitcnt vmcnt(0)
    s_barrier
    s_add_u32 s66, s95, 48
    s_cmp_lg_u32 s60, 0
    s_cbranch_scc1 L_sig_21
    s_lshl_b32 s71, s66, 7
    v_mov_b32 v4, s71
    v_mov_b32 v5, 1
    s_mov_b64 exec, 1
    buffer_atomic_add v5, v4, s[24:27], 0 offen sc1
    s_mov_b64 exec, -1
L_sig_21:
L_p3end_17:
    s_cmp_eq_u32 s99, 0
    s_cbranch_scc1 L_p4end_22
    s_lshl_b32 s46, s60, 3
    s_add_u32 s46, s46, 352
    s_mul_i32 s46, s46, 3456
    s_lshl_b32 s47, s98, 7
    s_add_u32 s46, s46, s47
    s_cmp_eq_u32 s99, 0
    s_cselect_b32 s46, 2146435072, s46
    s_lshl_b32 s47, s60, 11
    s_add_u32 m0, s47, 90112
    s_nop 0
    buffer_load_dwordx4 v8, s[8:11], s46 offen lds
    buffer_load_dwordx4 v8, s[12:15], s46 offen offset:1024 lds
    s_add_u32 s46, s46, 110592
    s_add_u32 m0, s47, 98304
    s_nop 0
    buffer_load_dwordx4 v8, s[8:11], s46 offen lds
    buffer_load_dwordx4 v8, s[12:15], s46 offen offset:1024 lds
    s_add_u32 s46, s46, 110592
    s_add_u32 m0, s47, 106496
    s_nop 0
    buffer_load_dwordx4 v8, s[8:11], s46 offen lds
    buffer_load_dwordx4 v8, s[12:15], s46 offen offset:1024 lds
    s_add_u32 s46, s46, 110592
    s_add_u32 m0, s47, 114688
    s_nop 0
    buffer_load_dwordx4 v8, s[8:11], s46 offen lds
    buffer_load_dwordx4 v8, s[12:15], s46 offen offset:1024 lds
    s_add_u32 s46, s46, 110592
    s_add_u32 m0, s47, 122880
    s_nop 0
    buffer_load_dwordx4 v8, s[8:11], s46 offen lds
    buffer_load_dwordx4 v8, s[12:15], s46 offen offset:1024 lds
    s_add_u32 s46, s46, 110592
    s_add_u32 m0, s47, 131072
    s_nop 0
    buffer_load_dwordx4 v8, s[8:11], s46 offen lds
    buffer_load_dwordx4 v8, s[12:15], s46 offen offset:1024 lds
    s_add_u32 s46, s46, 110592
    s_add_u32 m0, s47, 139264
    s_nop 0
    buffer_load_dwordx4 v8, s[8:11], s46 offen lds
    buffer_load_dwordx4 v8, s[12:15], s46 offen offset:1024 lds
    s_add_u32 s46, s46, 110592
    s_add_u32 m0, s47, 147456
    s_nop 0
    buffer_load_dwordx4 v8, s[8:11], s46 offen lds
    buffer_load_dwordx4 v8, s[12:15], s46 offen offset:1024 lds
    s_add_u32 s46, s46, 110592
    s_add_u32 m0, s47, 155648
    s_nop 0
    buffer_load_dwordx4 v8, s[8:11], s46 offen lds
    buffer_load_dwordx4 v8, s[12:15], s46 offen offset:1024 lds
    s_add_u32 s46, s46, 110592
    v_bfe_u32 v2, v1, 2, 2
    v_lshrrev_b32 v3, 4, v1
    v_lshl_add_u32 v2, v3, 2, v2
    v_bfe_u32 v3, v2, 1, 2
    v_and_b32 v4, 3, v1
    v_lshlrev_b32 v4, 3, v4
    v_and_b32 v5, 7, v2
    v_lshl_add_u32 v4, v5, 7, v4
    v_lshrrev_b32 v5, 3, v2
    v_lshl_add_u32 v2, v5, 11, v4
    v_xor_b32 v4, 0, v3
    v_lshl_add_u32 v248, v4, 5, v2
    v_xor_b32 v4, 1, v3
    v_lshl_add_u32 v249, v4, 5, v2
    v_xor_b32 v4, 2, v3
    v_lshl_add_u32 v250, v4, 5, v2
    v_xor_b32 v4, 3, v3
    v_lshl_add_u32 v251, v4, 5, v2
    s_add_u32 s16, s58, 9437184
    s_addc_u32 s17, s59, 0
    s_mov_b32 s18, 2621440
    s_mov_b32 s19, 0x20000
    v_lshlrev_b32 v4, 4, v1
    v_add_u32 v228, 0, v4
    v_add_u32 v229, 20480, v4
    v_add_u32 v230, 40960, v4
    v_add_u32 v231, 61440, v4
    s_lshl_b32 s66, s97, 4
    s_lshl_b32 s67, s60, 2
    s_add_u32 s81, s66, s67
    s_mul_i32 s74, s81, 20480
    v_and_b32 v3, 15, v1
    v_lshlrev_b32 v3, 3, v3
    v_mov_b32 v232, v3
    ds_read_b64_tr_b16 a[0:1], v248 offset:0
    ds_read_b64_tr_b16 a[2:3], v248 offset:4096
    ds_read_b64_tr_b16 a[4:5], v249 offset:0
    ds_read_b64_tr_b16 a[6:7], v249 offset:4096
    ds_read_b64_tr_b16 a[8:9], v250 offset:0
    ds_read_b64_tr_b16 a[10:11], v250 offset:4096
    ds_read_b64_tr_b16 a[12:13], v251 offset:0
    ds_read_b64_tr_b16 a[14:15], v251 offset:4096
    ds_read_b64_tr_b16 a[16:17], v248 offset:1024
    ds_read_b64_tr_b16 a[18:19], v248 offset:5120
    ds_read_b64_tr_b16 a[20:21], v249 offset:1024
    ds_read_b64_tr_b16 a[22:23], v249 offset:5120
    ds_read_b64_tr_b16 a[24:25], v250 offset:1024
    ds_read_b64_tr_b16 a[26:27], v250 offset:5120
    ds_read_b64_tr_b16 a[28:29], v251 offset:1024
    ds_read_b64_tr_b16 a[30:31], v251 offset:5120
    s_waitcnt vmcnt(0) lgkmcnt(0)
    s_barrier
    v_bfe_u32 v2, v1, 2, 2
    v_lshrrev_b32 v3, 4, v1
    v_lshl_add_u32 v2, v3, 2, v2
    v_bfe_u32 v3, v2, 1, 2
    v_xor_b32 v3, s60, v3
    v_and_b32 v4, 3, v1
    v_lshlrev_b32 v4, 3, v4
    v_and_b32 v5, 7, v2
    v_lshl_add_u32 v4, v5, 7, v4
    v_lshrrev_b32 v5, 3, v2
    v_lshl_add_u32 v2, v5, 11, v4
    v_lshl_add_u32 v6, v3, 5, v2
    v_add_u32 v6, 73728, v6
    v_mov_b32 v16, 0x3f803f80
    v_mov_b32 v17, 0x3f803f80
    v_mov_b32 v18, 0x3f803f80
    v_mov_b32 v19, 0x3f803f80
    ds_read_b64_tr_b16 v[20:21], v6 offset:0
    ds_read_b64_tr_b16 v[22:23], v6 offset:4096
    ds_read_b64_tr_b16 v[24:25], v6 offset:1024
    ds_read_b64_tr_b16 v[26:27], v6 offset:5120
    ds_read_b64_tr_b16 v[28:29], v6 offset:8192
    ds_read_b64_tr_b16 v[30:31], v6 offset:12288
    ds_read_b64_tr_b16 v[32:33], v6 offset:9216
    ds_read_b64_tr_b16 v[34:35], v6 offset:13312
    ds_read_b64_tr_b16 v[36:37], v6 offset:16384
    ds_read_b64_tr_b16 v[38:39], v6 offset:20480
    ds_read_b64_tr_b16 v[40:41], v6 offset:17408
    ds_read_b64_tr_b16 v[42:43], v6 offset:21504
    s_waitcnt lgkmcnt(8)
    v_mfma_f32_16x16x32_bf16 a[232:235], v[20:23], v[16:19], a[232:235]
    v_mfma_f32_16x16x32_bf16 a[236:239], v[24:27], v[16:19], a[236:239]
    ds_read_b64_tr_b16 v[20:21], v6 offset:24576
    ds_read_b64_tr_b16 v[22:23], v6 offset:28672
    ds_read_b64_tr_b16 v[24:25], v6 offset:25600
    ds_read_b64_tr_b16 v[26:27], v6 offset:29696
    s_waitcnt lgkmcnt(8)
    v_mfma_f32_16x16x32_bf16 a[232:235], v[28:31], v[16:19], a[232:235]
    v_mfma_f32_16x16x32_bf16 a[236:239], v[32:35], v[16:19], a[236:239]
    ds_read_b64_tr_b16 v[28:29], v6 offset:32768
    ds_read_b64_tr_b16 v[30:31], v6 offset:36864
    ds_read_b64_tr_b16 v[32:33], v6 offset:33792
    ds_read_b64_tr_b16 v[34:35], v6 offset:37888
    s_waitcnt lgkmcnt(8)
    v_mfma_f32_16x16x32_bf16 a[232:235], v[36:39], v[16:19], a[232:235]
    v_mfma_f32_16x16x32_bf16 a[236:239], v[40:43], v[16:19], a[236:239]
    ds_read_b64_tr_b16 v[36:37], v6 offset:40960
    ds_read_b64_tr_b16 v[38:39], v6 offset:45056
    ds_read_b64_tr_b16 v[40:41], v6 offset:41984
    ds_read_b64_tr_b16 v[42:43], v6 offset:46080
    s_waitcnt lgkmcnt(8)
    v_mfma_f32_16x16x32_bf16 a[232:235], v[20:23], v[16:19], a[232:235]
    v_mfma_f32_16x16x32_bf16 a[236:239], v[24:27], v[16:19], a[236:239]
    ds_read_b64_tr_b16 v[20:21], v6 offset:49152
    ds_read_b64_tr_b16 v[22:23], v6 offset:53248
    ds_read_b64_tr_b16 v[24:25], v6 offset:50176
    ds_read_b64_tr_b16 v[26:27], v6 offset:54272
    s_waitcnt lgkmcnt(8)
    v_mfma_f32_16x16x32_bf16 a[232:235], v[28:31], v[16:19], a[232:235]
    v_mfma_f32_16x16x32_bf16 a[236:239], v[32:35], v[16:19], a[236:239]
    v_add_u32 v6, 57344, v6
    ds_read_b64_tr_b16 v[28:29], v6 offset:0
    ds_read_b64_tr_b16 v[30:31], v6 offset:4096
    ds_read_b64_tr_b16 v[32:33], v6 offset:1024
    ds_read_b64_tr_b16 v[34:35], v6 offset:5120
    s_waitcnt lgkmcnt(8)
    v_mfma_f32_16x16x32_bf16 a[232:235], v[36:39], v[16:19], a[232:235]
    v_mfma_f32_16x16x32_bf16 a[236:239], v[40:43], v[16:19], a[236:239]
    ds_read_b64_tr_b16 v[36:37], v6 offset:8192
    ds_read_b64_tr_b16 v[38:39], v6 offset:12288
    ds_read_b64_tr_b16 v[40:41], v6 offset:9216
    ds_read_b64_tr_b16 v[42:43], v6 offset:13312
    s_waitcnt lgkmcnt(8)
    v_mfma_f32_16x16x32_bf16 a[232:235], v[20:23], v[16:19], a[232:235]
    v_mfma_f32_16x16x32_bf16 a[236:239], v[24:27], v[16:19], a[236:239]
    ds_read_b64_tr_b16 v[20:21], v6 offset:16384
    ds_read_b64_tr_b16 v[22:23], v6 offset:20480
    ds_read_b64_tr_b16 v[24:25], v6 offset:17408
    ds_read_b64_tr_b16 v[26:27], v6 offset:21504
    s_waitcnt lgkmcnt(8)
    v_mfma_f32_16x16x32_bf16 a[232:235], v[28:31], v[16:19], a[232:235]
    v_mfma_f32_16x16x32_bf16 a[236:239], v[32:35], v[16:19], a[236:239]
    ds_read_b64_tr_b16 v[28:29], v6 offset:24576
    ds_read_b64_tr_b16 v[30:31], v6 offset:28672
    ds_read_b64_tr_b16 v[32:33], v6 offset:25600
    ds_read_b64_tr_b16 v[34:35], v6 offset:29696
    s_waitcnt lgkmcnt(8)
    v_mfma_f32_16x16x32_bf16 a[232:235], v[36:39], v[16:19], a[232:235]
    v_mfma_f32_16x16x32_bf16 a[236:239], v[40:43], v[16:19], a[236:239]
    s_waitcnt lgkmcnt(4)
    v_mfma_f32_16x16x32_bf16 a[232:235], v[20:23], v[16:19], a[232:235]
    v_mfma_f32_16x16x32_bf16 a[236:239], v[24:27], v[16:19], a[236:239]
    s_waitcnt lgkmcnt(0)
    v_mfma_f32_16x16x32_bf16 a[232:235], v[28:31], v[16:19], a[232:235]
    v_mfma_f32_16x16x32_bf16 a[236:239], v[32:35], v[16:19], a[236:239]
    v_lshrrev_b32 v2, 4, v1
    v_lshlrev_b32 v2, 4, v2
    s_lshl_b32 s66, s60, 6
    v_add_u32 v3, s66, v2
    s_nop 2
    ds_write_b128 v3, a[232:235]
    ds_write_b128 v3, a[236:239] offset:256
    s_waitcnt lgkmcnt(0)
    s_barrier
    ds_read_b128 v[160:163], v2 offset:0
    ds_read_b128 v[164:167], v2 offset:64
    ds_read_b128 v[168:171], v2 offset:128
    ds_read_b128 v[172:175], v2 offset:192
    ds_read_b128 v[176:179], v2 offset:256
    ds_read_b128 v[180:183], v2 offset:320
    ds_read_b128 v[184:187], v2 offset:384
    ds_read_b128 v[188:191], v2 offset:448
    s_cmp_lg_u32 s60, 0
    s_cbranch_scc1 L_pskip_23
    s_lshl_b32 s66, s97, 4
    s_mul_i32 s67, s66, 43
    s_lshr_b32 s67, s67, 8
    s_add_u32 s66, s66, 15
    s_mul_i32 s66, s66, 43
    s_lshr_b32 s66, s66, 8
    v_add_u32 v2, s67, v1
    v_min_u32 v2, s66, v2
    v_add_u32 v2, 48, v2
    v_lshlrev_b32 v2, 7, v2
    s_mov_b64 exec, 15
    s_mov_b32 s71, 0
L_poll_24:
    buffer_load_dword v3, v2, s[24:27], 0 offen sc1
    s_add_u32 s71, s71, 1
    s_waitcnt vmcnt(0)
    v_cmp_gt_u32 vcc, 10, v3
    s_nop 4
    s_cbranch_vccz L_got_25
    s_cmp_lt_u32 s71, 0x40000
    s_cbranch_scc1 L_poll_24
L_got_25:
    s_mov_b64 exec, -1
L_pskip_23:
    s_barrier
    buffer_load_dwordx4 a[64:67], v228, s[16:19], s74 offen sc1
    buffer_load_dwordx4 a[68:71], v229, s[16:19], s74 offen sc1
    buffer_load_dwordx4 a[72:75], v230, s[16:19], s74 offen sc1
    buffer_load_dwordx4 a[76:79], v231, s[16:19], s74 offen sc1
    s_add_u32 s74, s74, 1024
    buffer_load_dwordx4 a[80:83], v228, s[16:19], s74 offen sc1
    buffer_load_dwordx4 a[84:87], v229, s[16:19], s74 offen sc1
    buffer_load_dwordx4 a[88:91], v230, s[16:19], s74 offen sc1
    buffer_load_dwordx4 a[92:95], v231, s[16:19], s74 offen sc1
    s_add_u32 s74, s74, 1024
    buffer_load_dwordx4 a[96:99], v228, s[16:19], s74 offen sc1
    buffer_load_dwordx4 a[100:103], v229, s[16:19], s74 offen sc1
    buffer_load_dwordx4 a[104:107], v230, s[16:19], s74 offen sc1
    buffer_load_dwordx4 a[108:111], v231, s[16:19], s74 offen sc1
    s_add_u32 s74, s74, 1024
    s_lshl_b32 s66, s81, 7
    s_add_u32 s66, s66, 16384
    buffer_load_dwordx2 v[208:209], v232, s[24:27], s66 offen offset:0 sc1
    buffer_load_dwordx2 v[210:211], v232, s[24:27], s66 offen offset:128 sc1
    buffer_load_dwordx2 v[212:213], v232, s[24:27], s66 offen offset:256 sc1
    buffer_load_dwordx2 v[214:215], v232, s[24:27], s66 offen offset:384 sc1
    s_mul_i32 s66, s60, 20480
    s_and_b32 s67, s60, 1
    s_lshl_b32 s67, s67, 1
    v_bfe_u32 v2, v1, 2, 2
    v_lshrrev_b32 v3, 4, v1
    v_lshl_add_u32 v2, v3, 2, v2
    v_bfe_u32 v3, v2, 1, 2
    v_and_b32 v4, 3, v1
    v_lshlrev_b32 v4, 3, v4
    v_lshl_add_u32 v2, v2, 7, v4
    v_add_u32 v2, s66, v2
    v_xor_b32 v3, s67, v3
    v_xor_b32 v4, 0, v3
    v_lshl_add_u32 v244, v4, 5, v2
    v_xor_b32 v4, 1, v3
    v_lshl_add_u32 v245, v4, 5, v2
    v_xor_b32 v4, 2, v3
    v_lshl_add_u32 v246, v4, 5, v2
    v_xor_b32 v4, 3, v3
    v_lshl_add_u32 v247, v4, 5, v2
    s_waitcnt vmcnt(12) lgkmcnt(0)
    v_mfma_f32_16x16x32_bf16 v[16:19], a[0:3], a[64:67], 0
    buffer_load_dwordx4 a[112:115], v228, s[16:19], s74 offen sc1
    ds_read_b64_tr_b16 a[32:33], v248 offset:8192
    v_mfma_f32_16x16x32_bf16 v[20:23], a[4:7], a[64:67], 0
    ds_read_b64_tr_b16 a[34:35], v248 offset:12288
    v_mfma_f32_16x16x32_bf16 v[24:27], a[8:11], a[64:67], 0
    ds_read_b64_tr_b16 a[36:37], v249 offset:8192
    v_mfma_f32_16x16x32_bf16 v[28:31], a[12:15], a[64:67], 0
    ds_read_b64_tr_b16 a[38:39], v249 offset:12288
    v_mfma_f32_16x16x32_bf16 v[32:35], a[16:19], a[64:67], 0
    buffer_load_dwordx4 a[116:119], v229, s[16:19], s74 offen sc1
    ds_read_b64_tr_b16 a[40:41], v250 offset:8192
    v_mfma_f32_16x16x32_bf16 v[36:39], a[20:23], a[64:67], 0
    ds_read_b64_tr_b16 a[42:43], v250 offset:12288
    v_mfma_f32_16x16x32_bf16 v[40:43], a[24:27], a[64:67], 0
    ds_read_b64_tr_b16 a[44:45], v251 offset:8192
    v_mfma_f32_16x16x32_bf16 v[44:47], a[28:31], a[64:67], 0
    ds_read_b64_tr_b16 a[46:47], v251 offset:12288
    v_mfma_f32_16x16x32_bf16 v[48:51], a[0:3], a[68:71], 0
    buffer_load_dwordx4 a[120:123], v230, s[16:19], s74 offen sc1
    ds_read_b64_tr_b16 a[48:49], v248 offset:9216
    v_mfma_f32_16x16x32_bf16 v[52:55], a[4:7], a[68:71], 0
    ds_read_b64_tr_b16 a[50:51], v248 offset:13312
    v_mfma_f32_16x16x32_bf16 v[56:59], a[8:11], a[68:71], 0
    ds_read_b64_tr_b16 a[52:53], v249 offset:9216
    v_mfma_f32_16x16x32_bf16 v[60:63], a[12:15], a[68:71], 0
    ds_read_b64_tr_b16 a[54:55], v249 offset:13312
    v_mfma_f32_16x16x32_bf16 v[64:67], a[16:19], a[68:71], 0
    buffer_load_dwordx4 a[124:127], v231, s[16:19], s74 offen sc1
    s_add_u32 s74, s74, 1024
    ds_read_b64_tr_b16 a[56:57], v250 offset:9216
    v_mfma_f32_16x16x32_bf16 v[68:71], a[20:23], a[68:71], 0
    ds_read_b64_tr_b16 a[58:59], v250 offset:13312
    v_mfma_f32_16x16x32_bf16 v[72:75], a[24:27], a[68:71], 0
    ds_read_b64_tr_b16 a[60:61], v251 offset:9216
    v_mfma_f32_16x16x32_bf16 v[76:79], a[28:31], a[68:71], 0
    ds_read_b64_tr_b16 a[62:63], v251 offset:13312
    v_mfma_f32_16x16x32_bf16 v[80:83], a[0:3], a[72:75], 0
    buffer_load_dwordx4 a[128:131], v228, s[16:19], s74 offen sc1
    v_mfma_f32_16x16x32_bf16 v[84:87], a[4:7], a[72:75], 0
    v_mfma_f32_16x16x32_bf16 v[88:91], a[8:11], a[72:75], 0
    v_mfma_f32_16x16x32_bf16 v[92:95], a[12:15], a[72:75], 0
    v_mfma_f32_16x16x32_bf16 v[96:99], a[16:19], a[72:75], 0
    buffer_load_dwordx4 a[132:135], v229, s[16:19], s74 offen sc1
    v_mfma_f32_16x16x32_bf16 v[100:103], a[20:23], a[72:75], 0
    v_mfma_f32_16x16x32_bf16 v[104:107], a[24:27], a[72:75], 0
    v_mfma_f32_16x16x32_bf16 v[108:111], a[28:31], a[72:75], 0
    v_mfma_f32_16x16x32_bf16 v[112:115], a[0:3], a[76:79], 0
    buffer_load_dwordx4 a[136:139], v230, s[16:19], s74 offen sc1
    v_mfma_f32_16x16x32_bf16 v[116:119], a[4:7], a[76:79], 0
    v_mfma_f32_16x16x32_bf16 v[120:123], a[8:11], a[76:79], 0
    v_mfma_f32_16x16x32_bf16 v[124:127], a[12:15], a[76:79], 0
    v_mfma_f32_16x16x32_bf16 v[128:131], a[16:19], a[76:79], 0
    buffer_load_dwordx4 a[140:143], v231, s[16:19], s74 offen sc1
    s_add_u32 s74, s74, 1024
    v_mfma_f32_16x16x32_bf16 v[132:135], a[20:23], a[76:79], 0
    v_mfma_f32_16x16x32_bf16 v[136:139], a[24:27], a[76:79], 0
    v_mfma_f32_16x16x32_bf16 v[140:143], a[28:31], a[76:79], 0
    s_waitcnt vmcnt(16) lgkmcnt(0)
    v_mfma_f32_16x16x32_bf16 v[16:19], a[32:35], a[80:83], v[16:19]
    buffer_load_dwordx4 a[64:67], v228, s[16:19], s74 offen sc1
    ds_read_b64_tr_b16 a[0:1], v248 offset:16384
    v_mfma_f32_16x16x32_bf16 v[20:23], a[36:39], a[80:83], v[20:23]
    ds_read_b64_tr_b16 a[2:3], v248 offset:20480
    v_mfma_f32_16x16x32_bf16 v[24:27], a[40:43], a[80:83], v[24:27]
    ds_read_b64_tr_b16 a[4:5], v249 offset:16384
    v_mfma_f32_16x16x32_bf16 v[28:31], a[44:47], a[80:83], v[28:31]
    ds_read_b64_tr_b16 a[6:7], v249 offset:20480
    v_mfma_f32_16x16x32_bf16 v[32:35], a[48:51], a[80:83], v[32:35]
    buffer_load_dwordx4 a[68:71], v229, s[16:19], s74 offen sc1
    ds_read_b64_tr_b16 a[8:9], v250 offset:16384
    v_mfma_f32_16x16x32_bf16 v[36:39], a[52:55], a[80:83], v[36:39]
    ds_read_b64_tr_b16 a[10:11], v250 offset:20480
    v_mfma_f32_16x16x32_bf16 v[40:43], a[56:59], a[80:83], v[40:43]
    ds_read_b64_tr_b16 a[12:13], v251 offset:16384
    v_mfma_f32_16x16x32_bf16 v[44:47], a[60:63], a[80:83], v[44:47]
    ds_read_b64_tr_b16 a[14:15], v251 offset:20480
    v_mfma_f32_16x16x32_bf16 v[48:51], a[32:35], a[84:87], v[48:51]
    buffer_load_dwordx4 a[72:75], v230, s[16:19], s74 offen sc1
    ds_read_b64_tr_b16 a[16:17], v248 offset:17408
    v_mfma_f32_16x16x32_bf16 v[52:55], a[36:39], a[84:87], v[52:55]
    ds_read_b64_tr_b16 a[18:19], v248 offset:21504
    v_mfma_f32_16x16x32_bf16 v[56:59], a[40:43], a[84:87], v[56:59]
    ds_read_b64_tr_b16 a[20:21], v249 offset:17408
    v_mfma_f32_16x16x32_bf16 v[60:63], a[44:47], a[84:87], v[60:63]
    ds_read_b64_tr_b16 a[22:23], v249 offset:21504
    v_mfma_f32_16x16x32_bf16 v[64:67], a[48:51], a[84:87], v[64:67]
    buffer_load_dwordx4 a[76:79], v231, s[16:19], s74 offen sc1
    s_add_u32 s74, s74, 1024
    ds_read_b64_tr_b16 a[24:25], v250 offset:17408
    v_mfma_f32_16x16x32_bf16 v[68:71], a[52:55], a[84:87], v[68:71]
    ds_read_b64_tr_b16 a[26:27], v250 offset:21504
    v_mfma_f32_16x16x32_bf16 v[72:75], a[56:59], a[84:87], v[72:75]
    ds_read_b64_tr_b16 a[28:29], v251 offset:17408
    v_mfma_f32_16x16x32_bf16 v[76:79], a[60:63], a[84:87], v[76:79]
    ds_read_b64_tr_b16 a[30:31], v251 offset:21504
    v_mfma_f32_16x16x32_bf16 v[80:83], a[32:35], a[88:91], v[80:83]
    v_mfma_f32_16x16x32_bf16 v[84:87], a[36:39], a[88:91], v[84:87]
    v_mfma_f32_16x16x32_bf16 v[88:91], a[40:43], a[88:91], v[88:91]
    v_mfma_f32_16x16x32_bf16 v[92:95], a[44:47], a[88:91], v[92:95]
    v_mfma_f32_16x16x32_bf16 v[96:99], a[48:51], a[88:91], v[96:99]
    v_mfma_f32_16x16x32_bf16 v[100:103], a[52:55], a[88:91], v[100:103]
    v_mfma_f32_16x16x32_bf16 v[104:107], a[56:59], a[88:91], v[104:107]
    v_mfma_f32_16x16x32_bf16 v[108:111], a[60:63], a[88:91], v[108:111]
    v_mfma_f32_16x16x32_bf16 v[112:115], a[32:35], a[92:95], v[112:115]
    v_mfma_f32_16x16x32_bf16 v[116:119], a[36:39], a[92:95], v[116:119]
    v_mfma_f32_16x16x32_bf16 v[120:123], a[40:43], a[92:95], v[120:123]
    v_mfma_f32_16x16x32_bf16 v[124:127], a[44:47], a[92:95], v[124:127]
    v_mfma_f32_16x16x32_bf16 v[128:131], a[48:51], a[92:95], v[128:131]
    v_mfma_f32_16x16x32_bf16 v[132:135], a[52:55], a[92:95], v[132:135]
    v_mfma_f32_16x16x32_bf16 v[136:139], a[56:59], a[92:95], v[136:139]
    v_mfma_f32_16x16x32_bf16 v[140:143], a[60:63], a[92:95], v[140:143]
    s_waitcnt vmcnt(16) lgkmcnt(0)
    v_mfma_f32_16x16x32_bf16 v[16:19], a[0:3], a[96:99], v[16:19]
    buffer_load_dwordx4 a[80:83], v228, s[16:19], s74 offen sc1
    ds_read_b64_tr_b16 a[32:33], v248 offset:24576
    v_mfma_f32_16x16x32_bf16 v[20:23], a[4:7], a[96:99], v[20:23]
    ds_read_b64_tr_b16 a[34:35], v248 offset:28672
    v_mfma_f32_16x16x32_bf16 v[24:27], a[8:11], a[96:99], v[24:27]
    ds_read_b64_tr_b16 a[36:37], v249 offset:24576
    v_mfma_f32_16x16x32_bf16 v[28:31], a[12:15], a[96:99], v[28:31]
    ds_read_b64_tr_b16 a[38:39], v249 offset:28672
    v_mfma_f32_16x16x32_bf16 v[32:35], a[16:19], a[96:99], v[32:35]
    buffer_load_dwordx4 a[84:87], v229, s[16:19], s74 offen sc1
    ds_read_b64_tr_b16 a[40:41], v250 offset:24576
    v_mfma_f32_16x16x32_bf16 v[36:39], a[20:23], a[96:99], v[36:39]
    ds_read_b64_tr_b16 a[42:43], v250 offset:28672
    v_mfma_f32_16x16x32_bf16 v[40:43], a[24:27], a[96:99], v[40:43]
    ds_read_b64_tr_b16 a[44:45], v251 offset:24576
    v_mfma_f32_16x16x32_bf16 v[44:47], a[28:31], a[96:99], v[44:47]
    ds_read_b64_tr_b16 a[46:47], v251 offset:28672
    v_mfma_f32_16x16x32_bf16 v[48:51], a[0:3], a[100:103], v[48:51]
    buffer_load_dwordx4 a[88:91], v230, s[16:19], s74 offen sc1
    ds_read_b64_tr_b16 a[48:49], v248 offset:25600
    v_mfma_f32_16x16x32_bf16 v[52:55], a[4:7], a[100:103], v[52:55]
    ds_read_b64_tr_b16 a[50:51], v248 offset:29696
    v_mfma_f32_16x16x32_bf16 v[56:59], a[8:11], a[100:103], v[56:59]
    ds_read_b64_tr_b16 a[52:53], v249 offset:25600
    v_mfma_f32_16x16x32_bf16 v[60:63], a[12:15], a[100:103], v[60:63]
    ds_read_b64_tr_b16 a[54:55], v249 offset:29696
    v_mfma_f32_16x16x32_bf16 v[64:67], a[16:19], a[100:103], v[64:67]
    buffer_load_dwordx4 a[92:95], v231, s[16:19], s74 offen sc1
    s_add_u32 s74, s74, 1024
    ds_read_b64_tr_b16 a[56:57], v250 offset:25600
    v_mfma_f32_16x16x32_bf16 v[68:71], a[20:23], a[100:103], v[68:71]
    ds_read_b64_tr_b16 a[58:59], v250 offset:29696
    v_mfma_f32_16x16x32_bf16 v[72:75], a[24:27], a[100:103], v[72:75]
    ds_read_b64_tr_b16 a[60:61], v251 offset:25600
    v_mfma_f32_16x16x32_bf16 v[76:79], a[28:31], a[100:103], v[76:79]
    ds_read_b64_tr_b16 a[62:63], v251 offset:29696
    v_mfma_f32_16x16x32_bf16 v[80:83], a[0:3], a[104:107], v[80:83]
    v_mfma_f32_16x16x32_bf16 v[84:87], a[4:7], a[104:107], v[84:87]
    v_mfma_f32_16x16x32_bf16 v[88:91], a[8:11], a[104:107], v[88:91]
    v_mfma_f32_16x16x32_bf16 v[92:95], a[12:15], a[104:107], v[92:95]
    v_mfma_f32_16x16x32_bf16 v[96:99], a[16:19], a[104:107], v[96:99]
    v_mfma_f32_16x16x32_bf16 v[100:103], a[20:23], a[104:107], v[100:103]
    v_mfma_f32_16x16x32_bf16 v[104:107], a[24:27], a[104:107], v[104:107]
    v_mfma_f32_16x16x32_bf16 v[108:111], a[28:31], a[104:107], v[108:111]
    v_mfma_f32_16x16x32_bf16 v[112:115], a[0:3], a[108:111], v[112:115]
    v_mfma_f32_16x16x32_bf16 v[116:119], a[4:7], a[108:111], v[116:119]
    v_mfma_f32_16x16x32_bf16 v[120:123], a[8:11], a[108:111], v[120:123]
    v_mfma_f32_16x16x32_bf16 v[124:127], a[12:15], a[108:111], v[124:127]
    v_mfma_f32_16x16x32_bf16 v[128:131], a[16:19], a[108:111], v[128:131]
    v_mfma_f32_16x16x32_bf16 v[132:135], a[20:23], a[108:111], v[132:135]
    v_mfma_f32_16x16x32_bf16 v[136:139], a[24:27], a[108:111], v[136:139]
    v_mfma_f32_16x16x32_bf16 v[140:143], a[28:31], a[108:111], v[140:143]
    s_waitcnt vmcnt(12) lgkmcnt(0)
    s_waitcnt vmcnt(16)
    v_mfma_f32_16x16x32_bf16 v[16:19], a[32:35], a[112:115], v[16:19]
    buffer_load_dwordx4 a[96:99], v228, s[16:19], s74 offen sc1
    ds_read_b64_tr_b16 a[0:1], v248 offset:32768
    ds_read_b64_tr_b16 a[2:3], v248 offset:36864
    v_mfma_f32_16x16x32_bf16 v[20:23], a[36:39], a[112:115], v[20:23]
    ds_read_b64_tr_b16 a[4:5], v249 offset:32768
    v_mfma_f32_16x16x32_bf16 v[24:27], a[40:43], a[112:115], v[24:27]
    ds_read_b64_tr_b16 a[6:7], v249 offset:36864
    ds_read_b64_tr_b16 a[8:9], v250 offset:32768
    v_mfma_f32_16x16x32_bf16 v[28:31], a[44:47], a[112:115], v[28:31]
    ds_read_b64_tr_b16 a[10:11], v250 offset:36864
    v_mfma_f32_16x16x32_bf16 v[32:35], a[48:51], a[112:115], v[32:35]
    buffer_load_dwordx4 a[100:103], v229, s[16:19], s74 offen sc1
    ds_read_b64_tr_b16 a[12:13], v251 offset:32768
    ds_read_b64_tr_b16 a[14:15], v251 offset:36864
    v_mfma_f32_16x16x32_bf16 v[36:39], a[52:55], a[112:115], v[36:39]
    ds_read_b64_tr_b16 a[16:17], v248 offset:33792
    v_mfma_f32_16x16x32_bf16 v[40:43], a[56:59], a[112:115], v[40:43]
    ds_read_b64_tr_b16 a[18:19], v248 offset:37888
    v_mfma_f32_16x16x32_bf16 v[44:47], a[60:63], a[112:115], v[44:47]
    ds_read_b64_tr_b16 a[20:21], v249 offset:33792
    ds_read_b64_tr_b16 a[22:23], v249 offset:37888
    v_mfma_f32_16x16x32_bf16 v[48:51], a[32:35], a[116:119], v[48:51]
    buffer_load_dwordx4 a[104:107], v230, s[16:19], s74 offen sc1
    ds_read_b64_tr_b16 a[24:25], v250 offset:33792
    v_mfma_f32_16x16x32_bf16 v[52:55], a[36:39], a[116:119], v[52:55]
    ds_read_b64_tr_b16 a[26:27], v250 offset:37888
    ds_read_b64_tr_b16 a[28:29], v251 offset:33792
    v_mfma_f32_16x16x32_bf16 v[56:59], a[40:43], a[116:119], v[56:59]
    ds_read_b64_tr_b16 a[30:31], v251 offset:37888
    v_mfma_f32_16x16x32_bf16 v[60:63], a[44:47], a[116:119], v[60:63]
    v_mul_f32 v192, 0.0015625, v208
    v_mul_f32 v209, 0.0015625, v209
    v_mfma_f32_16x16x32_bf16 v[64:67], a[48:51], a[116:119], v[64:67]
    buffer_load_dwordx4 a[108:111], v231, s[16:19], s74 offen sc1
    s_add_u32 s74, s74, 1024
    v_mul_f32 v194, 0.0015625, v210
    v_mfma_f32_16x16x32_bf16 v[68:71], a[52:55], a[116:119], v[68:71]
    v_mul_f32 v211, 0.0015625, v211
    v_mfma_f32_16x16x32_bf16 v[72:75], a[56:59], a[116:119], v[72:75]
    v_mul_f32 v196, 0.0015625, v212
    v_mul_f32 v213, 0.0015625, v213
    v_mfma_f32_16x16x32_bf16 v[76:79], a[60:63], a[116:119], v[76:79]
    v_mul_f32 v198, 0.0015625, v214
    v_mfma_f32_16x16x32_bf16 v[80:83], a[32:35], a[120:123], v[80:83]
    v_mul_f32 v215, 0.0015625, v215
    v_fma_f32 v209, -v192, v192, v209
    v_mfma_f32_16x16x32_bf16 v[84:87], a[36:39], a[120:123], v[84:87]
    v_fma_f32 v211, -v194, v194, v211
    v_mfma_f32_16x16x32_bf16 v[88:91], a[40:43], a[120:123], v[88:91]
    v_fma_f32 v213, -v196, v196, v213
    v_fma_f32 v215, -v198, v198, v215
    v_mfma_f32_16x16x32_bf16 v[92:95], a[44:47], a[120:123], v[92:95]
    v_max_f32 v209, 0, v209
    v_mfma_f32_16x16x32_bf16 v[96:99], a[48:51], a[120:123], v[96:99]
    v_max_f32 v211, 0, v211
    v_mfma_f32_16x16x32_bf16 v[100:103], a[52:55], a[120:123], v[100:103]
    v_max_f32 v213, 0, v213
    v_max_f32 v215, 0, v215
    v_mfma_f32_16x16x32_bf16 v[104:107], a[56:59], a[120:123], v[104:107]
    v_add_f32 v209, 0x3727c5ac, v209
    v_mfma_f32_16x16x32_bf16 v[108:111], a[60:63], a[120:123], v[108:111]
    v_add_f32 v211, 0x3727c5ac, v211
    v_add_f32 v213, 0x3727c5ac, v213
    v_mfma_f32_16x16x32_bf16 v[112:115], a[32:35], a[124:127], v[112:115]
    v_add_f32 v215, 0x3727c5ac, v215
    v_mfma_f32_16x16x32_bf16 v[116:119], a[36:39], a[124:127], v[116:119]
    v_rcp_f32 v200, v209
    v_rcp_f32 v202, v211
    v_mfma_f32_16x16x32_bf16 v[120:123], a[40:43], a[124:127], v[120:123]
    v_rcp_f32 v204, v213
    v_mfma_f32_16x16x32_bf16 v[124:127], a[44:47], a[124:127], v[124:127]
    v_rcp_f32 v206, v215
    v_mfma_f32_16x16x32_bf16 v[128:131], a[48:51], a[124:127], v[128:131]
    v_mfma_f32_16x16x32_bf16 v[132:135], a[52:55], a[124:127], v[132:135]
    v_mfma_f32_16x16x32_bf16 v[136:139], a[56:59], a[124:127], v[136:139]
    v_mfma_f32_16x16x32_bf16 v[140:143], a[60:63], a[124:127], v[140:143]
    s_waitcnt vmcnt(12) lgkmcnt(0)
    v_mfma_f32_16x16x32_bf16 v[16:19], a[0:3], a[128:131], v[16:19]
    buffer_load_dwordx4 a[112:115], v228, s[16:19], s74 offen sc1
    ds_read_b64_tr_b16 a[32:33], v248 offset:40960
    v_mfma_f32_16x16x32_bf16 v[20:23], a[4:7], a[128:131], v[20:23]
    ds_read_b64_tr_b16 a[34:35], v248 offset:45056
    v_mfma_f32_16x16x32_bf16 v[24:27], a[8:11], a[128:131], v[24:27]
    ds_read_b64_tr_b16 a[36:37], v249 offset:40960
    v_mfma_f32_16x16x32_bf16 v[28:31], a[12:15], a[128:131], v[28:31]
    ds_read_b64_tr_b16 a[38:39], v249 offset:45056
    v_mfma_f32_16x16x32_bf16 v[32:35], a[16:19], a[128:131], v[32:35]
    buffer_load_dwordx4 a[116:119], v229, s[16:19], s74 offen sc1
    ds_read_b64_tr_b16 a[40:41], v250 offset:40960
    v_mfma_f32_16x16x32_bf16 v[36:39], a[20:23], a[128:131], v[36:39]
    ds_read_b64_tr_b16 a[42:43], v250 offset:45056
    v_mfma_f32_16x16x32_bf16 v[40:43], a[24:27], a[128:131], v[40:43]
    ds_read_b64_tr_b16 a[44:45], v251 offset:40960
    v_mfma_f32_16x16x32_bf16 v[44:47], a[28:31], a[128:131], v[44:47]
    ds_read_b64_tr_b16 a[46:47], v251 offset:45056
    v_mfma_f32_16x16x32_bf16 v[48:51], a[0:3], a[132:135], v[48:51]
    buffer_load_dwordx4 a[120:123], v230, s[16:19], s74 offen sc1
    ds_read_b64_tr_b16 a[48:49], v248 offset:41984
    v_mfma_f32_16x16x32_bf16 v[52:55], a[4:7], a[132:135], v[52:55]
    ds_read_b64_tr_b16 a[50:51], v248 offset:46080
    v_mfma_f32_16x16x32_bf16 v[56:59], a[8:11], a[132:135], v[56:59]
    ds_read_b64_tr_b16 a[52:53], v249 offset:41984
    v_mfma_f32_16x16x32_bf16 v[60:63], a[12:15], a[132:135], v[60:63]
    ds_read_b64_tr_b16 a[54:55], v249 offset:46080
    v_mfma_f32_16x16x32_bf16 v[64:67], a[16:19], a[132:135], v[64:67]
    buffer_load_dwordx4 a[124:127], v231, s[16:19], s74 offen sc1
    s_add_u32 s74, s74, 1024
    ds_read_b64_tr_b16 a[56:57], v250 offset:41984
    v_mfma_f32_16x16x32_bf16 v[68:71], a[20:23], a[132:135], v[68:71]
    ds_read_b64_tr_b16 a[58:59], v250 offset:46080
    v_mfma_f32_16x16x32_bf16 v[72:75], a[24:27], a[132:135], v[72:75]
    ds_read_b64_tr_b16 a[60:61], v251 offset:41984
    v_mfma_f32_16x16x32_bf16 v[76:79], a[28:31], a[132:135], v[76:79]
    ds_read_b64_tr_b16 a[62:63], v251 offset:46080
    v_mfma_f32_16x16x32_bf16 v[80:83], a[0:3], a[136:139], v[80:83]
    v_mfma_f32_16x16x32_bf16 v[84:87], a[4:7], a[136:139], v[84:87]
    v_mfma_f32_16x16x32_bf16 v[88:91], a[8:11], a[136:139], v[88:91]
    v_mfma_f32_16x16x32_bf16 v[92:95], a[12:15], a[136:139], v[92:95]
    v_mfma_f32_16x16x32_bf16 v[96:99], a[16:19], a[136:139], v[96:99]
    v_mfma_f32_16x16x32_bf16 v[100:103], a[20:23], a[136:139], v[100:103]
    v_mfma_f32_16x16x32_bf16 v[104:107], a[24:27], a[136:139], v[104:107]
    v_mfma_f32_16x16x32_bf16 v[108:111], a[28:31], a[136:139], v[108:111]
    v_mfma_f32_16x16x32_bf16 v[112:115], a[0:3], a[140:143], v[112:115]
    v_mfma_f32_16x16x32_bf16 v[116:119], a[4:7], a[140:143], v[116:119]
    v_mfma_f32_16x16x32_bf16 v[120:123], a[8:11], a[140:143], v[120:123]
    v_mfma_f32_16x16x32_bf16 v[124:127], a[12:15], a[140:143], v[124:127]
    v_mfma_f32_16x16x32_bf16 v[128:131], a[16:19], a[140:143], v[128:131]
    v_mfma_f32_16x16x32_bf16 v[132:135], a[20:23], a[140:143], v[132:135]
    v_mfma_f32_16x16x32_bf16 v[136:139], a[24:27], a[140:143], v[136:139]
    v_mfma_f32_16x16x32_bf16 v[140:143], a[28:31], a[140:143], v[140:143]
    s_waitcnt vmcnt(12) lgkmcnt(0)
    v_mfma_f32_16x16x32_bf16 v[16:19], a[32:35], a[64:67], v[16:19]
    buffer_load_dwordx4 a[128:131], v228, s[16:19], s74 offen sc1
    ds_read_b64_tr_b16 a[0:1], v248 offset:49152
    v_mfma_f32_16x16x32_bf16 v[20:23], a[36:39], a[64:67], v[20:23]
    ds_read_b64_tr_b16 a[2:3], v248 offset:53248
    v_mfma_f32_16x16x32_bf16 v[24:27], a[40:43], a[64:67], v[24:27]
    ds_read_b64_tr_b16 a[4:5], v249 offset:49152
    v_mfma_f32_16x16x32_bf16 v[28:31], a[44:47], a[64:67], v[28:31]
    ds_read_b64_tr_b16 a[6:7], v249 offset:53248
    v_mfma_f32_16x16x32_bf16 v[32:35], a[48:51], a[64:67], v[32:35]
    buffer_load_dwordx4 a[132:135], v229, s[16:19], s74 offen sc1
    ds_read_b64_tr_b16 a[8:9], v250 offset:49152
    v_mfma_f32_16x16x32_bf16 v[36:39], a[52:55], a[64:67], v[36:39]
    ds_read_b64_tr_b16 a[10:11], v250 offset:53248
    v_mfma_f32_16x16x32_bf16 v[40:43], a[56:59], a[64:67], v[40:43]
    ds_read_b64_tr_b16 a[12:13], v251 offset:49152
    v_mfma_f32_16x16x32_bf16 v[44:47], a[60:63], a[64:67], v[44:47]
    ds_read_b64_tr_b16 a[14:15], v251 offset:53248
    v_mfma_f32_16x16x32_bf16 v[48:51], a[32:35], a[68:71], v[48:51]
    buffer_load_dwordx4 a[136:139], v230, s[16:19], s74 offen sc1
    ds_read_b64_tr_b16 a[16:17], v248 offset:50176
    v_mfma_f32_16x16x32_bf16 v[52:55], a[36:39], a[68:71], v[52:55]
    ds_read_b64_tr_b16 a[18:19], v248 offset:54272
    v_mfma_f32_16x16x32_bf16 v[56:59], a[40:43], a[68:71], v[56:59]
    ds_read_b64_tr_b16 a[20:21], v249 offset:50176
    v_mfma_f32_16x16x32_bf16 v[60:63], a[44:47], a[68:71], v[60:63]
    ds_read_b64_tr_b16 a[22:23], v249 offset:54272
    v_mfma_f32_16x16x32_bf16 v[64:67], a[48:51], a[68:71], v[64:67]
    buffer_load_dwordx4 a[140:143], v231, s[16:19], s74 offen sc1
    s_add_u32 s74, s74, 1024
    ds_read_b64_tr_b16 a[24:25], v250 offset:50176
    v_mfma_f32_16x16x32_bf16 v[68:71], a[52:55], a[68:71], v[68:71]
    ds_read_b64_tr_b16 a[26:27], v250 offset:54272
    v_mfma_f32_16x16x32_bf16 v[72:75], a[56:59], a[68:71], v[72:75]
    ds_read_b64_tr_b16 a[28:29], v251 offset:50176
    v_mfma_f32_16x16x32_bf16 v[76:79], a[60:63], a[68:71], v[76:79]
    ds_read_b64_tr_b16 a[30:31], v251 offset:54272
    v_mfma_f32_16x16x32_bf16 v[80:83], a[32:35], a[72:75], v[80:83]
    v_mfma_f32_16x16x32_bf16 v[84:87], a[36:39], a[72:75], v[84:87]
    v_mfma_f32_16x16x32_bf16 v[88:91], a[40:43], a[72:75], v[88:91]
    v_mfma_f32_16x16x32_bf16 v[92:95], a[44:47], a[72:75], v[92:95]
    v_mfma_f32_16x16x32_bf16 v[96:99], a[48:51], a[72:75], v[96:99]
    v_mfma_f32_16x16x32_bf16 v[100:103], a[52:55], a[72:75], v[100:103]
    v_mfma_f32_16x16x32_bf16 v[104:107], a[56:59], a[72:75], v[104:107]
    v_mfma_f32_16x16x32_bf16 v[108:111], a[60:63], a[72:75], v[108:111]
    v_mfma_f32_16x16x32_bf16 v[112:115], a[32:35], a[76:79], v[112:115]
    v_mfma_f32_16x16x32_bf16 v[116:119], a[36:39], a[76:79], v[116:119]
    v_mfma_f32_16x16x32_bf16 v[120:123], a[40:43], a[76:79], v[120:123]
    v_mfma_f32_16x16x32_bf16 v[124:127], a[44:47], a[76:79], v[124:127]
    v_mfma_f32_16x16x32_bf16 v[128:131], a[48:51], a[76:79], v[128:131]
    v_mfma_f32_16x16x32_bf16 v[132:135], a[52:55], a[76:79], v[132:135]
    v_mfma_f32_16x16x32_bf16 v[136:139], a[56:59], a[76:79], v[136:139]
    v_mfma_f32_16x16x32_bf16 v[140:143], a[60:63], a[76:79], v[140:143]
    s_waitcnt vmcnt(12) lgkmcnt(0)
    v_mfma_f32_16x16x32_bf16 v[16:19], a[0:3], a[80:83], v[16:19]
    buffer_load_dwordx4 a[64:67], v228, s[16:19], s74 offen sc1
    ds_read_b64_tr_b16 a[32:33], v248 offset:57344
    v_mfma_f32_16x16x32_bf16 v[20:23], a[4:7], a[80:83], v[20:23]
    ds_read_b64_tr_b16 a[34:35], v248 offset:61440
    v_mfma_f32_16x16x32_bf16 v[24:27], a[8:11], a[80:83], v[24:27]
    ds_read_b64_tr_b16 a[36:37], v249 offset:57344
    v_mfma_f32_16x16x32_bf16 v[28:31], a[12:15], a[80:83], v[28:31]
    ds_read_b64_tr_b16 a[38:39], v249 offset:61440
    v_mfma_f32_16x16x32_bf16 v[32:35], a[16:19], a[80:83], v[32:35]
    buffer_load_dwordx4 a[68:71], v229, s[16:19], s74 offen sc1
    ds_read_b64_tr_b16 a[40:41], v250 offset:57344
    v_mfma_f32_16x16x32_bf16 v[36:39], a[20:23], a[80:83], v[36:39]
    ds_read_b64_tr_b16 a[42:43], v250 offset:61440
    v_mfma_f32_16x16x32_bf16 v[40:43], a[24:27], a[80:83], v[40:43]
    ds_read_b64_tr_b16 a[44:45], v251 offset:57344
    v_mfma_f32_16x16x32_bf16 v[44:47], a[28:31], a[80:83], v[44:47]
    ds_read_b64_tr_b16 a[46:47], v251 offset:61440
    v_mfma_f32_16x16x32_bf16 v[48:51], a[0:3], a[84:87], v[48:51]
    buffer_load_dwordx4 a[72:75], v230, s[16:19], s74 offen sc1
    ds_read_b64_tr_b16 a[48:49], v248 offset:58368
    v_mfma_f32_16x16x32_bf16 v[52:55], a[4:7], a[84:87], v[52:55]
    ds_read_b64_tr_b16 a[50:51], v248 offset:62464
    v_mfma_f32_16x16x32_bf16 v[56:59], a[8:11], a[84:87], v[56:59]
    ds_read_b64_tr_b16 a[52:53], v249 offset:58368
    v_mfma_f32_16x16x32_bf16 v[60:63], a[12:15], a[84:87], v[60:63]
    ds_read_b64_tr_b16 a[54:55], v249 offset:62464
    v_mfma_f32_16x16x32_bf16 v[64:67], a[16:19], a[84:87], v[64:67]
    buffer_load_dwordx4 a[76:79], v231, s[16:19], s74 offen sc1
    s_add_u32 s74, s74, 1024
    ds_read_b64_tr_b16 a[56:57], v250 offset:58368
    v_mfma_f32_16x16x32_bf16 v[68:71], a[20:23], a[84:87], v[68:71]
    ds_read_b64_tr_b16 a[58:59], v250 offset:62464
    v_mfma_f32_16x16x32_bf16 v[72:75], a[24:27], a[84:87], v[72:75]
    ds_read_b64_tr_b16 a[60:61], v251 offset:58368
    v_mfma_f32_16x16x32_bf16 v[76:79], a[28:31], a[84:87], v[76:79]
    ds_read_b64_tr_b16 a[62:63], v251 offset:62464
    v_mfma_f32_16x16x32_bf16 v[80:83], a[0:3], a[88:91], v[80:83]
    v_mfma_f32_16x16x32_bf16 v[84:87], a[4:7], a[88:91], v[84:87]
    v_mfma_f32_16x16x32_bf16 v[88:91], a[8:11], a[88:91], v[88:91]
    v_mfma_f32_16x16x32_bf16 v[92:95], a[12:15], a[88:91], v[92:95]
    v_mfma_f32_16x16x32_bf16 v[96:99], a[16:19], a[88:91], v[96:99]
    v_mfma_f32_16x16x32_bf16 v[100:103], a[20:23], a[88:91], v[100:103]
    v_mfma_f32_16x16x32_bf16 v[104:107], a[24:27], a[88:91], v[104:107]
    v_mfma_f32_16x16x32_bf16 v[108:111], a[28:31], a[88:91], v[108:111]
    v_mfma_f32_16x16x32_bf16 v[112:115], a[0:3], a[92:95], v[112:115]
    v_mfma_f32_16x16x32_bf16 v[116:119], a[4:7], a[92:95], v[116:119]
    v_mfma_f32_16x16x32_bf16 v[120:123], a[8:11], a[92:95], v[120:123]
    v_mfma_f32_16x16x32_bf16 v[124:127], a[12:15], a[92:95], v[124:127]
    v_mfma_f32_16x16x32_bf16 v[128:131], a[16:19], a[92:95], v[128:131]
    v_mfma_f32_16x16x32_bf16 v[132:135], a[20:23], a[92:95], v[132:135]
    v_mfma_f32_16x16x32_bf16 v[136:139], a[24:27], a[92:95], v[136:139]
    v_mfma_f32_16x16x32_bf16 v[140:143], a[28:31], a[92:95], v[140:143]
    s_waitcnt vmcnt(12) lgkmcnt(0)
    v_mfma_f32_16x16x32_bf16 v[16:19], a[32:35], a[96:99], v[16:19]
    buffer_load_dwordx4 a[80:83], v228, s[16:19], s74 offen sc1
    v_add_u32 v248, 65536, v248
    v_mfma_f32_16x16x32_bf16 v[20:23], a[36:39], a[96:99], v[20:23]
    v_add_u32 v249, 65536, v249
    v_mfma_f32_16x16x32_bf16 v[24:27], a[40:43], a[96:99], v[24:27]
    v_add_u32 v250, 65536, v250
    v_mfma_f32_16x16x32_bf16 v[28:31], a[44:47], a[96:99], v[28:31]
    v_add_u32 v251, 65536, v251
    v_mfma_f32_16x16x32_bf16 v[32:35], a[48:51], a[96:99], v[32:35]
    buffer_load_dwordx4 a[84:87], v229, s[16:19], s74 offen sc1
    ds_read_b64_tr_b16 a[0:1], v248 offset:0
    v_mfma_f32_16x16x32_bf16 v[36:39], a[52:55], a[96:99], v[36:39]
    ds_read_b64_tr_b16 a[2:3], v248 offset:4096
    v_mfma_f32_16x16x32_bf16 v[40:43], a[56:59], a[96:99], v[40:43]
    ds_read_b64_tr_b16 a[4:5], v249 offset:0
    v_mfma_f32_16x16x32_bf16 v[44:47], a[60:63], a[96:99], v[44:47]
    ds_read_b64_tr_b16 a[6:7], v249 offset:4096
    v_mfma_f32_16x16x32_bf16 v[48:51], a[32:35], a[100:103], v[48:51]
    buffer_load_dwordx4 a[88:91], v230, s[16:19], s74 offen sc1
    ds_read_b64_tr_b16 a[8:9], v250 offset:0
    v_mfma_f32_16x16x32_bf16 v[52:55], a[36:39], a[100:103], v[52:55]
    ds_read_b64_tr_b16 a[10:11], v250 offset:4096
    v_mfma_f32_16x16x32_bf16 v[56:59], a[40:43], a[100:103], v[56:59]
    ds_read_b64_tr_b16 a[12:13], v251 offset:0
    v_mfma_f32_16x16x32_bf16 v[60:63], a[44:47], a[100:103], v[60:63]
    ds_read_b64_tr_b16 a[14:15], v251 offset:4096
    v_mfma_f32_16x16x32_bf16 v[64:67], a[48:51], a[100:103], v[64:67]
    buffer_load_dwordx4 a[92:95], v231, s[16:19], s74 offen sc1
    s_add_u32 s74, s74, 1024
    ds_read_b64_tr_b16 a[16:17], v248 offset:1024
    v_mfma_f32_16x16x32_bf16 v[68:71], a[52:55], a[100:103], v[68:71]
    ds_read_b64_tr_b16 a[18:19], v248 offset:5120
    v_mfma_f32_16x16x32_bf16 v[72:75], a[56:59], a[100:103], v[72:75]
    ds_read_b64_tr_b16 a[20:21], v249 offset:1024
    v_mfma_f32_16x16x32_bf16 v[76:79], a[60:63], a[100:103], v[76:79]
    ds_read_b64_tr_b16 a[22:23], v249 offset:5120
    v_mfma_f32_16x16x32_bf16 v[80:83], a[32:35], a[104:107], v[80:83]
    ds_read_b64_tr_b16 a[24:25], v250 offset:1024
    v_mfma_f32_16x16x32_bf16 v[84:87], a[36:39], a[104:107], v[84:87]
    ds_read_b64_tr_b16 a[26:27], v250 offset:5120
    v_mfma_f32_16x16x32_bf16 v[88:91], a[40:43], a[104:107], v[88:91]
    ds_read_b64_tr_b16 a[28:29], v251 offset:1024
    v_mfma_f32_16x16x32_bf16 v[92:95], a[44:47], a[104:107], v[92:95]
    ds_read_b64_tr_b16 a[30:31], v251 offset:5120
    v_mfma_f32_16x16x32_bf16 v[96:99], a[48:51], a[104:107], v[96:99]
    v_mfma_f32_16x16x32_bf16 v[100:103], a[52:55], a[104:107], v[100:103]
    v_mfma_f32_16x16x32_bf16 v[104:107], a[56:59], a[104:107], v[104:107]
    v_mfma_f32_16x16x32_bf16 v[108:111], a[60:63], a[104:107], v[108:111]
    v_mfma_f32_16x16x32_bf16 v[112:115], a[32:35], a[108:111], v[112:115]
    v_mfma_f32_16x16x32_bf16 v[116:119], a[36:39], a[108:111], v[116:119]
    v_mfma_f32_16x16x32_bf16 v[120:123], a[40:43], a[108:111], v[120:123]
    v_mfma_f32_16x16x32_bf16 v[124:127], a[44:47], a[108:111], v[124:127]
    v_mfma_f32_16x16x32_bf16 v[128:131], a[48:51], a[108:111], v[128:131]
    v_mfma_f32_16x16x32_bf16 v[132:135], a[52:55], a[108:111], v[132:135]
    v_mfma_f32_16x16x32_bf16 v[136:139], a[56:59], a[108:111], v[136:139]
    v_mfma_f32_16x16x32_bf16 v[140:143], a[60:63], a[108:111], v[140:143]
    s_waitcnt vmcnt(12) lgkmcnt(0)
    v_mfma_f32_16x16x32_bf16 v[16:19], a[0:3], a[112:115], v[16:19]
    buffer_load_dwordx4 a[96:99], v228, s[16:19], s74 offen sc1
    ds_read_b64_tr_b16 a[32:33], v248 offset:8192
    v_mfma_f32_16x16x32_bf16 v[20:23], a[4:7], a[112:115], v[20:23]
    ds_read_b64_tr_b16 a[34:35], v248 offset:12288
    v_mfma_f32_16x16x32_bf16 v[24:27], a[8:11], a[112:115], v[24:27]
    ds_read_b64_tr_b16 a[36:37], v249 offset:8192
    v_mfma_f32_16x16x32_bf16 v[28:31], a[12:15], a[112:115], v[28:31]
    ds_read_b64_tr_b16 a[38:39], v249 offset:12288
    v_mfma_f32_16x16x32_bf16 v[32:35], a[16:19], a[112:115], v[32:35]
    buffer_load_dwordx4 a[100:103], v229, s[16:19], s74 offen sc1
    ds_read_b64_tr_b16 a[40:41], v250 offset:8192
    v_mfma_f32_16x16x32_bf16 v[36:39], a[20:23], a[112:115], v[36:39]
    ds_read_b64_tr_b16 a[42:43], v250 offset:12288
    v_mfma_f32_16x16x32_bf16 v[40:43], a[24:27], a[112:115], v[40:43]
    ds_read_b64_tr_b16 a[44:45], v251 offset:8192
    v_mfma_f32_16x16x32_bf16 v[44:47], a[28:31], a[112:115], v[44:47]
    ds_read_b64_tr_b16 a[46:47], v251 offset:12288
    v_mfma_f32_16x16x32_bf16 v[48:51], a[0:3], a[116:119], v[48:51]
    buffer_load_dwordx4 a[104:107], v230, s[16:19], s74 offen sc1
    ds_read_b64_tr_b16 a[48:49], v248 offset:9216
    v_mfma_f32_16x16x32_bf16 v[52:55], a[4:7], a[116:119], v[52:55]
    ds_read_b64_tr_b16 a[50:51], v248 offset:13312
    v_mfma_f32_16x16x32_bf16 v[56:59], a[8:11], a[116:119], v[56:59]
    ds_read_b64_tr_b16 a[52:53], v249 offset:9216
    v_mfma_f32_16x16x32_bf16 v[60:63], a[12:15], a[116:119], v[60:63]
    ds_read_b64_tr_b16 a[54:55], v249 offset:13312
    v_mfma_f32_16x16x32_bf16 v[64:67], a[16:19], a[116:119], v[64:67]
    buffer_load_dwordx4 a[108:111], v231, s[16:19], s74 offen sc1
    s_add_u32 s74, s74, 1024
    ds_read_b64_tr_b16 a[56:57], v250 offset:9216
    v_mfma_f32_16x16x32_bf16 v[68:71], a[20:23], a[116:119], v[68:71]
    ds_read_b64_tr_b16 a[58:59], v250 offset:13312
    v_mfma_f32_16x16x32_bf16 v[72:75], a[24:27], a[116:119], v[72:75]
    ds_read_b64_tr_b16 a[60:61], v251 offset:9216
    v_mfma_f32_16x16x32_bf16 v[76:79], a[28:31], a[116:119], v[76:79]
    ds_read_b64_tr_b16 a[62:63], v251 offset:13312
    v_mfma_f32_16x16x32_bf16 v[80:83], a[0:3], a[120:123], v[80:83]
    v_mfma_f32_16x16x32_bf16 v[84:87], a[4:7], a[120:123], v[84:87]
    v_mfma_f32_16x16x32_bf16 v[88:91], a[8:11], a[120:123], v[88:91]
    v_mfma_f32_16x16x32_bf16 v[92:95], a[12:15], a[120:123], v[92:95]
    v_mfma_f32_16x16x32_bf16 v[96:99], a[16:19], a[120:123], v[96:99]
    v_mfma_f32_16x16x32_bf16 v[100:103], a[20:23], a[120:123], v[100:103]
    v_mfma_f32_16x16x32_bf16 v[104:107], a[24:27], a[120:123], v[104:107]
    v_mfma_f32_16x16x32_bf16 v[108:111], a[28:31], a[120:123], v[108:111]
    v_mfma_f32_16x16x32_bf16 v[112:115], a[0:3], a[124:127], v[112:115]
    v_mfma_f32_16x16x32_bf16 v[116:119], a[4:7], a[124:127], v[116:119]
    v_mfma_f32_16x16x32_bf16 v[120:123], a[8:11], a[124:127], v[120:123]
    v_mfma_f32_16x16x32_bf16 v[124:127], a[12:15], a[124:127], v[124:127]
    v_mfma_f32_16x16x32_bf16 v[128:131], a[16:19], a[124:127], v[128:131]
    v_mfma_f32_16x16x32_bf16 v[132:135], a[20:23], a[124:127], v[132:135]
    v_mfma_f32_16x16x32_bf16 v[136:139], a[24:27], a[124:127], v[136:139]
    v_mfma_f32_16x16x32_bf16 v[140:143], a[28:31], a[124:127], v[140:143]
    s_waitcnt vmcnt(12) lgkmcnt(0)
    v_mfma_f32_16x16x32_bf16 v[16:19], a[32:35], a[128:131], v[16:19]
    ds_read_b64_tr_b16 a[0:1], v248 offset:16384
    v_mfma_f32_16x16x32_bf16 v[20:23], a[36:39], a[128:131], v[20:23]
    ds_read_b64_tr_b16 a[2:3], v248 offset:20480
    v_mfma_f32_16x16x32_bf16 v[24:27], a[40:43], a[128:131], v[24:27]
    ds_read_b64_tr_b16 a[4:5], v249 offset:16384
    v_mfma_f32_16x16x32_bf16 v[28:31], a[44:47], a[128:131], v[28:31]
    ds_read_b64_tr_b16 a[6:7], v249 offset:20480
    v_mfma_f32_16x16x32_bf16 v[32:35], a[48:51], a[128:131], v[32:35]
    ds_read_b64_tr_b16 a[8:9], v250 offset:16384
    v_mfma_f32_16x16x32_bf16 v[36:39], a[52:55], a[128:131], v[36:39]
    ds_read_b64_tr_b16 a[10:11], v250 offset:20480
    v_mfma_f32_16x16x32_bf16 v[40:43], a[56:59], a[128:131], v[40:43]
    ds_read_b64_tr_b16 a[12:13], v251 offset:16384
    v_mfma_f32_16x16x32_bf16 v[44:47], a[60:63], a[128:131], v[44:47]
    ds_read_b64_tr_b16 a[14:15], v251 offset:20480
    v_mfma_f32_16x16x32_bf16 v[48:51], a[32:35], a[132:135], v[48:51]
    ds_read_b64_tr_b16 a[16:17], v248 offset:17408
    v_mfma_f32_16x16x32_bf16 v[52:55], a[36:39], a[132:135], v[52:55]
    ds_read_b64_tr_b16 a[18:19], v248 offset:21504
    v_mfma_f32_16x16x32_bf16 v[56:59], a[40:43], a[132:135], v[56:59]
    ds_read_b64_tr_b16 a[20:21], v249 offset:17408
    v_mfma_f32_16x16x32_bf16 v[60:63], a[44:47], a[132:135], v[60:63]
    ds_read_b64_tr_b16 a[22:23], v249 offset:21504
    v_mfma_f32_16x16x32_bf16 v[64:67], a[48:51], a[132:135], v[64:67]
    ds_read_b64_tr_b16 a[24:25], v250 offset:17408
    v_mfma_f32_16x16x32_bf16 v[68:71], a[52:55], a[132:135], v[68:71]
    ds_read_b64_tr_b16 a[26:27], v250 offset:21504
    v_mfma_f32_16x16x32_bf16 v[72:75], a[56:59], a[132:135], v[72:75]
    ds_read_b64_tr_b16 a[28:29], v251 offset:17408
    v_mfma_f32_16x16x32_bf16 v[76:79], a[60:63], a[132:135], v[76:79]
    ds_read_b64_tr_b16 a[30:31], v251 offset:21504
    v_mfma_f32_16x16x32_bf16 v[80:83], a[32:35], a[136:139], v[80:83]
    v_mfma_f32_16x16x32_bf16 v[84:87], a[36:39], a[136:139], v[84:87]
    v_mfma_f32_16x16x32_bf16 v[88:91], a[40:43], a[136:139], v[88:91]
    v_mfma_f32_16x16x32_bf16 v[92:95], a[44:47], a[136:139], v[92:95]
    v_mfma_f32_16x16x32_bf16 v[96:99], a[48:51], a[136:139], v[96:99]
    v_mfma_f32_16x16x32_bf16 v[100:103], a[52:55], a[136:139], v[100:103]
    v_mfma_f32_16x16x32_bf16 v[104:107], a[56:59], a[136:139], v[104:107]
    v_mfma_f32_16x16x32_bf16 v[108:111], a[60:63], a[136:139], v[108:111]
    v_mfma_f32_16x16x32_bf16 v[112:115], a[32:35], a[140:143], v[112:115]
    v_mfma_f32_16x16x32_bf16 v[116:119], a[36:39], a[140:143], v[116:119]
    v_mfma_f32_16x16x32_bf16 v[120:123], a[40:43], a[140:143], v[120:123]
    v_mfma_f32_16x16x32_bf16 v[124:127], a[44:47], a[140:143], v[124:127]
    v_mfma_f32_16x16x32_bf16 v[128:131], a[48:51], a[140:143], v[128:131]
    v_mfma_f32_16x16x32_bf16 v[132:135], a[52:55], a[140:143], v[132:135]
    v_mfma_f32_16x16x32_bf16 v[136:139], a[56:59], a[140:143], v[136:139]
    v_mfma_f32_16x16x32_bf16 v[140:143], a[60:63], a[140:143], v[140:143]
    s_waitcnt vmcnt(8) lgkmcnt(0)
    s_barrier
    v_mfma_f32_16x16x32_bf16 v[16:19], a[0:3], a[64:67], v[16:19]
    s_mov_b32 s8, s52
    s_mov_b32 s9, s53
    s_mov_b32 s10, 2211840
    s_mov_b32 s11, 0x20000
    s_mul_i32 s46, s60, 14
    s_add_u32 s46, s46, 0
    s_mul_i32 s46, s46, 40960
    s_lshl_b32 s47, s94, 7
    s_add_u32 s46, s46, s47
    s_cmp_eq_u32 s96, 0
    s_cselect_b32 s46, 2146435072, s46
    s_mul_i32 s47, s60, 20480
    s_add_u32 m0, s47, 0
    s_nop 0
    buffer_load_dwordx4 v252, s[8:11], s46 offen lds
    ds_read_b64_tr_b16 a[32:33], v248 offset:24576
    v_mfma_f32_16x16x32_bf16 v[20:23], a[4:7], a[64:67], v[20:23]
    ds_read_b64_tr_b16 a[34:35], v248 offset:28672
    v_mfma_f32_16x16x32_bf16 v[24:27], a[8:11], a[64:67], v[24:27]
    ds_read_b64_tr_b16 a[36:37], v249 offset:24576
    v_mfma_f32_16x16x32_bf16 v[28:31], a[12:15], a[64:67], v[28:31]
    ds_read_b64_tr_b16 a[38:39], v249 offset:28672
    v_mfma_f32_16x16x32_bf16 v[32:35], a[16:19], a[64:67], v[32:35]
    buffer_load_dwordx4 v253, s[8:11], s46 offen offset:1024 lds
    ds_read_b64_tr_b16 a[40:41], v250 offset:24576
    v_mfma_f32_16x16x32_bf16 v[36:39], a[20:23], a[64:67], v[36:39]
    ds_read_b64_tr_b16 a[42:43], v250 offset:28672
    v_mfma_f32_16x16x32_bf16 v[40:43], a[24:27], a[64:67], v[40:43]
    ds_read_b64_tr_b16 a[44:45], v251 offset:24576
    v_mfma_f32_16x16x32_bf16 v[44:47], a[28:31], a[64:67], v[44:47]
    ds_read_b64_tr_b16 a[46:47], v251 offset:28672
    v_mfma_f32_16x16x32_bf16 v[48:51], a[0:3], a[68:71], v[48:51]
    buffer_load_dwordx4 v254, s[8:11], s46 offen offset:2048 lds
    ds_read_b64_tr_b16 a[48:49], v248 offset:25600
    v_mfma_f32_16x16x32_bf16 v[52:55], a[4:7], a[68:71], v[52:55]
    ds_read_b64_tr_b16 a[50:51], v248 offset:29696
    v_mfma_f32_16x16x32_bf16 v[56:59], a[8:11], a[68:71], v[56:59]
    ds_read_b64_tr_b16 a[52:53], v249 offset:25600
    v_mfma_f32_16x16x32_bf16 v[60:63], a[12:15], a[68:71], v[60:63]
    ds_read_b64_tr_b16 a[54:55], v249 offset:29696
    v_mfma_f32_16x16x32_bf16 v[64:67], a[16:19], a[68:71], v[64:67]
    buffer_load_dwordx4 v255, s[8:11], s46 offen offset:3072 lds
    s_add_u32 s46, s46, 40960
    ds_read_b64_tr_b16 a[56:57], v250 offset:25600
    v_mfma_f32_16x16x32_bf16 v[68:71], a[20:23], a[68:71], v[68:71]
    ds_read_b64_tr_b16 a[58:59], v250 offset:29696
    v_mfma_f32_16x16x32_bf16 v[72:75], a[24:27], a[68:71], v[72:75]
    ds_read_b64_tr_b16 a[60:61], v251 offset:25600
    v_mfma_f32_16x16x32_bf16 v[76:79], a[28:31], a[68:71], v[76:79]
    ds_read_b64_tr_b16 a[62:63], v251 offset:29696
    v_mfma_f32_16x16x32_bf16 v[80:83], a[0:3], a[72:75], v[80:83]
    buffer_load_dwordx4 a[112:115], v228, s[16:19], s74 offen sc1
    v_mfma_f32_16x16x32_bf16 v[84:87], a[4:7], a[72:75], v[84:87]
    v_mfma_f32_16x16x32_bf16 v[88:91], a[8:11], a[72:75], v[88:91]
    v_mfma_f32_16x16x32_bf16 v[92:95], a[12:15], a[72:75], v[92:95]
    v_mfma_f32_16x16x32_bf16 v[96:99], a[16:19], a[72:75], v[96:99]
    buffer_load_dwordx4 a[116:119], v229, s[16:19], s74 offen sc1
    v_mfma_f32_16x16x32_bf16 v[100:103], a[20:23], a[72:75], v[100:103]
    v_mfma_f32_16x16x32_bf16 v[104:107], a[24:27], a[72:75], v[104:107]
    v_mfma_f32_16x16x32_bf16 v[108:111], a[28:31], a[72:75], v[108:111]
    v_mfma_f32_16x16x32_bf16 v[112:115], a[0:3], a[76:79], v[112:115]
    buffer_load_dwordx4 a[120:123], v230, s[16:19], s74 offen sc1
    v_mfma_f32_16x16x32_bf16 v[116:119], a[4:7], a[76:79], v[116:119]
    v_mfma_f32_16x16x32_bf16 v[120:123], a[8:11], a[76:79], v[120:123]
    v_mfma_f32_16x16x32_bf16 v[124:127], a[12:15], a[76:79], v[124:127]
    v_mfma_f32_16x16x32_bf16 v[128:131], a[16:19], a[76:79], v[128:131]
    buffer_load_dwordx4 a[124:127], v231, s[16:19], s74 offen sc1
    s_add_u32 s74, s74, 1024
    v_mfma_f32_16x16x32_bf16 v[132:135], a[20:23], a[76:79], v[132:135]
    v_mfma_f32_16x16x32_bf16 v[136:139], a[24:27], a[76:79], v[136:139]
    v_mfma_f32_16x16x32_bf16 v[140:143], a[28:31], a[76:79], v[140:143]
    s_waitcnt vmcnt(12) lgkmcnt(0)
    v_mfma_f32_16x16x32_bf16 v[16:19], a[32:35], a[80:83], v[16:19]
    s_add_u32 m0, s47, 4096
    s_nop 0
    buffer_load_dwordx4 v252, s[8:11], s46 offen lds
    ds_read_b64_tr_b16 a[0:1], v248 offset:32768
    v_mfma_f32_16x16x32_bf16 v[20:23], a[36:39], a[80:83], v[20:23]
    ds_read_b64_tr_b16 a[2:3], v248 offset:36864
    v_mfma_f32_16x16x32_bf16 v[24:27], a[40:43], a[80:83], v[24:27]
    ds_read_b64_tr_b16 a[4:5], v249 offset:32768
    v_mfma_f32_16x16x32_bf16 v[28:31], a[44:47], a[80:83], v[28:31]
    ds_read_b64_tr_b16 a[6:7], v249 offset:36864
    v_mfma_f32_16x16x32_bf16 v[32:35], a[48:51], a[80:83], v[32:35]
    buffer_load_dwordx4 v253, s[8:11], s46 offen offset:1024 lds
    ds_read_b64_tr_b16 a[8:9], v250 offset:32768
    v_mfma_f32_16x16x32_bf16 v[36:39], a[52:55], a[80:83], v[36:39]
    ds_read_b64_tr_b16 a[10:11], v250 offset:36864
    v_mfma_f32_16x16x32_bf16 v[40:43], a[56:59], a[80:83], v[40:43]
    ds_read_b64_tr_b16 a[12:13], v251 offset:32768
    v_mfma_f32_16x16x32_bf16 v[44:47], a[60:63], a[80:83], v[44:47]
    ds_read_b64_tr_b16 a[14:15], v251 offset:36864
    v_mfma_f32_16x16x32_bf16 v[48:51], a[32:35], a[84:87], v[48:51]
    buffer_load_dwordx4 v254, s[8:11], s46 offen offset:2048 lds
    ds_read_b64_tr_b16 a[16:17], v248 offset:33792
    v_mfma_f32_16x16x32_bf16 v[52:55], a[36:39], a[84:87], v[52:55]
    ds_read_b64_tr_b16 a[18:19], v248 offset:37888
    v_mfma_f32_16x16x32_bf16 v[56:59], a[40:43], a[84:87], v[56:59]
    ds_read_b64_tr_b16 a[20:21], v249 offset:33792
    v_mfma_f32_16x16x32_bf16 v[60:63], a[44:47], a[84:87], v[60:63]
    ds_read_b64_tr_b16 a[22:23], v249 offset:37888
    v_mfma_f32_16x16x32_bf16 v[64:67], a[48:51], a[84:87], v[64:67]
    buffer_load_dwordx4 v255, s[8:11], s46 offen offset:3072 lds
    s_add_u32 s46, s46, 40960
    ds_read_b64_tr_b16 a[24:25], v250 offset:33792
    v_mfma_f32_16x16x32_bf16 v[68:71], a[52:55], a[84:87], v[68:71]
    ds_read_b64_tr_b16 a[26:27], v250 offset:37888
    v_mfma_f32_16x16x32_bf16 v[72:75], a[56:59], a[84:87], v[72:75]
    ds_read_b64_tr_b16 a[28:29], v251 offset:33792
    v_mfma_f32_16x16x32_bf16 v[76:79], a[60:63], a[84:87], v[76:79]
    ds_read_b64_tr_b16 a[30:31], v251 offset:37888
    v_mfma_f32_16x16x32_bf16 v[80:83], a[32:35], a[88:91], v[80:83]
    buffer_load_dwordx4 a[128:131], v228, s[16:19], s74 offen sc1
    v_mfma_f32_16x16x32_bf16 v[84:87], a[36:39], a[88:91], v[84:87]
    v_mfma_f32_16x16x32_bf16 v[88:91], a[40:43], a[88:91], v[88:91]
    v_mfma_f32_16x16x32_bf16 v[92:95], a[44:47], a[88:91], v[92:95]
    v_mfma_f32_16x16x32_bf16 v[96:99], a[48:51], a[88:91], v[96:99]
    buffer_load_dwordx4 a[132:135], v229, s[16:19], s74 offen sc1
    v_mfma_f32_16x16x32_bf16 v[100:103], a[52:55], a[88:91], v[100:103]
    v_mfma_f32_16x16x32_bf16 v[104:107], a[56:59], a[88:91], v[104:107]
    v_mfma_f32_16x16x32_bf16 v[108:111], a[60:63], a[88:91], v[108:111]
    v_mfma_f32_16x16x32_bf16 v[112:115], a[32:35], a[92:95], v[112:115]
    buffer_load_dwordx4 a[136:139], v230, s[16:19], s74 offen sc1
    v_mfma_f32_16x16x32_bf16 v[116:119], a[36:39], a[92:95], v[116:119]
    v_mfma_f32_16x16x32_bf16 v[120:123], a[40:43], a[92:95], v[120:123]
    v_mfma_f32_16x16x32_bf16 v[124:127], a[44:47], a[92:95], v[124:127]
    v_mfma_f32_16x16x32_bf16 v[128:131], a[48:51], a[92:95], v[128:131]
    buffer_load_dwordx4 a[140:143], v231, s[16:19], s74 offen sc1
    s_add_u32 s74, s74, 1024
    v_mfma_f32_16x16x32_bf16 v[132:135], a[52:55], a[92:95], v[132:135]
    v_mfma_f32_16x16x32_bf16 v[136:139], a[56:59], a[92:95], v[136:139]
    v_mfma_f32_16x16x32_bf16 v[140:143], a[60:63], a[92:95], v[140:143]
    s_waitcnt vmcnt(16) lgkmcnt(0)
    v_mfma_f32_16x16x32_bf16 v[16:19], a[0:3], a[96:99], v[16:19]
    s_add_u32 m0, s47, 8192
    s_nop 0
    buffer_load_dwordx4 v252, s[8:11], s46 offen lds
    ds_read_b64_tr_b16 a[32:33], v248 offset:40960
    v_mfma_f32_16x16x32_bf16 v[20:23], a[4:7], a[96:99], v[20:23]
    ds_read_b64_tr_b16 a[34:35], v248 offset:45056
    v_mfma_f32_16x16x32_bf16 v[24:27], a[8:11], a[96:99], v[24:27]
    ds_read_b64_tr_b16 a[36:37], v249 offset:40960
    v_mfma_f32_16x16x32_bf16 v[28:31], a[12:15], a[96:99], v[28:31]
    ds_read_b64_tr_b16 a[38:39], v249 offset:45056
    v_mfma_f32_16x16x32_bf16 v[32:35], a[16:19], a[96:99], v[32:35]
    buffer_load_dwordx4 v253, s[8:11], s46 offen offset:1024 lds
    ds_read_b64_tr_b16 a[40:41], v250 offset:40960
    v_mfma_f32_16x16x32_bf16 v[36:39], a[20:23], a[96:99], v[36:39]
    ds_read_b64_tr_b16 a[42:43], v250 offset:45056
    v_mfma_f32_16x16x32_bf16 v[40:43], a[24:27], a[96:99], v[40:43]
    ds_read_b64_tr_b16 a[44:45], v251 offset:40960
    v_mfma_f32_16x16x32_bf16 v[44:47], a[28:31], a[96:99], v[44:47]
    ds_read_b64_tr_b16 a[46:47], v251 offset:45056
    v_mfma_f32_16x16x32_bf16 v[48:51], a[0:3], a[100:103], v[48:51]
    buffer_load_dwordx4 v254, s[8:11], s46 offen offset:2048 lds
    ds_read_b64_tr_b16 a[48:49], v248 offset:41984
    v_mfma_f32_16x16x32_bf16 v[52:55], a[4:7], a[100:103], v[52:55]
    ds_read_b64_tr_b16 a[50:51], v248 offset:46080
    v_mfma_f32_16x16x32_bf16 v[56:59], a[8:11], a[100:103], v[56:59]
    ds_read_b64_tr_b16 a[52:53], v249 offset:41984
    v_mfma_f32_16x16x32_bf16 v[60:63], a[12:15], a[100:103], v[60:63]
    ds_read_b64_tr_b16 a[54:55], v249 offset:46080
    v_mfma_f32_16x16x32_bf16 v[64:67], a[16:19], a[100:103], v[64:67]
    buffer_load_dwordx4 v255, s[8:11], s46 offen offset:3072 lds
    s_add_u32 s46, s46, 40960
    ds_read_b64_tr_b16 a[56:57], v250 offset:41984
    v_mfma_f32_16x16x32_bf16 v[68:71], a[20:23], a[100:103], v[68:71]
    ds_read_b64_tr_b16 a[58:59], v250 offset:46080
    v_mfma_f32_16x16x32_bf16 v[72:75], a[24:27], a[100:103], v[72:75]
    ds_read_b64_tr_b16 a[60:61], v251 offset:41984
    v_mfma_f32_16x16x32_bf16 v[76:79], a[28:31], a[100:103], v[76:79]
    ds_read_b64_tr_b16 a[62:63], v251 offset:46080
    v_mfma_f32_16x16x32_bf16 v[80:83], a[0:3], a[104:107], v[80:83]
    buffer_load_dwordx4 a[64:67], v228, s[16:19], s74 offen sc1
    v_mfma_f32_16x16x32_bf16 v[84:87], a[4:7], a[104:107], v[84:87]
    v_mfma_f32_16x16x32_bf16 v[88:91], a[8:11], a[104:107], v[88:91]
    v_mfma_f32_16x16x32_bf16 v[92:95], a[12:15], a[104:107], v[92:95]
    v_mfma_f32_16x16x32_bf16 v[96:99], a[16:19], a[104:107], v[96:99]
    buffer_load_dwordx4 a[68:71], v229, s[16:19], s74 offen sc1
    v_mfma_f32_16x16x32_bf16 v[100:103], a[20:23], a[104:107], v[100:103]
    v_mfma_f32_16x16x32_bf16 v[104:107], a[24:27], a[104:107], v[104:107]
    v_mfma_f32_16x16x32_bf16 v[108:111], a[28:31], a[104:107], v[108:111]
    v_mfma_f32_16x16x32_bf16 v[112:115], a[0:3], a[108:111], v[112:115]
    buffer_load_dwordx4 a[72:75], v230, s[16:19], s74 offen sc1
    v_mfma_f32_16x16x32_bf16 v[116:119], a[4:7], a[108:111], v[116:119]
    v_mfma_f32_16x16x32_bf16 v[120:123], a[8:11], a[108:111], v[120:123]
    v_mfma_f32_16x16x32_bf16 v[124:127], a[12:15], a[108:111], v[124:127]
    v_mfma_f32_16x16x32_bf16 v[128:131], a[16:19], a[108:111], v[128:131]
    buffer_load_dwordx4 a[76:79], v231, s[16:19], s74 offen sc1
    s_add_u32 s74, s74, 1024
    v_mfma_f32_16x16x32_bf16 v[132:135], a[20:23], a[108:111], v[132:135]
    v_mfma_f32_16x16x32_bf16 v[136:139], a[24:27], a[108:111], v[136:139]
    v_mfma_f32_16x16x32_bf16 v[140:143], a[28:31], a[108:111], v[140:143]
    s_waitcnt vmcnt(16) lgkmcnt(0)
    v_mfma_f32_16x16x32_bf16 v[16:19], a[32:35], a[112:115], v[16:19]
    s_add_u32 m0, s47, 12288
    s_nop 0
    buffer_load_dwordx4 v252, s[8:11], s46 offen lds
    ds_read_b64_tr_b16 a[0:1], v248 offset:49152
    v_mfma_f32_16x16x32_bf16 v[20:23], a[36:39], a[112:115], v[20:23]
    ds_read_b64_tr_b16 a[2:3], v248 offset:53248
    v_mfma_f32_16x16x32_bf16 v[24:27], a[40:43], a[112:115], v[24:27]
    ds_read_b64_tr_b16 a[4:5], v249 offset:49152
    v_mfma_f32_16x16x32_bf16 v[28:31], a[44:47], a[112:115], v[28:31]
    ds_read_b64_tr_b16 a[6:7], v249 offset:53248
    v_mfma_f32_16x16x32_bf16 v[32:35], a[48:51], a[112:115], v[32:35]
    buffer_load_dwordx4 v253, s[8:11], s46 offen offset:1024 lds
    ds_read_b64_tr_b16 a[8:9], v250 offset:49152
    v_mfma_f32_16x16x32_bf16 v[36:39], a[52:55], a[112:115], v[36:39]
    ds_read_b64_tr_b16 a[10:11], v250 offset:53248
    v_mfma_f32_16x16x32_bf16 v[40:43], a[56:59], a[112:115], v[40:43]
    ds_read_b64_tr_b16 a[12:13], v251 offset:49152
    v_mfma_f32_16x16x32_bf16 v[44:47], a[60:63], a[112:115], v[44:47]
    ds_read_b64_tr_b16 a[14:15], v251 offset:53248
    v_mfma_f32_16x16x32_bf16 v[48:51], a[32:35], a[116:119], v[48:51]
    buffer_load_dwordx4 v254, s[8:11], s46 offen offset:2048 lds
    ds_read_b64_tr_b16 a[16:17], v248 offset:50176
    v_mfma_f32_16x16x32_bf16 v[52:55], a[36:39], a[116:119], v[52:55]
    ds_read_b64_tr_b16 a[18:19], v248 offset:54272
    v_mfma_f32_16x16x32_bf16 v[56:59], a[40:43], a[116:119], v[56:59]
    ds_read_b64_tr_b16 a[20:21], v249 offset:50176
    v_mfma_f32_16x16x32_bf16 v[60:63], a[44:47], a[116:119], v[60:63]
    ds_read_b64_tr_b16 a[22:23], v249 offset:54272
    v_mfma_f32_16x16x32_bf16 v[64:67], a[48:51], a[116:119], v[64:67]
    buffer_load_dwordx4 v255, s[8:11], s46 offen offset:3072 lds
    s_add_u32 s46, s46, 40960
    ds_read_b64_tr_b16 a[24:25], v250 offset:50176
    v_mfma_f32_16x16x32_bf16 v[68:71], a[52:55], a[116:119], v[68:71]
    ds_read_b64_tr_b16 a[26:27], v250 offset:54272
    v_mfma_f32_16x16x32_bf16 v[72:75], a[56:59], a[116:119], v[72:75]
    ds_read_b64_tr_b16 a[28:29], v251 offset:50176
    v_mfma_f32_16x16x32_bf16 v[76:79], a[60:63], a[116:119], v[76:79]
    ds_read_b64_tr_b16 a[30:31], v251 offset:54272
    v_mfma_f32_16x16x32_bf16 v[80:83], a[32:35], a[120:123], v[80:83]
    buffer_load_dwordx4 a[80:83], v228, s[16:19], s74 offen sc1
    v_mfma_f32_16x16x32_bf16 v[84:87], a[36:39], a[120:123], v[84:87]
    v_mfma_f32_16x16x32_bf16 v[88:91], a[40:43], a[120:123], v[88:91]
    v_mfma_f32_16x16x32_bf16 v[92:95], a[44:47], a[120:123], v[92:95]
    v_mfma_f32_16x16x32_bf16 v[96:99], a[48:51], a[120:123], v[96:99]
    buffer_load_dwordx4 a[84:87], v229, s[16:19], s74 offen sc1
    v_mfma_f32_16x16x32_bf16 v[100:103], a[52:55], a[120:123], v[100:103]
    v_mfma_f32_16x16x32_bf16 v[104:107], a[56:59], a[120:123], v[104:107]
    v_mfma_f32_16x16x32_bf16 v[108:111], a[60:63], a[120:123], v[108:111]
    v_mfma_f32_16x16x32_bf16 v[112:115], a[32:35], a[124:127], v[112:115]
    buffer_load_dwordx4 a[88:91], v230, s[16:19], s74 offen sc1
    v_mfma_f32_16x16x32_bf16 v[116:119], a[36:39], a[124:127], v[116:119]
    v_mfma_f32_16x16x32_bf16 v[120:123], a[40:43], a[124:127], v[120:123]
    v_mfma_f32_16x16x32_bf16 v[124:127], a[44:47], a[124:127], v[124:127]
    v_mfma_f32_16x16x32_bf16 v[128:131], a[48:51], a[124:127], v[128:131]
    buffer_load_dwordx4 a[92:95], v231, s[16:19], s74 offen sc1
    s_add_u32 s74, s74, 1024
    v_mfma_f32_16x16x32_bf16 v[132:135], a[52:55], a[124:127], v[132:135]
    v_mfma_f32_16x16x32_bf16 v[136:139], a[56:59], a[124:127], v[136:139]
    v_mfma_f32_16x16x32_bf16 v[140:143], a[60:63], a[124:127], v[140:143]
    s_waitcnt vmcnt(16) lgkmcnt(0)
    v_mfma_f32_16x16x32_bf16 v[16:19], a[0:3], a[128:131], v[16:19]
    s_add_u32 m0, s47, 16384
    s_nop 0
    buffer_load_dwordx4 v252, s[8:11], s46 offen lds
    ds_read_b64_tr_b16 a[32:33], v248 offset:57344
    v_mfma_f32_16x16x32_bf16 v[20:23], a[4:7], a[128:131], v[20:23]
    ds_read_b64_tr_b16 a[34:35], v248 offset:61440
    v_mfma_f32_16x16x32_bf16 v[24:27], a[8:11], a[128:131], v[24:27]
    ds_read_b64_tr_b16 a[36:37], v249 offset:57344
    v_mfma_f32_16x16x32_bf16 v[28:31], a[12:15], a[128:131], v[28:31]
    ds_read_b64_tr_b16 a[38:39], v249 offset:61440
    v_mfma_f32_16x16x32_bf16 v[32:35], a[16:19], a[128:131], v[32:35]
    buffer_load_dwordx4 v253, s[8:11], s46 offen offset:1024 lds
    ds_read_b64_tr_b16 a[40:41], v250 offset:57344
    v_mfma_f32_16x16x32_bf16 v[36:39], a[20:23], a[128:131], v[36:39]
    ds_read_b64_tr_b16 a[42:43], v250 offset:61440
    v_mfma_f32_16x16x32_bf16 v[40:43], a[24:27], a[128:131], v[40:43]
    ds_read_b64_tr_b16 a[44:45], v251 offset:57344
    v_mfma_f32_16x16x32_bf16 v[44:47], a[28:31], a[128:131], v[44:47]
    ds_read_b64_tr_b16 a[46:47], v251 offset:61440
    v_mfma_f32_16x16x32_bf16 v[48:51], a[0:3], a[132:135], v[48:51]
    buffer_load_dwordx4 v254, s[8:11], s46 offen offset:2048 lds
    ds_read_b64_tr_b16 a[48:49], v248 offset:58368
    v_mfma_f32_16x16x32_bf16 v[52:55], a[4:7], a[132:135], v[52:55]
    ds_read_b64_tr_b16 a[50:51], v248 offset:62464
    v_mfma_f32_16x16x32_bf16 v[56:59], a[8:11], a[132:135], v[56:59]
    ds_read_b64_tr_b16 a[52:53], v249 offset:58368
    v_mfma_f32_16x16x32_bf16 v[60:63], a[12:15], a[132:135], v[60:63]
    ds_read_b64_tr_b16 a[54:55], v249 offset:62464
    v_mfma_f32_16x16x32_bf16 v[64:67], a[16:19], a[132:135], v[64:67]
    buffer_load_dwordx4 v255, s[8:11], s46 offen offset:3072 lds
    s_add_u32 s46, s46, 40960
    ds_read_b64_tr_b16 a[56:57], v250 offset:58368
    v_mfma_f32_16x16x32_bf16 v[68:71], a[20:23], a[132:135], v[68:71]
    ds_read_b64_tr_b16 a[58:59], v250 offset:62464
    v_mfma_f32_16x16x32_bf16 v[72:75], a[24:27], a[132:135], v[72:75]
    ds_read_b64_tr_b16 a[60:61], v251 offset:58368
    v_mfma_f32_16x16x32_bf16 v[76:79], a[28:31], a[132:135], v[76:79]
    ds_read_b64_tr_b16 a[62:63], v251 offset:62464
    v_mfma_f32_16x16x32_bf16 v[80:83], a[0:3], a[136:139], v[80:83]
    buffer_load_dwordx4 a[96:99], v228, s[16:19], s74 offen sc1
    v_mfma_f32_16x16x32_bf16 v[84:87], a[4:7], a[136:139], v[84:87]
    v_mfma_f32_16x16x32_bf16 v[88:91], a[8:11], a[136:139], v[88:91]
    v_mfma_f32_16x16x32_bf16 v[92:95], a[12:15], a[136:139], v[92:95]
    v_mfma_f32_16x16x32_bf16 v[96:99], a[16:19], a[136:139], v[96:99]
    buffer_load_dwordx4 a[100:103], v229, s[16:19], s74 offen sc1
    v_mfma_f32_16x16x32_bf16 v[100:103], a[20:23], a[136:139], v[100:103]
    v_mfma_f32_16x16x32_bf16 v[104:107], a[24:27], a[136:139], v[104:107]
    v_mfma_f32_16x16x32_bf16 v[108:111], a[28:31], a[136:139], v[108:111]
    v_mfma_f32_16x16x32_bf16 v[112:115], a[0:3], a[140:143], v[112:115]
    buffer_load_dwordx4 a[104:107], v230, s[16:19], s74 offen sc1
    v_mfma_f32_16x16x32_bf16 v[116:119], a[4:7], a[140:143], v[116:119]
    v_mfma_f32_16x16x32_bf16 v[120:123], a[8:11], a[140:143], v[120:123]
    v_mfma_f32_16x16x32_bf16 v[124:127], a[12:15], a[140:143], v[124:127]
    v_mfma_f32_16x16x32_bf16 v[128:131], a[16:19], a[140:143], v[128:131]
    buffer_load_dwordx4 a[108:111], v231, s[16:19], s74 offen sc1
    s_add_u32 s74, s74, 1024
    v_mfma_f32_16x16x32_bf16 v[132:135], a[20:23], a[140:143], v[132:135]
    v_mfma_f32_16x16x32_bf16 v[136:139], a[24:27], a[140:143], v[136:139]
    v_mfma_f32_16x16x32_bf16 v[140:143], a[28:31], a[140:143], v[140:143]
    s_waitcnt vmcnt(16) lgkmcnt(0)
    v_mfma_f32_16x16x32_bf16 v[16:19], a[32:35], a[64:67], v[16:19]
    buffer_load_dwordx4 a[112:115], v228, s[16:19], s74 offen sc1
    v_add_u32 v248, 65536, v248
    v_mfma_f32_16x16x32_bf16 v[20:23], a[36:39], a[64:67], v[20:23]
    v_add_u32 v249, 65536, v249
    v_mfma_f32_16x16x32_bf16 v[24:27], a[40:43], a[64:67], v[24:27]
    v_add_u32 v250, 65536, v250
    v_mfma_f32_16x16x32_bf16 v[28:31], a[44:47], a[64:67], v[28:31]
    v_add_u32 v251, 65536, v251
    v_mfma_f32_16x16x32_bf16 v[32:35], a[48:51], a[64:67], v[32:35]
    buffer_load_dwordx4 a[116:119], v229, s[16:19], s74 offen sc1
    ds_read_b64_tr_b16 a[0:1], v248 offset:0
    v_mfma_f32_16x16x32_bf16 v[36:39], a[52:55], a[64:67], v[36:39]
    ds_read_b64_tr_b16 a[2:3], v248 offset:4096
    v_mfma_f32_16x16x32_bf16 v[40:43], a[56:59], a[64:67], v[40:43]
    ds_read_b64_tr_b16 a[4:5], v249 offset:0
    v_mfma_f32_16x16x32_bf16 v[44:47], a[60:63], a[64:67], v[44:47]
    ds_read_b64_tr_b16 a[6:7], v249 offset:4096
    v_mfma_f32_16x16x32_bf16 v[48:51], a[32:35], a[68:71], v[48:51]
    buffer_load_dwordx4 a[120:123], v230, s[16:19], s74 offen sc1
    ds_read_b64_tr_b16 a[8:9], v250 offset:0
    v_mfma_f32_16x16x32_bf16 v[52:55], a[36:39], a[68:71], v[52:55]
    ds_read_b64_tr_b16 a[10:11], v250 offset:4096
    v_mfma_f32_16x16x32_bf16 v[56:59], a[40:43], a[68:71], v[56:59]
    ds_read_b64_tr_b16 a[12:13], v251 offset:0
    v_mfma_f32_16x16x32_bf16 v[60:63], a[44:47], a[68:71], v[60:63]
    ds_read_b64_tr_b16 a[14:15], v251 offset:4096
    v_mfma_f32_16x16x32_bf16 v[64:67], a[48:51], a[68:71], v[64:67]
    buffer_load_dwordx4 a[124:127], v231, s[16:19], s74 offen sc1
    s_add_u32 s74, s74, 1024
    ds_read_b64_tr_b16 a[16:17], v248 offset:1024
    v_mfma_f32_16x16x32_bf16 v[68:71], a[52:55], a[68:71], v[68:71]
    ds_read_b64_tr_b16 a[18:19], v248 offset:5120
    v_mfma_f32_16x16x32_bf16 v[72:75], a[56:59], a[68:71], v[72:75]
    ds_read_b64_tr_b16 a[20:21], v249 offset:1024
    v_mfma_f32_16x16x32_bf16 v[76:79], a[60:63], a[68:71], v[76:79]
    ds_read_b64_tr_b16 a[22:23], v249 offset:5120
    v_mfma_f32_16x16x32_bf16 v[80:83], a[32:35], a[72:75], v[80:83]
    buffer_load_dwordx4 a[128:131], v228, s[16:19], s74 offen sc1
    ds_read_b64_tr_b16 a[24:25], v250 offset:1024
    v_mfma_f32_16x16x32_bf16 v[84:87], a[36:39], a[72:75], v[84:87]
    ds_read_b64_tr_b16 a[26:27], v250 offset:5120
    v_mfma_f32_16x16x32_bf16 v[88:91], a[40:43], a[72:75], v[88:91]
    ds_read_b64_tr_b16 a[28:29], v251 offset:1024
    v_mfma_f32_16x16x32_bf16 v[92:95], a[44:47], a[72:75], v[92:95]
    ds_read_b64_tr_b16 a[30:31], v251 offset:5120
    v_mfma_f32_16x16x32_bf16 v[96:99], a[48:51], a[72:75], v[96:99]
    buffer_load_dwordx4 a[132:135], v229, s[16:19], s74 offen sc1
    v_mfma_f32_16x16x32_bf16 v[100:103], a[52:55], a[72:75], v[100:103]
    v_mfma_f32_16x16x32_bf16 v[104:107], a[56:59], a[72:75], v[104:107]
    v_mfma_f32_16x16x32_bf16 v[108:111], a[60:63], a[72:75], v[108:111]
    v_mfma_f32_16x16x32_bf16 v[112:115], a[32:35], a[76:79], v[112:115]
    buffer_load_dwordx4 a[136:139], v230, s[16:19], s74 offen sc1
    v_mfma_f32_16x16x32_bf16 v[116:119], a[36:39], a[76:79], v[116:119]
    v_mfma_f32_16x16x32_bf16 v[120:123], a[40:43], a[76:79], v[120:123]
    v_mfma_f32_16x16x32_bf16 v[124:127], a[44:47], a[76:79], v[124:127]
    v_mfma_f32_16x16x32_bf16 v[128:131], a[48:51], a[76:79], v[128:131]
    buffer_load_dwordx4 a[140:143], v231, s[16:19], s74 offen sc1
    s_add_u32 s74, s74, 1024
    v_mfma_f32_16x16x32_bf16 v[132:135], a[52:55], a[76:79], v[132:135]
    v_mfma_f32_16x16x32_bf16 v[136:139], a[56:59], a[76:79], v[136:139]
    v_mfma_f32_16x16x32_bf16 v[140:143], a[60:63], a[76:79], v[140:143]
    s_waitcnt vmcnt(16) lgkmcnt(0)
    s_waitcnt vmcnt(12)
    v_mfma_f32_16x16x32_bf16 v[16:19], a[0:3], a[80:83], v[16:19]
    ds_read_b64_tr_b16 a[32:33], v248 offset:8192
    ds_read_b64_tr_b16 a[34:35], v248 offset:12288
    v_mfma_f32_16x16x32_bf16 v[20:23], a[4:7], a[80:83], v[20:23]
    ds_read_b64_tr_b16 a[36:37], v249 offset:8192
    v_mfma_f32_16x16x32_bf16 v[24:27], a[8:11], a[80:83], v[24:27]
    ds_read_b64_tr_b16 a[38:39], v249 offset:12288
    ds_read_b64_tr_b16 a[40:41], v250 offset:8192
    v_mfma_f32_16x16x32_bf16 v[28:31], a[12:15], a[80:83], v[28:31]
    ds_read_b64_tr_b16 a[42:43], v250 offset:12288
    v_mfma_f32_16x16x32_bf16 v[32:35], a[16:19], a[80:83], v[32:35]
    ds_read_b64_tr_b16 a[44:45], v251 offset:8192
    ds_read_b64_tr_b16 a[46:47], v251 offset:12288
    v_mfma_f32_16x16x32_bf16 v[36:39], a[20:23], a[80:83], v[36:39]
    ds_read_b64_tr_b16 a[48:49], v248 offset:9216
    v_mfma_f32_16x16x32_bf16 v[40:43], a[24:27], a[80:83], v[40:43]
    ds_read_b64_tr_b16 a[50:51], v248 offset:13312
    v_mfma_f32_16x16x32_bf16 v[44:47], a[28:31], a[80:83], v[44:47]
    ds_read_b64_tr_b16 a[52:53], v249 offset:9216
    ds_read_b64_tr_b16 a[54:55], v249 offset:13312
    v_mfma_f32_16x16x32_bf16 v[48:51], a[0:3], a[84:87], v[48:51]
    ds_read_b64_tr_b16 a[56:57], v250 offset:9216
    v_mfma_f32_16x16x32_bf16 v[52:55], a[4:7], a[84:87], v[52:55]
    ds_read_b64_tr_b16 a[58:59], v250 offset:13312
    ds_read_b64_tr_b16 a[60:61], v251 offset:9216
    v_mfma_f32_16x16x32_bf16 v[56:59], a[8:11], a[84:87], v[56:59]
    ds_read_b64_tr_b16 a[62:63], v251 offset:13312
    v_mfma_f32_16x16x32_bf16 v[60:63], a[12:15], a[84:87], v[60:63]
    ds_read_b64_tr_b16 a[144:145], v244 offset:0
    ds_read_b64_tr_b16 a[146:147], v244 offset:2048
    v_mfma_f32_16x16x32_bf16 v[64:67], a[16:19], a[84:87], v[64:67]
    ds_read_b64_tr_b16 a[148:149], v245 offset:0
    v_mfma_f32_16x16x32_bf16 v[68:71], a[20:23], a[84:87], v[68:71]
    ds_read_b64_tr_b16 a[150:151], v245 offset:2048
    v_mfma_f32_16x16x32_bf16 v[72:75], a[24:27], a[84:87], v[72:75]
    ds_read_b64_tr_b16 a[152:153], v246 offset:0
    ds_read_b64_tr_b16 a[154:155], v246 offset:2048
    v_mfma_f32_16x16x32_bf16 v[76:79], a[28:31], a[84:87], v[76:79]
    ds_read_b64_tr_b16 a[156:157], v247 offset:0
    v_mfma_f32_16x16x32_bf16 v[80:83], a[0:3], a[88:91], v[80:83]
    ds_read_b64_tr_b16 a[158:159], v247 offset:2048
    ds_read_b64_tr_b16 a[160:161], v244 offset:4096
    v_mfma_f32_16x16x32_bf16 v[84:87], a[4:7], a[88:91], v[84:87]
    ds_read_b64_tr_b16 a[162:163], v244 offset:6144
    v_mfma_f32_16x16x32_bf16 v[88:91], a[8:11], a[88:91], v[88:91]
    ds_read_b64_tr_b16 a[164:165], v245 offset:4096
    ds_read_b64_tr_b16 a[166:167], v245 offset:6144
    v_mfma_f32_16x16x32_bf16 v[92:95], a[12:15], a[88:91], v[92:95]
    ds_read_b64_tr_b16 a[168:169], v246 offset:4096
    v_mfma_f32_16x16x32_bf16 v[96:99], a[16:19], a[88:91], v[96:99]
    ds_read_b64_tr_b16 a[170:171], v246 offset:6144
    v_mfma_f32_16x16x32_bf16 v[100:103], a[20:23], a[88:91], v[100:103]
    ds_read_b64_tr_b16 a[172:173], v247 offset:4096
    ds_read_b64_tr_b16 a[174:175], v247 offset:6144
    v_mfma_f32_16x16x32_bf16 v[104:107], a[24:27], a[88:91], v[104:107]
    ds_read_b64_tr_b16 a[176:177], v244 offset:8192
    v_mfma_f32_16x16x32_bf16 v[108:111], a[28:31], a[88:91], v[108:111]
    ds_read_b64_tr_b16 a[178:179], v244 offset:10240
    ds_read_b64_tr_b16 a[180:181], v245 offset:8192
    v_mfma_f32_16x16x32_bf16 v[112:115], a[0:3], a[92:95], v[112:115]
    ds_read_b64_tr_b16 a[182:183], v245 offset:10240
    v_mfma_f32_16x16x32_bf16 v[116:119], a[4:7], a[92:95], v[116:119]
    ds_read_b64_tr_b16 a[184:185], v246 offset:8192
    ds_read_b64_tr_b16 a[186:187], v246 offset:10240
    v_mfma_f32_16x16x32_bf16 v[120:123], a[8:11], a[92:95], v[120:123]
    ds_read_b64_tr_b16 a[188:189], v247 offset:8192
    v_mfma_f32_16x16x32_bf16 v[124:127], a[12:15], a[92:95], v[124:127]
    ds_read_b64_tr_b16 a[190:191], v247 offset:10240
    v_mfma_f32_16x16x32_bf16 v[128:131], a[16:19], a[92:95], v[128:131]
    v_mfma_f32_16x16x32_bf16 v[132:135], a[20:23], a[92:95], v[132:135]
    v_mfma_f32_16x16x32_bf16 v[136:139], a[24:27], a[92:95], v[136:139]
    v_mfma_f32_16x16x32_bf16 v[140:143], a[28:31], a[92:95], v[140:143]
    s_waitcnt vmcnt(8) lgkmcnt(0)
    v_mfma_f32_16x16x32_bf16 v[16:19], a[32:35], a[96:99], v[16:19]
    ds_read_b64_tr_b16 a[0:1], v248 offset:16384
    ds_read_b64_tr_b16 a[2:3], v248 offset:20480
    v_mfma_f32_16x16x32_bf16 v[20:23], a[36:39], a[96:99], v[20:23]
    ds_read_b64_tr_b16 a[4:5], v249 offset:16384
    v_mfma_f32_16x16x32_bf16 v[24:27], a[40:43], a[96:99], v[24:27]
    ds_read_b64_tr_b16 a[6:7], v249 offset:20480
    v_mfma_f32_16x16x32_bf16 v[28:31], a[44:47], a[96:99], v[28:31]
    ds_read_b64_tr_b16 a[8:9], v250 offset:16384
    v_mfma_f32_16x16x32_bf16 v[32:35], a[48:51], a[96:99], v[32:35]
    ds_read_b64_tr_b16 a[10:11], v250 offset:20480
    v_mfma_f32_16x16x32_bf16 v[36:39], a[52:55], a[96:99], v[36:39]
    ds_read_b64_tr_b16 a[12:13], v251 offset:16384
    v_mfma_f32_16x16x32_bf16 v[40:43], a[56:59], a[96:99], v[40:43]
    ds_read_b64_tr_b16 a[14:15], v251 offset:20480
    v_mfma_f32_16x16x32_bf16 v[44:47], a[60:63], a[96:99], v[44:47]
    ds_read_b64_tr_b16 a[16:17], v248 offset:17408
    ds_read_b64_tr_b16 a[18:19], v248 offset:21504
    v_mfma_f32_16x16x32_bf16 v[48:51], a[32:35], a[100:103], v[48:51]
    ds_read_b64_tr_b16 a[20:21], v249 offset:17408
    v_mfma_f32_16x16x32_bf16 v[52:55], a[36:39], a[100:103], v[52:55]
    ds_read_b64_tr_b16 a[22:23], v249 offset:21504
    v_mfma_f32_16x16x32_bf16 v[56:59], a[40:43], a[100:103], v[56:59]
    ds_read_b64_tr_b16 a[24:25], v250 offset:17408
    v_mfma_f32_16x16x32_bf16 v[60:63], a[44:47], a[100:103], v[60:63]
    ds_read_b64_tr_b16 a[26:27], v250 offset:21504
    v_mfma_f32_16x16x32_bf16 v[64:67], a[48:51], a[100:103], v[64:67]
    ds_read_b64_tr_b16 a[28:29], v251 offset:17408
    v_mfma_f32_16x16x32_bf16 v[68:71], a[52:55], a[100:103], v[68:71]
    ds_read_b64_tr_b16 a[30:31], v251 offset:21504
    v_mfma_f32_16x16x32_bf16 v[72:75], a[56:59], a[100:103], v[72:75]
    ds_read_b64_tr_b16 a[192:193], v244 offset:12288
    ds_read_b64_tr_b16 a[194:195], v244 offset:14336
    v_mfma_f32_16x16x32_bf16 v[76:79], a[60:63], a[100:103], v[76:79]
    ds_read_b64_tr_b16 a[196:197], v245 offset:12288
    v_mfma_f32_16x16x32_bf16 v[80:83], a[32:35], a[104:107], v[80:83]
    ds_read_b64_tr_b16 a[198:199], v245 offset:14336
    v_mfma_f32_16x16x32_bf16 v[84:87], a[36:39], a[104:107], v[84:87]
    ds_read_b64_tr_b16 a[200:201], v246 offset:12288
    v_mfma_f32_16x16x32_bf16 v[88:91], a[40:43], a[104:107], v[88:91]
    ds_read_b64_tr_b16 a[202:203], v246 offset:14336
    v_mfma_f32_16x16x32_bf16 v[92:95], a[44:47], a[104:107], v[92:95]
    ds_read_b64_tr_b16 a[204:205], v247 offset:12288
    v_mfma_f32_16x16x32_bf16 v[96:99], a[48:51], a[104:107], v[96:99]
    ds_read_b64_tr_b16 a[206:207], v247 offset:14336
    v_mfma_f32_16x16x32_bf16 v[100:103], a[52:55], a[104:107], v[100:103]
    ds_read_b64_tr_b16 a[208:209], v244 offset:16384
    ds_read_b64_tr_b16 a[210:211], v244 offset:18432
    v_mfma_f32_16x16x32_bf16 v[104:107], a[56:59], a[104:107], v[104:107]
    ds_read_b64_tr_b16 a[212:213], v245 offset:16384
    v_mfma_f32_16x16x32_bf16 v[108:111], a[60:63], a[104:107], v[108:111]
    ds_read_b64_tr_b16 a[214:215], v245 offset:18432
    v_mfma_f32_16x16x32_bf16 v[112:115], a[32:35], a[108:111], v[112:115]
    ds_read_b64_tr_b16 a[216:217], v246 offset:16384
    v_mfma_f32_16x16x32_bf16 v[116:119], a[36:39], a[108:111], v[116:119]
    ds_read_b64_tr_b16 a[218:219], v246 offset:18432
    v_mfma_f32_16x16x32_bf16 v[120:123], a[40:43], a[108:111], v[120:123]
    ds_read_b64_tr_b16 a[220:221], v247 offset:16384
    v_mfma_f32_16x16x32_bf16 v[124:127], a[44:47], a[108:111], v[124:127]
    ds_read_b64_tr_b16 a[222:223], v247 offset:18432
    v_mfma_f32_16x16x32_bf16 v[128:131], a[48:51], a[108:111], v[128:131]
    v_mfma_f32_16x16x32_bf16 v[132:135], a[52:55], a[108:111], v[132:135]
    v_mfma_f32_16x16x32_bf16 v[136:139], a[56:59], a[108:111], v[136:139]
    v_mfma_f32_16x16x32_bf16 v[140:143], a[60:63], a[108:111], v[140:143]
    s_waitcnt vmcnt(4) lgkmcnt(0)
    v_mfma_f32_16x16x32_bf16 v[16:19], a[0:3], a[112:115], v[16:19]
    s_mul_i32 s46, s60, 14
    s_add_u32 s46, s46, 5
    s_mul_i32 s46, s46, 40960
    s_lshl_b32 s47, s94, 7
    s_add_u32 s46, s46, s47
    s_cmp_eq_u32 s96, 0
    s_cselect_b32 s46, 2146435072, s46
    s_mul_i32 s47, s60, 20480
    s_add_u32 m0, s47, 0
    s_nop 0
    buffer_load_dwordx4 v252, s[8:11], s46 offen lds
    ds_read_b64_tr_b16 a[32:33], v248 offset:24576
    v_mfma_f32_16x16x32_bf16 v[20:23], a[4:7], a[112:115], v[20:23]
    ds_read_b64_tr_b16 a[34:35], v248 offset:28672
    v_mfma_f32_16x16x32_bf16 v[24:27], a[8:11], a[112:115], v[24:27]
    ds_read_b64_tr_b16 a[36:37], v249 offset:24576
    v_mfma_f32_16x16x32_bf16 v[28:31], a[12:15], a[112:115], v[28:31]
    ds_read_b64_tr_b16 a[38:39], v249 offset:28672
    v_mfma_f32_16x16x32_bf16 v[32:35], a[16:19], a[112:115], v[32:35]
    buffer_load_dwordx4 v253, s[8:11], s46 offen offset:1024 lds
    ds_read_b64_tr_b16 a[40:41], v250 offset:24576
    v_mfma_f32_16x16x32_bf16 v[36:39], a[20:23], a[112:115], v[36:39]
    ds_read_b64_tr_b16 a[42:43], v250 offset:28672
    v_mfma_f32_16x16x32_bf16 v[40:43], a[24:27], a[112:115], v[40:43]
    ds_read_b64_tr_b16 a[44:45], v251 offset:24576
    v_mfma_f32_16x16x32_bf16 v[44:47], a[28:31], a[112:115], v[44:47]
    ds_read_b64_tr_b16 a[46:47], v251 offset:28672
    v_mfma_f32_16x16x32_bf16 v[48:51], a[0:3], a[116:119], v[48:51]
    buffer_load_dwordx4 v254, s[8:11], s46 offen offset:2048 lds
    ds_read_b64_tr_b16 a[48:49], v248 offset:25600
    v_mfma_f32_16x16x32_bf16 v[52:55], a[4:7], a[116:119], v[52:55]
    ds_read_b64_tr_b16 a[50:51], v248 offset:29696
    v_mfma_f32_16x16x32_bf16 v[56:59], a[8:11], a[116:119], v[56:59]
    ds_read_b64_tr_b16 a[52:53], v249 offset:25600
    v_mfma_f32_16x16x32_bf16 v[60:63], a[12:15], a[116:119], v[60:63]
    ds_read_b64_tr_b16 a[54:55], v249 offset:29696
    v_mfma_f32_16x16x32_bf16 v[64:67], a[16:19], a[116:119], v[64:67]
    buffer_load_dwordx4 v255, s[8:11], s46 offen offset:3072 lds
    s_add_u32 s46, s46, 40960
    ds_read_b64_tr_b16 a[56:57], v250 offset:25600
    v_mfma_f32_16x16x32_bf16 v[68:71], a[20:23], a[116:119], v[68:71]
    ds_read_b64_tr_b16 a[58:59], v250 offset:29696
    v_mfma_f32_16x16x32_bf16 v[72:75], a[24:27], a[116:119], v[72:75]
    ds_read_b64_tr_b16 a[60:61], v251 offset:25600
    v_mfma_f32_16x16x32_bf16 v[76:79], a[28:31], a[116:119], v[76:79]
    ds_read_b64_tr_b16 a[62:63], v251 offset:29696
    v_mfma_f32_16x16x32_bf16 v[80:83], a[0:3], a[120:123], v[80:83]
    s_add_u32 m0, s47, 4096
    s_nop 0
    buffer_load_dwordx4 v252, s[8:11], s46 offen lds
    v_mfma_f32_16x16x32_bf16 v[84:87], a[4:7], a[120:123], v[84:87]
    v_mfma_f32_16x16x32_bf16 v[88:91], a[8:11], a[120:123], v[88:91]
    v_mfma_f32_16x16x32_bf16 v[92:95], a[12:15], a[120:123], v[92:95]
    v_mfma_f32_16x16x32_bf16 v[96:99], a[16:19], a[120:123], v[96:99]
    buffer_load_dwordx4 v253, s[8:11], s46 offen offset:1024 lds
    v_mfma_f32_16x16x32_bf16 v[100:103], a[20:23], a[120:123], v[100:103]
    v_mfma_f32_16x16x32_bf16 v[104:107], a[24:27], a[120:123], v[104:107]
    v_mfma_f32_16x16x32_bf16 v[108:111], a[28:31], a[120:123], v[108:111]
    v_mfma_f32_16x16x32_bf16 v[112:115], a[0:3], a[124:127], v[112:115]
    buffer_load_dwordx4 v254, s[8:11], s46 offen offset:2048 lds
    v_mfma_f32_16x16x32_bf16 v[116:119], a[4:7], a[124:127], v[116:119]
    v_mfma_f32_16x16x32_bf16 v[120:123], a[8:11], a[124:127], v[120:123]
    v_mfma_f32_16x16x32_bf16 v[124:127], a[12:15], a[124:127], v[124:127]
    v_mfma_f32_16x16x32_bf16 v[128:131], a[16:19], a[124:127], v[128:131]
    buffer_load_dwordx4 v255, s[8:11], s46 offen offset:3072 lds
    s_add_u32 s46, s46, 40960
    v_mfma_f32_16x16x32_bf16 v[132:135], a[20:23], a[124:127], v[132:135]
    v_mfma_f32_16x16x32_bf16 v[136:139], a[24:27], a[124:127], v[136:139]
    v_mfma_f32_16x16x32_bf16 v[140:143], a[28:31], a[124:127], v[140:143]
    s_waitcnt vmcnt(8) lgkmcnt(0)
    v_mfma_f32_16x16x32_bf16 v[16:19], a[32:35], a[128:131], v[16:19]
    s_add_u32 m0, s47, 8192
    s_nop 0
    buffer_load_dwordx4 v252, s[8:11], s46 offen lds
    v_mfma_f32_16x16x32_bf16 v[20:23], a[36:39], a[128:131], v[20:23]
    v_mfma_f32_16x16x32_bf16 v[24:27], a[40:43], a[128:131], v[24:27]
    v_mfma_f32_16x16x32_bf16 v[28:31], a[44:47], a[128:131], v[28:31]
    v_mfma_f32_16x16x32_bf16 v[32:35], a[48:51], a[128:131], v[32:35]
    buffer_load_dwordx4 v253, s[8:11], s46 offen offset:1024 lds
    v_mfma_f32_16x16x32_bf16 v[36:39], a[52:55], a[128:131], v[36:39]
    v_mfma_f32_16x16x32_bf16 v[40:43], a[56:59], a[128:131], v[40:43]
    v_mfma_f32_16x16x32_bf16 v[44:47], a[60:63], a[128:131], v[44:47]
    v_mfma_f32_16x16x32_bf16 v[48:51], a[32:35], a[132:135], v[48:51]
    buffer_load_dwordx4 v254, s[8:11], s46 offen offset:2048 lds
    v_mfma_f32_16x16x32_bf16 v[52:55], a[36:39], a[132:135], v[52:55]
    v_mfma_f32_16x16x32_bf16 v[56:59], a[40:43], a[132:135], v[56:59]
    v_mfma_f32_16x16x32_bf16 v[60:63], a[44:47], a[132:135], v[60:63]
    v_mfma_f32_16x16x32_bf16 v[64:67], a[48:51], a[132:135], v[64:67]
    buffer_load_dwordx4 v255, s[8:11], s46 offen offset:3072 lds
    s_add_u32 s46, s46, 40960
    v_mfma_f32_16x16x32_bf16 v[68:71], a[52:55], a[132:135], v[68:71]
    v_mfma_f32_16x16x32_bf16 v[72:75], a[56:59], a[132:135], v[72:75]
    v_mfma_f32_16x16x32_bf16 v[76:79], a[60:63], a[132:135], v[76:79]
    v_mfma_f32_16x16x32_bf16 v[80:83], a[32:35], a[136:139], v[80:83]
    s_add_u32 m0, s47, 12288
    s_nop 0
    buffer_load_dwordx4 v252, s[8:11], s46 offen lds
    v_mfma_f32_16x16x32_bf16 v[84:87], a[36:39], a[136:139], v[84:87]
    v_mfma_f32_16x16x32_bf16 v[88:91], a[40:43], a[136:139], v[88:91]
    v_mfma_f32_16x16x32_bf16 v[92:95], a[44:47], a[136:139], v[92:95]
    v_mfma_f32_16x16x32_bf16 v[96:99], a[48:51], a[136:139], v[96:99]
    buffer_load_dwordx4 v253, s[8:11], s46 offen offset:1024 lds
    v_mfma_f32_16x16x32_bf16 v[100:103], a[52:55], a[136:139], v[100:103]
    v_mfma_f32_16x16x32_bf16 v[104:107], a[56:59], a[136:139], v[104:107]
    v_mfma_f32_16x16x32_bf16 v[108:111], a[60:63], a[136:139], v[108:111]
    v_mfma_f32_16x16x32_bf16 v[112:115], a[32:35], a[140:143], v[112:115]
    buffer_load_dwordx4 v254, s[8:11], s46 offen offset:2048 lds
    v_mfma_f32_16x16x32_bf16 v[116:119], a[36:39], a[140:143], v[116:119]
    v_mfma_f32_16x16x32_bf16 v[120:123], a[40:43], a[140:143], v[120:123]
    v_mfma_f32_16x16x32_bf16 v[124:127], a[44:47], a[140:143], v[124:127]
    v_mfma_f32_16x16x32_bf16 v[128:131], a[48:51], a[140:143], v[128:131]
    buffer_load_dwordx4 v255, s[8:11], s46 offen offset:3072 lds
    s_add_u32 s46, s46, 40960
    v_mfma_f32_16x16x32_bf16 v[132:135], a[52:55], a[140:143], v[132:135]
    v_mfma_f32_16x16x32_bf16 v[136:139], a[56:59], a[140:143], v[136:139]
    v_mfma_f32_16x16x32_bf16 v[140:143], a[60:63], a[140:143], v[140:143]
    s_add_u32 m0, s47, 16384
    s_nop 0
    buffer_load_dwordx4 v252, s[8:11], s46 offen lds
    buffer_load_dwordx4 v253, s[8:11], s46 offen offset:1024 lds
    buffer_load_dwordx4 v254, s[8:11], s46 offen offset:2048 lds
    buffer_load_dwordx4 v255, s[8:11], s46 offen offset:3072 lds
    s_add_u32 s46, s46, 40960
    s_add_u32 s20, s58, 12582912
    s_addc_u32 s21, s59, 0
    s_mov_b32 s22, 7077888
    s_mov_b32 s23, 0x20000
    s_mul_i32 s66, s81, 54
    s_lshl_b32 s67, s98, 1
    s_add_u32 s66, s66, s67
    s_lshl_b32 s74, s66, 10
    v_lshlrev_b32 v6, 4, v1
    v_pk_fma_f32 v[16:17], v[160:161], v[192:193], v[16:17] op_sel_hi:[1,0,1] neg_lo:[1,0,0] neg_hi:[1,0,0]
    v_pk_fma_f32 v[32:33], v[176:177], v[192:193], v[32:33] op_sel_hi:[1,0,1] neg_lo:[1,0,0] neg_hi:[1,0,0]
    v_pk_fma_f32 v[18:19], v[162:163], v[192:193], v[18:19] op_sel_hi:[1,0,1] neg_lo:[1,0,0] neg_hi:[1,0,0]
    v_pk_fma_f32 v[34:35], v[178:179], v[192:193], v[34:35] op_sel_hi:[1,0,1] neg_lo:[1,0,0] neg_hi:[1,0,0]
    v_max_f32 v16, 0, v16
    v_max_f32 v17, 0, v17
    v_max_f32 v18, 0, v18
    v_max_f32 v19, 0, v19
    v_pk_mul_f32 v[32:33], v[32:33], v[200:201] op_sel_hi:[1,0]
    v_pk_mul_f32 v[34:35], v[34:35], v[200:201] op_sel_hi:[1,0]
    v_pk_mul_f32 v[16:17], v[16:17], v[32:33]
    v_pk_mul_f32 v[18:19], v[18:19], v[34:35]
    v_cvt_pk_bf16_f32 v216, v16, v17
    v_cvt_pk_bf16_f32 v217, v18, v19
    v_pk_fma_f32 v[20:21], v[164:165], v[192:193], v[20:21] op_sel_hi:[1,0,1] neg_lo:[1,0,0] neg_hi:[1,0,0]
    v_pk_fma_f32 v[36:37], v[180:181], v[192:193], v[36:37] op_sel_hi:[1,0,1] neg_lo:[1,0,0] neg_hi:[1,0,0]
    v_pk_fma_f32 v[22:23], v[166:167], v[192:193], v[22:23] op_sel_hi:[1,0,1] neg_lo:[1,0,0] neg_hi:[1,0,0]
    v_pk_fma_f32 v[38:39], v[182:183], v[192:193], v[38:39] op_sel_hi:[1,0,1] neg_lo:[1,0,0] neg_hi:[1,0,0]
    v_max_f32 v20, 0, v20
    v_max_f32 v21, 0, v21
    v_max_f32 v22, 0, v22
    v_max_f32 v23, 0, v23
    v_pk_mul_f32 v[36:37], v[36:37], v[200:201] op_sel_hi:[1,0]
    v_pk_mul_f32 v[38:39], v[38:39], v[200:201] op_sel_hi:[1,0]
    v_pk_mul_f32 v[20:21], v[20:21], v[36:37]
    v_pk_mul_f32 v[22:23], v[22:23], v[38:39]
    v_cvt_pk_bf16_f32 v218, v20, v21
    v_cvt_pk_bf16_f32 v219, v22, v23
    buffer_store_dwordx4 v[216:219], v6, s[20:23], s74 offen offset:0 sc1
    v_pk_fma_f32 v[24:25], v[168:169], v[192:193], v[24:25] op_sel_hi:[1,0,1] neg_lo:[1,0,0] neg_hi:[1,0,0]
    v_pk_fma_f32 v[40:41], v[184:185], v[192:193], v[40:41] op_sel_hi:[1,0,1] neg_lo:[1,0,0] neg_hi:[1,0,0]
    v_pk_fma_f32 v[26:27], v[170:171], v[192:193], v[26:27] op_sel_hi:[1,0,1] neg_lo:[1,0,0] neg_hi:[1,0,0]
    v_pk_fma_f32 v[42:43], v[186:187], v[192:193], v[42:43] op_sel_hi:[1,0,1] neg_lo:[1,0,0] neg_hi:[1,0,0]
    v_max_f32 v24, 0, v24
    v_max_f32 v25, 0, v25
    v_max_f32 v26, 0, v26
    v_max_f32 v27, 0, v27
    v_pk_mul_f32 v[40:41], v[40:41], v[200:201] op_sel_hi:[1,0]
    v_pk_mul_f32 v[42:43], v[42:43], v[200:201] op_sel_hi:[1,0]
    v_pk_mul_f32 v[24:25], v[24:25], v[40:41]
    v_pk_mul_f32 v[26:27], v[26:27], v[42:43]
    v_cvt_pk_bf16_f32 v220, v24, v25
    v_cvt_pk_bf16_f32 v221, v26, v27
    v_pk_fma_f32 v[28:29], v[172:173], v[192:193], v[28:29] op_sel_hi:[1,0,1] neg_lo:[1,0,0] neg_hi:[1,0,0]
    v_pk_fma_f32 v[44:45], v[188:189], v[192:193], v[44:45] op_sel_hi:[1,0,1] neg_lo:[1,0,0] neg_hi:[1,0,0]
    v_pk_fma_f32 v[30:31], v[174:175], v[192:193], v[30:31] op_sel_hi:[1,0,1] neg_lo:[1,0,0] neg_hi:[1,0,0]
    v_pk_fma_f32 v[46:47], v[190:191], v[192:193], v[46:47] op_sel_hi:[1,0,1] neg_lo:[1,0,0] neg_hi:[1,0,0]
    v_max_f32 v28, 0, v28
    v_max_f32 v29, 0, v29
    v_max_f32 v30, 0, v30
    v_max_f32 v31, 0, v31
    v_pk_mul_f32 v[44:45], v[44:45], v[200:201] op_sel_hi:[1,0]
    v_pk_mul_f32 v[46:47], v[46:47], v[200:201] op_sel_hi:[1,0]
    v_pk_mul_f32 v[28:29], v[28:29], v[44:45]
    v_pk_mul_f32 v[30:31], v[30:31], v[46:47]
    v_cvt_pk_bf16_f32 v222, v28, v29
    v_cvt_pk_bf16_f32 v223, v30, v31
    buffer_store_dwordx4 v[220:223], v6, s[20:23], s74 offen offset:1024 sc1
    s_add_u32 s74, s74, 55296
    v_pk_fma_f32 v[48:49], v[160:161], v[194:195], v[48:49] op_sel_hi:[1,0,1] neg_lo:[1,0,0] neg_hi:[1,0,0]
    v_pk_fma_f32 v[64:65], v[176:177], v[194:195], v[64:65] op_sel_hi:[1,0,1] neg_lo:[1,0,0] neg_hi:[1,0,0]
    v_pk_fma_f32 v[50:51], v[162:163], v[194:195], v[50:51] op_sel_hi:[1,0,1] neg_lo:[1,0,0] neg_hi:[1,0,0]
    v_pk_fma_f32 v[66:67], v[178:179], v[194:195], v[66:67] op_sel_hi:[1,0,1] neg_lo:[1,0,0] neg_hi:[1,0,0]
    v_max_f32 v48, 0, v48
    v_max_f32 v49, 0, v49
    v_max_f32 v50, 0, v50
    v_max_f32 v51, 0, v51
    v_pk_mul_f32 v[64:65], v[64:65], v[202:203] op_sel_hi:[1,0]
    v_pk_mul_f32 v[66:67], v[66:67], v[202:203] op_sel_hi:[1,0]
    v_pk_mul_f32 v[48:49], v[48:49], v[64:65]
    v_pk_mul_f32 v[50:51], v[50:51], v[66:67]
    v_cvt_pk_bf16_f32 v216, v48, v49
    v_cvt_pk_bf16_f32 v217, v50, v51
    v_pk_fma_f32 v[52:53], v[164:165], v[194:195], v[52:53] op_sel_hi:[1,0,1] neg_lo:[1,0,0] neg_hi:[1,0,0]
    v_pk_fma_f32 v[68:69], v[180:181], v[194:195], v[68:69] op_sel_hi:[1,0,1] neg_lo:[1,0,0] neg_hi:[1,0,0]
    v_pk_fma_f32 v[54:55], v[166:167], v[194:195], v[54:55] op_sel_hi:[1,0,1] neg_lo:[1,0,0] neg_hi:[1,0,0]
    v_pk_fma_f32 v[70:71], v[182:183], v[194:195], v[70:71] op_sel_hi:[1,0,1] neg_lo:[1,0,0] neg_hi:[1,0,0]
    v_max_f32 v52, 0, v52
    v_max_f32 v53, 0, v53
    v_max_f32 v54, 0, v54
    v_max_f32 v55, 0, v55
    v_pk_mul_f32 v[68:69], v[68:69], v[202:203] op_sel_hi:[1,0]
    v_pk_mul_f32 v[70:71], v[70:71], v[202:203] op_sel_hi:[1,0]
    v_pk_mul_f32 v[52:53], v[52:53], v[68:69]
    v_pk_mul_f32 v[54:55], v[54:55], v[70:71]
    v_cvt_pk_bf16_f32 v218, v52, v53
    v_cvt_pk_bf16_f32 v219, v54, v55
    buffer_store_dwordx4 v[216:219], v6, s[20:23], s74 offen offset:0 sc1
    v_pk_fma_f32 v[56:57], v[168:169], v[194:195], v[56:57] op_sel_hi:[1,0,1] neg_lo:[1,0,0] neg_hi:[1,0,0]
    v_pk_fma_f32 v[72:73], v[184:185], v[194:195], v[72:73] op_sel_hi:[1,0,1] neg_lo:[1,0,0] neg_hi:[1,0,0]
    v_pk_fma_f32 v[58:59], v[170:171], v[194:195], v[58:59] op_sel_hi:[1,0,1] neg_lo:[1,0,0] neg_hi:[1,0,0]
    v_pk_fma_f32 v[74:75], v[186:187], v[194:195], v[74:75] op_sel_hi:[1,0,1] neg_lo:[1,0,0] neg_hi:[1,0,0]
    v_max_f32 v56, 0, v56
    v_max_f32 v57, 0, v57
    v_max_f32 v58, 0, v58
    v_max_f32 v59, 0, v59
    v_pk_mul_f32 v[72:73], v[72:73], v[202:203] op_sel_hi:[1,0]
    v_pk_mul_f32 v[74:75], v[74:75], v[202:203] op_sel_hi:[1,0]
    v_pk_mul_f32 v[56:57], v[56:57], v[72:73]
    v_pk_mul_f32 v[58:59], v[58:59], v[74:75]
    v_cvt_pk_bf16_f32 v220, v56, v57
    v_cvt_pk_bf16_f32 v221, v58, v59
    v_pk_fma_f32 v[60:61], v[172:173], v[194:195], v[60:61] op_sel_hi:[1,0,1] neg_lo:[1,0,0] neg_hi:[1,0,0]
    v_pk_fma_f32 v[76:77], v[188:189], v[194:195], v[76:77] op_sel_hi:[1,0,1] neg_lo:[1,0,0] neg_hi:[1,0,0]
    v_pk_fma_f32 v[62:63], v[174:175], v[194:195], v[62:63] op_sel_hi:[1,0,1] neg_lo:[1,0,0] neg_hi:[1,0,0]
    v_pk_fma_f32 v[78:79], v[190:191], v[194:195], v[78:79] op_sel_hi:[1,0,1] neg_lo:[1,0,0] neg_hi:[1,0,0]
    v_max_f32 v60, 0, v60
    v_max_f32 v61, 0, v61
    v_max_f32 v62, 0, v62
    v_max_f32 v63, 0, v63
    v_pk_mul_f32 v[76:77], v[76:77], v[202:203] op_sel_hi:[1,0]
    v_pk_mul_f32 v[78:79], v[78:79], v[202:203] op_sel_hi:[1,0]
    v_pk_mul_f32 v[60:61], v[60:61], v[76:77]
    v_pk_mul_f32 v[62:63], v[62:63], v[78:79]
    v_cvt_pk_bf16_f32 v222, v60, v61
    v_cvt_pk_bf16_f32 v223, v62, v63
    buffer_store_dwordx4 v[220:223], v6, s[20:23], s74 offen offset:1024 sc1
    s_add_u32 s74, s74, 55296
    v_pk_fma_f32 v[80:81], v[160:161], v[196:197], v[80:81] op_sel_hi:[1,0,1] neg_lo:[1,0,0] neg_hi:[1,0,0]
    v_pk_fma_f32 v[96:97], v[176:177], v[196:197], v[96:97] op_sel_hi:[1,0,1] neg_lo:[1,0,0] neg_hi:[1,0,0]
    v_pk_fma_f32 v[82:83], v[162:163], v[196:197], v[82:83] op_sel_hi:[1,0,1] neg_lo:[1,0,0] neg_hi:[1,0,0]
    v_pk_fma_f32 v[98:99], v[178:179], v[196:197], v[98:99] op_sel_hi:[1,0,1] neg_lo:[1,0,0] neg_hi:[1,0,0]
    v_max_f32 v80, 0, v80
    v_max_f32 v81, 0, v81
    v_max_f32 v82, 0, v82
    v_max_f32 v83, 0, v83
    v_pk_mul_f32 v[96:97], v[96:97], v[204:205] op_sel_hi:[1,0]
    v_pk_mul_f32 v[98:99], v[98:99], v[204:205] op_sel_hi:[1,0]
    v_pk_mul_f32 v[80:81], v[80:81], v[96:97]
    v_pk_mul_f32 v[82:83], v[82:83], v[98:99]
    v_cvt_pk_bf16_f32 v216, v80, v81
    v_cvt_pk_bf16_f32 v217, v82, v83
    v_pk_fma_f32 v[84:85], v[164:165], v[196:197], v[84:85] op_sel_hi:[1,0,1] neg_lo:[1,0,0] neg_hi:[1,0,0]
    v_pk_fma_f32 v[100:101], v[180:181], v[196:197], v[100:101] op_sel_hi:[1,0,1] neg_lo:[1,0,0] neg_hi:[1,0,0]
    v_pk_fma_f32 v[86:87], v[166:167], v[196:197], v[86:87] op_sel_hi:[1,0,1] neg_lo:[1,0,0] neg_hi:[1,0,0]
    v_pk_fma_f32 v[102:103], v[182:183], v[196:197], v[102:103] op_sel_hi:[1,0,1] neg_lo:[1,0,0] neg_hi:[1,0,0]
    v_max_f32 v84, 0, v84
    v_max_f32 v85, 0, v85
    v_max_f32 v86, 0, v86
    v_max_f32 v87, 0, v87
    v_pk_mul_f32 v[100:101], v[100:101], v[204:205] op_sel_hi:[1,0]
    v_pk_mul_f32 v[102:103], v[102:103], v[204:205] op_sel_hi:[1,0]
    v_pk_mul_f32 v[84:85], v[84:85], v[100:101]
    v_pk_mul_f32 v[86:87], v[86:87], v[102:103]
    v_cvt_pk_bf16_f32 v218, v84, v85
    v_cvt_pk_bf16_f32 v219, v86, v87
    buffer_store_dwordx4 v[216:219], v6, s[20:23], s74 offen offset:0 sc1
    v_pk_fma_f32 v[88:89], v[168:169], v[196:197], v[88:89] op_sel_hi:[1,0,1] neg_lo:[1,0,0] neg_hi:[1,0,0]
    v_pk_fma_f32 v[104:105], v[184:185], v[196:197], v[104:105] op_sel_hi:[1,0,1] neg_lo:[1,0,0] neg_hi:[1,0,0]
    v_pk_fma_f32 v[90:91], v[170:171], v[196:197], v[90:91] op_sel_hi:[1,0,1] neg_lo:[1,0,0] neg_hi:[1,0,0]
    v_pk_fma_f32 v[106:107], v[186:187], v[196:197], v[106:107] op_sel_hi:[1,0,1] neg_lo:[1,0,0] neg_hi:[1,0,0]
    v_max_f32 v88, 0, v88
    v_max_f32 v89, 0, v89
    v_max_f32 v90, 0, v90
    v_max_f32 v91, 0, v91
    v_pk_mul_f32 v[104:105], v[104:105], v[204:205] op_sel_hi:[1,0]
    v_pk_mul_f32 v[106:107], v[106:107], v[204:205] op_sel_hi:[1,0]
    v_pk_mul_f32 v[88:89], v[88:89], v[104:105]
    v_pk_mul_f32 v[90:91], v[90:91], v[106:107]
    v_cvt_pk_bf16_f32 v220, v88, v89
    v_cvt_pk_bf16_f32 v221, v90, v91
    v_pk_fma_f32 v[92:93], v[172:173], v[196:197], v[92:93] op_sel_hi:[1,0,1] neg_lo:[1,0,0] neg_hi:[1,0,0]
    v_pk_fma_f32 v[108:109], v[188:189], v[196:197], v[108:109] op_sel_hi:[1,0,1] neg_lo:[1,0,0] neg_hi:[1,0,0]
    v_pk_fma_f32 v[94:95], v[174:175], v[196:197], v[94:95] op_sel_hi:[1,0,1] neg_lo:[1,0,0] neg_hi:[1,0,0]
    v_pk_fma_f32 v[110:111], v[190:191], v[196:197], v[110:111] op_sel_hi:[1,0,1] neg_lo:[1,0,0] neg_hi:[1,0,0]
    v_max_f32 v92, 0, v92
    v_max_f32 v93, 0, v93
    v_max_f32 v94, 0, v94
    v_max_f32 v95, 0, v95
    v_pk_mul_f32 v[108:109], v[108:109], v[204:205] op_sel_hi:[1,0]
    v_pk_mul_f32 v[110:111], v[110:111], v[204:205] op_sel_hi:[1,0]
    v_pk_mul_f32 v[92:93], v[92:93], v[108:109]
    v_pk_mul_f32 v[94:95], v[94:95], v[110:111]
    v_cvt_pk_bf16_f32 v222, v92, v93
    v_cvt_pk_bf16_f32 v223, v94, v95
    buffer_store_dwordx4 v[220:223], v6, s[20:23], s74 offen offset:1024 sc1
    s_add_u32 s74, s74, 55296
    v_pk_fma_f32 v[112:113], v[160:161], v[198:199], v[112:113] op_sel_hi:[1,0,1] neg_lo:[1,0,0] neg_hi:[1,0,0]
    v_pk_fma_f32 v[128:129], v[176:177], v[198:199], v[128:129] op_sel_hi:[1,0,1] neg_lo:[1,0,0] neg_hi:[1,0,0]
    v_pk_fma_f32 v[114:115], v[162:163], v[198:199], v[114:115] op_sel_hi:[1,0,1] neg_lo:[1,0,0] neg_hi:[1,0,0]
    v_pk_fma_f32 v[130:131], v[178:179], v[198:199], v[130:131] op_sel_hi:[1,0,1] neg_lo:[1,0,0] neg_hi:[1,0,0]
    v_max_f32 v112, 0, v112
    v_max_f32 v113, 0, v113
    v_max_f32 v114, 0, v114
    v_max_f32 v115, 0, v115
    v_pk_mul_f32 v[128:129], v[128:129], v[206:207] op_sel_hi:[1,0]
    v_pk_mul_f32 v[130:131], v[130:131], v[206:207] op_sel_hi:[1,0]
    v_pk_mul_f32 v[112:113], v[112:113], v[128:129]
    v_pk_mul_f32 v[114:115], v[114:115], v[130:131]
    v_cvt_pk_bf16_f32 v216, v112, v113
    v_cvt_pk_bf16_f32 v217, v114, v115
    v_pk_fma_f32 v[116:117], v[164:165], v[198:199], v[116:117] op_sel_hi:[1,0,1] neg_lo:[1,0,0] neg_hi:[1,0,0]
    v_pk_fma_f32 v[132:133], v[180:181], v[198:199], v[132:133] op_sel_hi:[1,0,1] neg_lo:[1,0,0] neg_hi:[1,0,0]
    v_pk_fma_f32 v[118:119], v[166:167], v[198:199], v[118:119] op_sel_hi:[1,0,1] neg_lo:[1,0,0] neg_hi:[1,0,0]
    v_pk_fma_f32 v[134:135], v[182:183], v[198:199], v[134:135] op_sel_hi:[1,0,1] neg_lo:[1,0,0] neg_hi:[1,0,0]
    v_max_f32 v116, 0, v116
    v_max_f32 v117, 0, v117
    v_max_f32 v118, 0, v118
    v_max_f32 v119, 0, v119
    v_pk_mul_f32 v[132:133], v[132:133], v[206:207] op_sel_hi:[1,0]
    v_pk_mul_f32 v[134:135], v[134:135], v[206:207] op_sel_hi:[1,0]
    v_pk_mul_f32 v[116:117], v[116:117], v[132:133]
    v_pk_mul_f32 v[118:119], v[118:119], v[134:135]
    v_cvt_pk_bf16_f32 v218, v116, v117
    v_cvt_pk_bf16_f32 v219, v118, v119
    buffer_store_dwordx4 v[216:219], v6, s[20:23], s74 offen offset:0 sc1
    v_pk_fma_f32 v[120:121], v[168:169], v[198:199], v[120:121] op_sel_hi:[1,0,1] neg_lo:[1,0,0] neg_hi:[1,0,0]
    v_pk_fma_f32 v[136:137], v[184:185], v[198:199], v[136:137] op_sel_hi:[1,0,1] neg_lo:[1,0,0] neg_hi:[1,0,0]
    v_pk_fma_f32 v[122:123], v[170:171], v[198:199], v[122:123] op_sel_hi:[1,0,1] neg_lo:[1,0,0] neg_hi:[1,0,0]
    v_pk_fma_f32 v[138:139], v[186:187], v[198:199], v[138:139] op_sel_hi:[1,0,1] neg_lo:[1,0,0] neg_hi:[1,0,0]
    v_max_f32 v120, 0, v120
    v_max_f32 v121, 0, v121
    v_max_f32 v122, 0, v122
    v_max_f32 v123, 0, v123
    v_pk_mul_f32 v[136:137], v[136:137], v[206:207] op_sel_hi:[1,0]
    v_pk_mul_f32 v[138:139], v[138:139], v[206:207] op_sel_hi:[1,0]
    v_pk_mul_f32 v[120:121], v[120:121], v[136:137]
    v_pk_mul_f32 v[122:123], v[122:123], v[138:139]
    v_cvt_pk_bf16_f32 v220, v120, v121
    v_cvt_pk_bf16_f32 v221, v122, v123
    v_pk_fma_f32 v[124:125], v[172:173], v[198:199], v[124:125] op_sel_hi:[1,0,1] neg_lo:[1,0,0] neg_hi:[1,0,0]
    v_pk_fma_f32 v[140:141], v[188:189], v[198:199], v[140:141] op_sel_hi:[1,0,1] neg_lo:[1,0,0] neg_hi:[1,0,0]
    v_pk_fma_f32 v[126:127], v[174:175], v[198:199], v[126:127] op_sel_hi:[1,0,1] neg_lo:[1,0,0] neg_hi:[1,0,0]
    v_pk_fma_f32 v[142:143], v[190:191], v[198:199], v[142:143] op_sel_hi:[1,0,1] neg_lo:[1,0,0] neg_hi:[1,0,0]
    v_max_f32 v124, 0, v124
    v_max_f32 v125, 0, v125
    v_max_f32 v126, 0, v126
    v_max_f32 v127, 0, v127
    v_pk_mul_f32 v[140:141], v[140:141], v[206:207] op_sel_hi:[1,0]
    v_pk_mul_f32 v[142:143], v[142:143], v[206:207] op_sel_hi:[1,0]
    v_pk_mul_f32 v[124:125], v[124:125], v[140:141]
    v_pk_mul_f32 v[126:127], v[126:127], v[142:143]
    v_cvt_pk_bf16_f32 v222, v124, v125
    v_cvt_pk_bf16_f32 v223, v126, v127
    buffer_store_dwordx4 v[220:223], v6, s[20:23], s74 offen offset:1024 sc1
    s_waitcnt vmcnt(0)
    s_barrier
    s_add_u32 s66, s97, 72
    s_cmp_lg_u32 s60, 0
    s_cbranch_scc1 L_sig_26
    s_lshl_b32 s71, s66, 7
    v_mov_b32 v4, s71
    v_mov_b32 v5, 1
    s_mov_b64 exec, 1
    buffer_atomic_add v5, v4, s[24:27], 0 offen sc1
    s_mov_b64 exec, -1
L_sig_26:
    s_branch L_p4join_27
L_p4end_22:
    s_waitcnt vmcnt(0)
    s_barrier
    s_mov_b32 s8, s52
    s_mov_b32 s9, s53
    s_mov_b32 s10, 2211840
    s_mov_b32 s11, 0x20000
    s_mul_i32 s46, s60, 14
    s_add_u32 s46, s46, 0
    s_mul_i32 s46, s46, 40960
    s_lshl_b32 s47, s94, 7
    s_add_u32 s46, s46, s47
    s_cmp_eq_u32 s96, 0
    s_cselect_b32 s46, 2146435072, s46
    s_mul_i32 s47, s60, 20480
    s_add_u32 m0, s47, 0
    s_nop 0
    buffer_load_dwordx4 v252, s[8:11], s46 offen lds
    buffer_load_dwordx4 v253, s[8:11], s46 offen offset:1024 lds
    buffer_load_dwordx4 v254, s[8:11], s46 offen offset:2048 lds
    buffer_load_dwordx4 v255, s[8:11], s46 offen offset:3072 lds
    s_add_u32 s46, s46, 40960
    s_add_u32 m0, s47, 4096
    s_nop 0
    buffer_load_dwordx4 v252, s[8:11], s46 offen lds
    buffer_load_dwordx4 v253, s[8:11], s46 offen offset:1024 lds
    buffer_load_dwordx4 v254, s[8:11], s46 offen offset:2048 lds
    buffer_load_dwordx4 v255, s[8:11], s46 offen offset:3072 lds
    s_add_u32 s46, s46, 40960
    s_add_u32 m0, s47, 8192
    s_nop 0
    buffer_load_dwordx4 v252, s[8:11], s46 offen lds
    buffer_load_dwordx4 v253, s[8:11], s46 offen offset:1024 lds
    buffer_load_dwordx4 v254, s[8:11], s46 offen offset:2048 lds
    buffer_load_dwordx4 v255, s[8:11], s46 offen offset:3072 lds
    s_add_u32 s46, s46, 40960
    s_add_u32 m0, s47, 12288
    s_nop 0
    buffer_load_dwordx4 v252, s[8:11], s46 offen lds
    buffer_load_dwordx4 v253, s[8:11], s46 offen offset:1024 lds
    buffer_load_dwordx4 v254, s[8:11], s46 offen offset:2048 lds
    buffer_load_dwordx4 v255, s[8:11], s46 offen offset:3072 lds
    s_add_u32 s46, s46, 40960
    s_add_u32 m0, s47, 16384
    s_nop 0
    buffer_load_dwordx4 v252, s[8:11], s46 offen lds
    buffer_load_dwordx4 v253, s[8:11], s46 offen offset:1024 lds
    buffer_load_dwordx4 v254, s[8:11], s46 offen offset:2048 lds
    buffer_load_dwordx4 v255, s[8:11], s46 offen offset:3072 lds
    s_add_u32 s46, s46, 40960
    s_mul_i32 s66, s60, 20480
    s_and_b32 s67, s60, 1
    s_lshl_b32 s67, s67, 1
    v_bfe_u32 v2, v1, 2, 2
    v_lshrrev_b32 v3, 4, v1
    v_lshl_add_u32 v2, v3, 2, v2
    v_bfe_u32 v3, v2, 1, 2
    v_and_b32 v4, 3, v1
    v_lshlrev_b32 v4, 3, v4
    v_lshl_add_u32 v2, v2, 7, v4
    v_add_u32 v2, s66, v2
    v_xor_b32 v3, s67, v3
    v_xor_b32 v4, 0, v3
    v_lshl_add_u32 v244, v4, 5, v2
    v_xor_b32 v4, 1, v3
    v_lshl_add_u32 v245, v4, 5, v2
    v_xor_b32 v4, 2, v3
    v_lshl_add_u32 v246, v4, 5, v2
    v_xor_b32 v4, 3, v3
    v_lshl_add_u32 v247, v4, 5, v2
    s_waitcnt vmcnt(0)
    ds_read_b64_tr_b16 a[144:145], v244 offset:0
    ds_read_b64_tr_b16 a[146:147], v244 offset:2048
    ds_read_b64_tr_b16 a[148:149], v245 offset:0
    ds_read_b64_tr_b16 a[150:151], v245 offset:2048
    ds_read_b64_tr_b16 a[152:153], v246 offset:0
    ds_read_b64_tr_b16 a[154:155], v246 offset:2048
    ds_read_b64_tr_b16 a[156:157], v247 offset:0
    ds_read_b64_tr_b16 a[158:159], v247 offset:2048
    ds_read_b64_tr_b16 a[160:161], v244 offset:4096
    ds_read_b64_tr_b16 a[162:163], v244 offset:6144
    ds_read_b64_tr_b16 a[164:165], v245 offset:4096
    ds_read_b64_tr_b16 a[166:167], v245 offset:6144
    ds_read_b64_tr_b16 a[168:169], v246 offset:4096
    ds_read_b64_tr_b16 a[170:171], v246 offset:6144
    ds_read_b64_tr_b16 a[172:173], v247 offset:4096
    ds_read_b64_tr_b16 a[174:175], v247 offset:6144
    ds_read_b64_tr_b16 a[176:177], v244 offset:8192
    ds_read_b64_tr_b16 a[178:179], v244 offset:10240
    ds_read_b64_tr_b16 a[180:181], v245 offset:8192
    ds_read_b64_tr_b16 a[182:183], v245 offset:10240
    ds_read_b64_tr_b16 a[184:185], v246 offset:8192
    ds_read_b64_tr_b16 a[186:187], v246 offset:10240
    ds_read_b64_tr_b16 a[188:189], v247 offset:8192
    ds_read_b64_tr_b16 a[190:191], v247 offset:10240
    ds_read_b64_tr_b16 a[192:193], v244 offset:12288
    ds_read_b64_tr_b16 a[194:195], v244 offset:14336
    ds_read_b64_tr_b16 a[196:197], v245 offset:12288
    ds_read_b64_tr_b16 a[198:199], v245 offset:14336
    ds_read_b64_tr_b16 a[200:201], v246 offset:12288
    ds_read_b64_tr_b16 a[202:203], v246 offset:14336
    ds_read_b64_tr_b16 a[204:205], v247 offset:12288
    ds_read_b64_tr_b16 a[206:207], v247 offset:14336
    ds_read_b64_tr_b16 a[208:209], v244 offset:16384
    ds_read_b64_tr_b16 a[210:211], v244 offset:18432
    ds_read_b64_tr_b16 a[212:213], v245 offset:16384
    ds_read_b64_tr_b16 a[214:215], v245 offset:18432
    ds_read_b64_tr_b16 a[216:217], v246 offset:16384
    ds_read_b64_tr_b16 a[218:219], v246 offset:18432
    ds_read_b64_tr_b16 a[220:221], v247 offset:16384
    ds_read_b64_tr_b16 a[222:223], v247 offset:18432
    s_waitcnt lgkmcnt(0)
    s_mul_i32 s46, s60, 14
    s_add_u32 s46, s46, 5
    s_mul_i32 s46, s46, 40960
    s_lshl_b32 s47, s94, 7
    s_add_u32 s46, s46, s47
    s_cmp_eq_u32 s96, 0
    s_cselect_b32 s46, 2146435072, s46
    s_mul_i32 s47, s60, 20480
    s_add_u32 m0, s47, 0
    s_nop 0
    buffer_load_dwordx4 v252, s[8:11], s46 offen lds
    buffer_load_dwordx4 v253, s[8:11], s46 offen offset:1024 lds
    buffer_load_dwordx4 v254, s[8:11], s46 offen offset:2048 lds
    buffer_load_dwordx4 v255, s[8:11], s46 offen offset:3072 lds
    s_add_u32 s46, s46, 40960
    s_add_u32 m0, s47, 4096
    s_nop 0
    buffer_load_dwordx4 v252, s[8:11], s46 offen lds
    buffer_load_dwordx4 v253, s[8:11], s46 offen offset:1024 lds
    buffer_load_dwordx4 v254, s[8:11], s46 offen offset:2048 lds
    buffer_load_dwordx4 v255, s[8:11], s46 offen offset:3072 lds
    s_add_u32 s46, s46, 40960
    s_add_u32 m0, s47, 8192
    s_nop 0
    buffer_load_dwordx4 v252, s[8:11], s46 offen lds
    buffer_load_dwordx4 v253, s[8:11], s46 offen offset:1024 lds
    buffer_load_dwordx4 v254, s[8:11], s46 offen offset:2048 lds
    buffer_load_dwordx4 v255, s[8:11], s46 offen offset:3072 lds
    s_add_u32 s46, s46, 40960
    s_add_u32 m0, s47, 12288
    s_nop 0
    buffer_load_dwordx4 v252, s[8:11], s46 offen lds
    buffer_load_dwordx4 v253, s[8:11], s46 offen offset:1024 lds
    buffer_load_dwordx4 v254, s[8:11], s46 offen offset:2048 lds
    buffer_load_dwordx4 v255, s[8:11], s46 offen offset:3072 lds
    s_add_u32 s46, s46, 40960
    s_add_u32 m0, s47, 16384
    s_nop 0
    buffer_load_dwordx4 v252, s[8:11], s46 offen lds
    buffer_load_dwordx4 v253, s[8:11], s46 offen offset:1024 lds
    buffer_load_dwordx4 v254, s[8:11], s46 offen offset:2048 lds
    buffer_load_dwordx4 v255, s[8:11], s46 offen offset:3072 lds
    s_add_u32 s46, s46, 40960
    s_waitcnt vmcnt(0)
L_p4join_27:
    s_cmp_eq_u32 s96, 0
    s_cbranch_scc1 L_p5end_28
    s_mul_i32 s46, s60, 14
    s_add_u32 s46, s46, 10
    s_mul_i32 s46, s46, 40960
    s_lshl_b32 s47, s94, 7
    s_add_u32 s46, s46, s47
    s_cmp_eq_u32 s96, 0
    s_cselect_b32 s46, 2146435072, s46
    s_mul_i32 s47, s60, 20480
    s_add_u32 m0, s47, 81920
    s_nop 0
    buffer_load_dwordx4 v252, s[8:11], s46 offen lds
    buffer_load_dwordx4 v253, s[8:11], s46 offen offset:1024 lds
    buffer_load_dwordx4 v254, s[8:11], s46 offen offset:2048 lds
    buffer_load_dwordx4 v255, s[8:11], s46 offen offset:3072 lds
    s_add_u32 s46, s46, 40960
    s_add_u32 m0, s47, 86016
    s_nop 0
    buffer_load_dwordx4 v252, s[8:11], s46 offen lds
    buffer_load_dwordx4 v253, s[8:11], s46 offen offset:1024 lds
    buffer_load_dwordx4 v254, s[8:11], s46 offen offset:2048 lds
    buffer_load_dwordx4 v255, s[8:11], s46 offen offset:3072 lds
    s_add_u32 s46, s46, 40960
    s_add_u32 m0, s47, 90112
    s_nop 0
    buffer_load_dwordx4 v252, s[8:11], s46 offen lds
    buffer_load_dwordx4 v253, s[8:11], s46 offen offset:1024 lds
    buffer_load_dwordx4 v254, s[8:11], s46 offen offset:2048 lds
    buffer_load_dwordx4 v255, s[8:11], s46 offen offset:3072 lds
    s_add_u32 s46, s46, 40960
    s_add_u32 m0, s47, 94208
    s_nop 0
    buffer_load_dwordx4 v252, s[8:11], s46 offen lds
    buffer_load_dwordx4 v253, s[8:11], s46 offen offset:1024 lds
    buffer_load_dwordx4 v254, s[8:11], s46 offen offset:2048 lds
    buffer_load_dwordx4 v255, s[8:11], s46 offen offset:3072 lds
    s_add_u32 s46, s46, 40960
    v_add_u32 v248, 81920, v244
    v_add_u32 v249, 81920, v245
    v_add_u32 v250, 81920, v246
    v_add_u32 v251, 81920, v247
    ds_read_b64_tr_b16 a[0:1], v244 offset:0
    ds_read_b64_tr_b16 a[2:3], v244 offset:2048
    ds_read_b64_tr_b16 a[4:5], v245 offset:0
    ds_read_b64_tr_b16 a[6:7], v245 offset:2048
    ds_read_b64_tr_b16 a[8:9], v246 offset:0
    ds_read_b64_tr_b16 a[10:11], v246 offset:2048
    ds_read_b64_tr_b16 a[12:13], v247 offset:0
    ds_read_b64_tr_b16 a[14:15], v247 offset:2048
    ds_read_b64_tr_b16 a[16:17], v244 offset:4096
    ds_read_b64_tr_b16 a[18:19], v244 offset:6144
    ds_read_b64_tr_b16 a[20:21], v245 offset:4096
    ds_read_b64_tr_b16 a[22:23], v245 offset:6144
    ds_read_b64_tr_b16 a[24:25], v246 offset:4096
    ds_read_b64_tr_b16 a[26:27], v246 offset:6144
    ds_read_b64_tr_b16 a[28:29], v247 offset:4096
    ds_read_b64_tr_b16 a[30:31], v247 offset:6144
    ds_read_b64_tr_b16 a[32:33], v244 offset:8192
    ds_read_b64_tr_b16 a[34:35], v244 offset:10240
    ds_read_b64_tr_b16 a[36:37], v245 offset:8192
    ds_read_b64_tr_b16 a[38:39], v245 offset:10240
    ds_read_b64_tr_b16 a[40:41], v246 offset:8192
    ds_read_b64_tr_b16 a[42:43], v246 offset:10240
    ds_read_b64_tr_b16 a[44:45], v247 offset:8192
    ds_read_b64_tr_b16 a[46:47], v247 offset:10240
    ds_read_b64_tr_b16 a[48:49], v244 offset:12288
    ds_read_b64_tr_b16 a[50:51], v244 offset:14336
    ds_read_b64_tr_b16 a[52:53], v245 offset:12288
    ds_read_b64_tr_b16 a[54:55], v245 offset:14336
    ds_read_b64_tr_b16 a[56:57], v246 offset:12288
    ds_read_b64_tr_b16 a[58:59], v246 offset:14336
    ds_read_b64_tr_b16 a[60:61], v247 offset:12288
    ds_read_b64_tr_b16 a[62:63], v247 offset:14336
    ds_read_b64_tr_b16 a[64:65], v244 offset:16384
    ds_read_b64_tr_b16 a[66:67], v244 offset:18432
    ds_read_b64_tr_b16 a[68:69], v245 offset:16384
    ds_read_b64_tr_b16 a[70:71], v245 offset:18432
    ds_read_b64_tr_b16 a[72:73], v246 offset:16384
    ds_read_b64_tr_b16 a[74:75], v246 offset:18432
    ds_read_b64_tr_b16 a[76:77], v247 offset:16384
    ds_read_b64_tr_b16 a[78:79], v247 offset:18432
    s_xor_b32 s66, s60, 1
    s_mul_i32 s66, s66, 18432
    s_add_u32 s66, s66, 90112
    v_lshl_add_u32 v232, v1, 4, s66
    s_xor_b32 s66, s60, 2
    s_mul_i32 s66, s66, 18432
    s_add_u32 s66, s66, 96256
    v_lshl_add_u32 v233, v1, 4, s66
    s_xor_b32 s66, s60, 3
    s_mul_i32 s66, s66, 18432
    s_add_u32 s66, s66, 102400
    v_lshl_add_u32 v234, v1, 4, s66
    s_mul_i32 s66, s60, 18432
    s_add_u32 s66, s66, 90112
    v_lshl_add_u32 v235, v1, 4, s66
    s_add_u32 s16, s58, 12582912
    s_addc_u32 s17, s59, 0
    s_mov_b32 s18, 7077888
    s_mov_b32 s19, 0x20000
    v_lshlrev_b32 v2, 4, v1
    s_lshr_b32 s66, s60, 1
    s_mul_i32 s66, s66, 165888
    s_add_u32 s67, s66, 0
    v_add_u32 v236, s67, v2
    s_add_u32 s67, s66, 55296
    v_add_u32 v237, s67, v2
    s_add_u32 s67, s66, 110592
    v_add_u32 v238, s67, v2
    s_sub_u32 s67, 165888, s66
    v_add_u32 v239, s67, v2
    s_sub_u32 s67, 221184, s66
    v_add_u32 v240, s67, v2
    s_sub_u32 s67, 276480, s66
    v_add_u32 v241, s67, v2
    s_mul_i32 s66, s95, 324
    s_mul_i32 s68, s60, 14
    s_add_u32 s66, s66, s68
    s_lshl_b32 s72, s66, 10
    s_waitcnt vmcnt(0)
    ds_read_b64_tr_b16 a[80:81], v248 offset:0
    ds_read_b64_tr_b16 a[82:83], v248 offset:2048
    ds_read_b64_tr_b16 a[84:85], v249 offset:0
    ds_read_b64_tr_b16 a[86:87], v249 offset:2048
    ds_read_b64_tr_b16 a[88:89], v250 offset:0
    ds_read_b64_tr_b16 a[90:91], v250 offset:2048
    ds_read_b64_tr_b16 a[92:93], v251 offset:0
    ds_read_b64_tr_b16 a[94:95], v251 offset:2048
    ds_read_b64_tr_b16 a[96:97], v248 offset:4096
    ds_read_b64_tr_b16 a[98:99], v248 offset:6144
    ds_read_b64_tr_b16 a[100:101], v249 offset:4096
    ds_read_b64_tr_b16 a[102:103], v249 offset:6144
    ds_read_b64_tr_b16 a[104:105], v250 offset:4096
    ds_read_b64_tr_b16 a[106:107], v250 offset:6144
    ds_read_b64_tr_b16 a[108:109], v251 offset:4096
    ds_read_b64_tr_b16 a[110:111], v251 offset:6144
    ds_read_b64_tr_b16 a[112:113], v248 offset:8192
    ds_read_b64_tr_b16 a[114:115], v248 offset:10240
    ds_read_b64_tr_b16 a[116:117], v249 offset:8192
    ds_read_b64_tr_b16 a[118:119], v249 offset:10240
    ds_read_b64_tr_b16 a[120:121], v250 offset:8192
    ds_read_b64_tr_b16 a[122:123], v250 offset:10240
    ds_read_b64_tr_b16 a[124:125], v251 offset:8192
    ds_read_b64_tr_b16 a[126:127], v251 offset:10240
    ds_read_b64_tr_b16 a[128:129], v248 offset:12288
    ds_read_b64_tr_b16 a[130:131], v248 offset:14336
    ds_read_b64_tr_b16 a[132:133], v249 offset:12288
    ds_read_b64_tr_b16 a[134:135], v249 offset:14336
    ds_read_b64_tr_b16 a[136:137], v250 offset:12288
    ds_read_b64_tr_b16 a[138:139], v250 offset:14336
    ds_read_b64_tr_b16 a[140:141], v251 offset:12288
    ds_read_b64_tr_b16 a[142:143], v251 offset:14336
    s_waitcnt lgkmcnt(0)
    s_cmp_lg_u32 s60, 0
    s_cbranch_scc1 L_pskip_29
    s_mul_i32 s66, s95, 6
    s_lshr_b32 s67, s66, 4
    s_add_u32 s66, s66, 5
    s_min_u32 s66, s66, 127
    s_lshr_b32 s66, s66, 4
    v_add_u32 v2, s67, v1
    v_min_u32 v2, s66, v2
    v_add_u32 v2, 72, v2
    v_lshlrev_b32 v2, 7, v2
    s_mov_b64 exec, 3
    s_mov_b32 s71, 0
L_poll_30:
    buffer_load_dword v3, v2, s[24:27], 0 offen sc1
    s_add_u32 s71, s71, 1
    s_waitcnt vmcnt(0)
    v_cmp_gt_u32 vcc, 27, v3
    s_nop 4
    s_cbranch_vccz L_got_31
    s_cmp_lt_u32 s71, 0x40000
    s_cbranch_scc1 L_poll_30
L_got_31:
    s_mov_b64 exec, -1
L_pskip_29:
    s_barrier
    s_mul_i32 s73, s60, 14
    s_mov_b32 s74, s72
    buffer_load_dwordx4 v[112:115], v239, s[16:19], s74 offen sc1
    buffer_load_dwordx4 v[116:119], v240, s[16:19], s74 offen sc1
    buffer_load_dwordx4 v[120:123], v241, s[16:19], s74 offen sc1
    s_add_u32 s74, s74, 1024
    buffer_load_dwordx4 v[124:127], v239, s[16:19], s74 offen sc1
    buffer_load_dwordx4 v[128:131], v240, s[16:19], s74 offen sc1
    buffer_load_dwordx4 v[132:135], v241, s[16:19], s74 offen sc1
    s_add_u32 s74, s74, 1024
    buffer_load_dwordx4 v[136:139], v239, s[16:19], s74 offen sc1
    buffer_load_dwordx4 v[140:143], v240, s[16:19], s74 offen sc1
    buffer_load_dwordx4 v[144:147], v241, s[16:19], s74 offen sc1
    s_add_u32 s74, s74, 1024
    buffer_load_dwordx4 v[148:151], v239, s[16:19], s74 offen sc1
    buffer_load_dwordx4 v[152:155], v240, s[16:19], s74 offen sc1
    buffer_load_dwordx4 v[156:159], v241, s[16:19], s74 offen sc1
    s_add_u32 s74, s74, 1024
    buffer_load_dwordx4 v[160:163], v239, s[16:19], s74 offen sc1
    buffer_load_dwordx4 v[164:167], v240, s[16:19], s74 offen sc1
    buffer_load_dwordx4 v[168:171], v241, s[16:19], s74 offen sc1
    s_add_u32 s74, s74, 1024
    buffer_load_dwordx4 v[172:175], v239, s[16:19], s74 offen sc1
    buffer_load_dwordx4 v[176:179], v240, s[16:19], s74 offen sc1
    buffer_load_dwordx4 v[180:183], v241, s[16:19], s74 offen sc1
    s_add_u32 s74, s74, 1024
    s_waitcnt vmcnt(15)
    v_mfma_f32_16x16x32_bf16 v[72:75], a[152:155], v[112:115], 0
    buffer_load_dwordx4 v[184:187], v239, s[16:19], s74 offen sc1
    v_mfma_f32_16x16x32_bf16 v[76:79], a[156:159], v[112:115], 0
    v_mfma_f32_16x16x32_bf16 v[64:67], a[144:147], v[112:115], 0
    v_mfma_f32_16x16x32_bf16 v[68:71], a[148:151], v[112:115], 0
    buffer_load_dwordx4 v[188:191], v240, s[16:19], s74 offen sc1
    v_mfma_f32_16x16x32_bf16 v[88:91], a[152:155], v[116:119], 0
    v_mfma_f32_16x16x32_bf16 v[92:95], a[156:159], v[116:119], 0
    v_mfma_f32_16x16x32_bf16 v[80:83], a[144:147], v[116:119], 0
    buffer_load_dwordx4 v[192:195], v241, s[16:19], s74 offen sc1
    s_add_u32 s74, s74, 1024
    v_mfma_f32_16x16x32_bf16 v[84:87], a[148:151], v[116:119], 0
    v_mfma_f32_16x16x32_bf16 v[104:107], a[152:155], v[120:123], 0
    v_mfma_f32_16x16x32_bf16 v[108:111], a[156:159], v[120:123], 0
    buffer_load_dwordx4 v[196:199], v239, s[16:19], s74 offen sc1
    v_mfma_f32_16x16x32_bf16 v[96:99], a[144:147], v[120:123], 0
    v_mfma_f32_16x16x32_bf16 v[100:103], a[148:151], v[120:123], 0
    s_waitcnt vmcnt(16)
    v_mfma_f32_16x16x32_bf16 v[72:75], a[168:171], v[124:127], v[72:75]
    buffer_load_dwordx4 v[200:203], v240, s[16:19], s74 offen sc1
    v_mfma_f32_16x16x32_bf16 v[76:79], a[172:175], v[124:127], v[76:79]
    v_mfma_f32_16x16x32_bf16 v[64:67], a[160:163], v[124:127], v[64:67]
    v_mfma_f32_16x16x32_bf16 v[68:71], a[164:167], v[124:127], v[68:71]
    buffer_load_dwordx4 v[204:207], v241, s[16:19], s74 offen sc1
    s_add_u32 s74, s74, 1024
    v_mfma_f32_16x16x32_bf16 v[88:91], a[168:171], v[128:131], v[88:91]
    v_mfma_f32_16x16x32_bf16 v[92:95], a[172:175], v[128:131], v[92:95]
    v_mfma_f32_16x16x32_bf16 v[80:83], a[160:163], v[128:131], v[80:83]
    buffer_load_dwordx4 v[112:115], v239, s[16:19], s74 offen sc1
    v_mfma_f32_16x16x32_bf16 v[84:87], a[164:167], v[128:131], v[84:87]
    v_mfma_f32_16x16x32_bf16 v[104:107], a[168:171], v[132:135], v[104:107]
    v_mfma_f32_16x16x32_bf16 v[108:111], a[172:175], v[132:135], v[108:111]
    buffer_load_dwordx4 v[116:119], v240, s[16:19], s74 offen sc1
    v_mfma_f32_16x16x32_bf16 v[96:99], a[160:163], v[132:135], v[96:99]
    v_mfma_f32_16x16x32_bf16 v[100:103], a[164:167], v[132:135], v[100:103]
    s_waitcnt vmcnt(17)
    v_mfma_f32_16x16x32_bf16 v[72:75], a[184:187], v[136:139], v[72:75]
    buffer_load_dwordx4 v[120:123], v241, s[16:19], s74 offen sc1
    s_add_u32 s74, s74, 1024
    v_mfma_f32_16x16x32_bf16 v[76:79], a[188:191], v[136:139], v[76:79]
    v_mfma_f32_16x16x32_bf16 v[64:67], a[176:179], v[136:139], v[64:67]
    v_mfma_f32_16x16x32_bf16 v[68:71], a[180:183], v[136:139], v[68:71]
    buffer_load_dwordx4 v[124:127], v239, s[16:19], s74 offen sc1
    v_mfma_f32_16x16x32_bf16 v[88:91], a[184:187], v[140:143], v[88:91]
    v_mfma_f32_16x16x32_bf16 v[92:95], a[188:191], v[140:143], v[92:95]
    v_mfma_f32_16x16x32_bf16 v[80:83], a[176:179], v[140:143], v[80:83]
    buffer_load_dwordx4 v[128:131], v240, s[16:19], s74 offen sc1
    v_mfma_f32_16x16x32_bf16 v[84:87], a[180:183], v[140:143], v[84:87]
    v_mfma_f32_16x16x32_bf16 v[104:107], a[184:187], v[144:147], v[104:107]
    v_mfma_f32_16x16x32_bf16 v[108:111], a[188:191], v[144:147], v[108:111]
    buffer_load_dwordx4 v[132:135], v241, s[16:19], s74 offen sc1
    s_add_u32 s74, s74, 1024
    v_mfma_f32_16x16x32_bf16 v[96:99], a[176:179], v[144:147], v[96:99]
    v_mfma_f32_16x16x32_bf16 v[100:103], a[180:183], v[144:147], v[100:103]
    s_waitcnt vmcnt(18)
    v_mfma_f32_16x16x32_bf16 v[72:75], a[200:203], v[148:151], v[72:75]
    buffer_load_dwordx4 v[136:139], v239, s[16:19], s74 offen sc1
    v_mfma_f32_16x16x32_bf16 v[76:79], a[204:207], v[148:151], v[76:79]
    v_mfma_f32_16x16x32_bf16 v[64:67], a[192:195], v[148:151], v[64:67]
    v_mfma_f32_16x16x32_bf16 v[68:71], a[196:199], v[148:151], v[68:71]
    buffer_load_dwordx4 v[140:143], v240, s[16:19], s74 offen sc1
    v_mfma_f32_16x16x32_bf16 v[88:91], a[200:203], v[152:155], v[88:91]
    v_mfma_f32_16x16x32_bf16 v[92:95], a[204:207], v[152:155], v[92:95]
    v_mfma_f32_16x16x32_bf16 v[80:83], a[192:195], v[152:155], v[80:83]
    buffer_load_dwordx4 v[144:147], v241, s[16:19], s74 offen sc1
    s_add_u32 s74, s74, 1024
    v_mfma_f32_16x16x32_bf16 v[84:87], a[196:199], v[152:155], v[84:87]
    v_mfma_f32_16x16x32_bf16 v[104:107], a[200:203], v[156:159], v[104:107]
    v_mfma_f32_16x16x32_bf16 v[108:111], a[204:207], v[156:159], v[108:111]
    v_mfma_f32_16x16x32_bf16 v[96:99], a[192:195], v[156:159], v[96:99]
    v_mfma_f32_16x16x32_bf16 v[100:103], a[196:199], v[156:159], v[100:103]
    s_waitcnt vmcnt(18)
    v_mfma_f32_16x16x32_bf16 v[72:75], a[216:219], v[160:163], v[72:75]
    buffer_load_dwordx4 v[148:151], v239, s[16:19], s74 offen sc1
    v_mfma_f32_16x16x32_bf16 v[76:79], a[220:223], v[160:163], v[76:79]
    v_mfma_f32_16x16x32_bf16 v[64:67], a[208:211], v[160:163], v[64:67]
    v_mfma_f32_16x16x32_bf16 v[68:71], a[212:215], v[160:163], v[68:71]
    buffer_load_dwordx4 v[152:155], v240, s[16:19], s74 offen sc1
    v_mfma_f32_16x16x32_bf16 v[88:91], a[216:219], v[164:167], v[88:91]
    v_mfma_f32_16x16x32_bf16 v[92:95], a[220:223], v[164:167], v[92:95]
    v_mfma_f32_16x16x32_bf16 v[80:83], a[208:211], v[164:167], v[80:83]
    buffer_load_dwordx4 v[156:159], v241, s[16:19], s74 offen sc1
    s_add_u32 s74, s74, 1024
    v_mfma_f32_16x16x32_bf16 v[84:87], a[212:215], v[164:167], v[84:87]
    v_mfma_f32_16x16x32_bf16 v[104:107], a[216:219], v[168:171], v[104:107]
    v_mfma_f32_16x16x32_bf16 v[108:111], a[220:223], v[168:171], v[108:111]
    v_mfma_f32_16x16x32_bf16 v[96:99], a[208:211], v[168:171], v[96:99]
    v_mfma_f32_16x16x32_bf16 v[100:103], a[212:215], v[168:171], v[100:103]
    s_waitcnt vmcnt(18)
    v_mfma_f32_16x16x32_bf16 v[72:75], a[8:11], v[172:175], v[72:75]
    s_add_u32 s46, s73, 12
    s_cmp_lt_u32 s46, 54
    s_cselect_b32 s46, s74, 2146435072
    buffer_load_dwordx4 v[160:163], v239, s[16:19], s46 offen sc1
    v_mfma_f32_16x16x32_bf16 v[76:79], a[12:15], v[172:175], v[76:79]
    v_mfma_f32_16x16x32_bf16 v[64:67], a[0:3], v[172:175], v[64:67]
    v_mfma_f32_16x16x32_bf16 v[68:71], a[4:7], v[172:175], v[68:71]
    v_mfma_f32_16x16x32_bf16 v[88:91], a[8:11], v[176:179], v[88:91]
    buffer_load_dwordx4 v[164:167], v240, s[16:19], s46 offen sc1
    v_mfma_f32_16x16x32_bf16 v[92:95], a[12:15], v[176:179], v[92:95]
    v_mfma_f32_16x16x32_bf16 v[80:83], a[0:3], v[176:179], v[80:83]
    v_mfma_f32_16x16x32_bf16 v[84:87], a[4:7], v[176:179], v[84:87]
    buffer_load_dwordx4 v[168:171], v241, s[16:19], s46 offen sc1
    s_add_u32 s74, s74, 1024
    v_mfma_f32_16x16x32_bf16 v[104:107], a[8:11], v[180:183], v[104:107]
    v_mfma_f32_16x16x32_bf16 v[108:111], a[12:15], v[180:183], v[108:111]
    v_mfma_f32_16x16x32_bf16 v[96:99], a[0:3], v[180:183], v[96:99]
    v_mfma_f32_16x16x32_bf16 v[100:103], a[4:7], v[180:183], v[100:103]
    s_waitcnt vmcnt(18)
    v_mfma_f32_16x16x32_bf16 v[72:75], a[24:27], v[184:187], v[72:75]
    s_add_u32 s46, s73, 13
    s_cmp_lt_u32 s46, 54
    s_cselect_b32 s46, s74, 2146435072
    buffer_load_dwordx4 v[172:175], v239, s[16:19], s46 offen sc1
    v_mfma_f32_16x16x32_bf16 v[76:79], a[28:31], v[184:187], v[76:79]
    v_mfma_f32_16x16x32_bf16 v[64:67], a[16:19], v[184:187], v[64:67]
    v_mfma_f32_16x16x32_bf16 v[68:71], a[20:23], v[184:187], v[68:71]
    v_mfma_f32_16x16x32_bf16 v[88:91], a[24:27], v[188:191], v[88:91]
    buffer_load_dwordx4 v[176:179], v240, s[16:19], s46 offen sc1
    v_mfma_f32_16x16x32_bf16 v[92:95], a[28:31], v[188:191], v[92:95]
    v_mfma_f32_16x16x32_bf16 v[80:83], a[16:19], v[188:191], v[80:83]
    v_mfma_f32_16x16x32_bf16 v[84:87], a[20:23], v[188:191], v[84:87]
    buffer_load_dwordx4 v[180:183], v241, s[16:19], s46 offen sc1
    s_add_u32 s74, s74, 1024
    v_mfma_f32_16x16x32_bf16 v[104:107], a[24:27], v[192:195], v[104:107]
    v_mfma_f32_16x16x32_bf16 v[108:111], a[28:31], v[192:195], v[108:111]
    v_mfma_f32_16x16x32_bf16 v[96:99], a[16:19], v[192:195], v[96:99]
    v_mfma_f32_16x16x32_bf16 v[100:103], a[20:23], v[192:195], v[100:103]
    s_waitcnt vmcnt(18)
    v_mfma_f32_16x16x32_bf16 v[72:75], a[40:43], v[196:199], v[72:75]
    s_mov_b32 s74, s72
    buffer_load_dwordx4 v[184:187], v236, s[16:19], s74 offen sc1
    v_mfma_f32_16x16x32_bf16 v[76:79], a[44:47], v[196:199], v[76:79]
    v_mfma_f32_16x16x32_bf16 v[64:67], a[32:35], v[196:199], v[64:67]
    v_mfma_f32_16x16x32_bf16 v[68:71], a[36:39], v[196:199], v[68:71]
    buffer_load_dwordx4 v[188:191], v237, s[16:19], s74 offen sc1
    v_mfma_f32_16x16x32_bf16 v[88:91], a[40:43], v[200:203], v[88:91]
    v_mfma_f32_16x16x32_bf16 v[92:95], a[44:47], v[200:203], v[92:95]
    v_mfma_f32_16x16x32_bf16 v[80:83], a[32:35], v[200:203], v[80:83]
    buffer_load_dwordx4 v[192:195], v238, s[16:19], s74 offen sc1
    s_add_u32 s74, s74, 1024
    v_mfma_f32_16x16x32_bf16 v[84:87], a[36:39], v[200:203], v[84:87]
    v_mfma_f32_16x16x32_bf16 v[104:107], a[40:43], v[204:207], v[104:107]
    v_mfma_f32_16x16x32_bf16 v[108:111], a[44:47], v[204:207], v[108:111]
    v_mfma_f32_16x16x32_bf16 v[96:99], a[32:35], v[204:207], v[96:99]
    v_mfma_f32_16x16x32_bf16 v[100:103], a[36:39], v[204:207], v[100:103]
    s_waitcnt vmcnt(18)
    v_mfma_f32_16x16x32_bf16 v[72:75], a[56:59], v[112:115], v[72:75]
    buffer_load_dwordx4 v[196:199], v236, s[16:19], s74 offen sc1
    v_mfma_f32_16x16x32_bf16 v[76:79], a[60:63], v[112:115], v[76:79]
    v_mfma_f32_16x16x32_bf16 v[64:67], a[48:51], v[112:115], v[64:67]
    v_mfma_f32_16x16x32_bf16 v[68:71], a[52:55], v[112:115], v[68:71]
    buffer_load_dwordx4 v[200:203], v237, s[16:19], s74 offen sc1
    v_mfma_f32_16x16x32_bf16 v[88:91], a[56:59], v[116:119], v[88:91]
    v_mfma_f32_16x16x32_bf16 v[92:95], a[60:63], v[116:119], v[92:95]
    v_mfma_f32_16x16x32_bf16 v[80:83], a[48:51], v[116:119], v[80:83]
    buffer_load_dwordx4 v[204:207], v238, s[16:19], s74 offen sc1
    s_add_u32 s74, s74, 1024
    v_mfma_f32_16x16x32_bf16 v[84:87], a[52:55], v[116:119], v[84:87]
    v_mfma_f32_16x16x32_bf16 v[104:107], a[56:59], v[120:123], v[104:107]
    v_mfma_f32_16x16x32_bf16 v[108:111], a[60:63], v[120:123], v[108:111]
    v_mfma_f32_16x16x32_bf16 v[96:99], a[48:51], v[120:123], v[96:99]
    v_mfma_f32_16x16x32_bf16 v[100:103], a[52:55], v[120:123], v[100:103]
    s_waitcnt vmcnt(18)
    v_mfma_f32_16x16x32_bf16 v[72:75], a[72:75], v[124:127], v[72:75]
    buffer_load_dwordx4 v[112:115], v236, s[16:19], s74 offen sc1
    v_mfma_f32_16x16x32_bf16 v[76:79], a[76:79], v[124:127], v[76:79]
    v_mfma_f32_16x16x32_bf16 v[64:67], a[64:67], v[124:127], v[64:67]
    v_mfma_f32_16x16x32_bf16 v[68:71], a[68:71], v[124:127], v[68:71]
    buffer_load_dwordx4 v[116:119], v237, s[16:19], s74 offen sc1
    v_mfma_f32_16x16x32_bf16 v[88:91], a[72:75], v[128:131], v[88:91]
    v_mfma_f32_16x16x32_bf16 v[92:95], a[76:79], v[128:131], v[92:95]
    v_mfma_f32_16x16x32_bf16 v[80:83], a[64:67], v[128:131], v[80:83]
    buffer_load_dwordx4 v[120:123], v238, s[16:19], s74 offen sc1
    s_add_u32 s74, s74, 1024
    v_mfma_f32_16x16x32_bf16 v[84:87], a[68:71], v[128:131], v[84:87]
    v_mfma_f32_16x16x32_bf16 v[104:107], a[72:75], v[132:135], v[104:107]
    v_mfma_f32_16x16x32_bf16 v[108:111], a[76:79], v[132:135], v[108:111]
    v_mfma_f32_16x16x32_bf16 v[96:99], a[64:67], v[132:135], v[96:99]
    v_mfma_f32_16x16x32_bf16 v[100:103], a[68:71], v[132:135], v[100:103]
    s_waitcnt vmcnt(18)
    v_mfma_f32_16x16x32_bf16 v[72:75], a[88:91], v[136:139], v[72:75]
    buffer_load_dwordx4 v[124:127], v236, s[16:19], s74 offen sc1
    v_mfma_f32_16x16x32_bf16 v[76:79], a[92:95], v[136:139], v[76:79]
    v_mfma_f32_16x16x32_bf16 v[64:67], a[80:83], v[136:139], v[64:67]
    v_mfma_f32_16x16x32_bf16 v[68:71], a[84:87], v[136:139], v[68:71]
    buffer_load_dwordx4 v[128:131], v237, s[16:19], s74 offen sc1
    v_mfma_f32_16x16x32_bf16 v[88:91], a[88:91], v[140:143], v[88:91]
    v_mfma_f32_16x16x32_bf16 v[92:95], a[92:95], v[140:143], v[92:95]
    v_mfma_f32_16x16x32_bf16 v[80:83], a[80:83], v[140:143], v[80:83]
    buffer_load_dwordx4 v[132:135], v238, s[16:19], s74 offen sc1
    s_add_u32 s74, s74, 1024
    v_mfma_f32_16x16x32_bf16 v[84:87], a[84:87], v[140:143], v[84:87]
    v_mfma_f32_16x16x32_bf16 v[104:107], a[88:91], v[144:147], v[104:107]
    v_mfma_f32_16x16x32_bf16 v[108:111], a[92:95], v[144:147], v[108:111]
    v_mfma_f32_16x16x32_bf16 v[96:99], a[80:83], v[144:147], v[96:99]
    v_mfma_f32_16x16x32_bf16 v[100:103], a[84:87], v[144:147], v[100:103]
    s_waitcnt vmcnt(18)
    v_mfma_f32_16x16x32_bf16 v[72:75], a[104:107], v[148:151], v[72:75]
    buffer_load_dwordx4 v[136:139], v236, s[16:19], s74 offen sc1
    v_mfma_f32_16x16x32_bf16 v[76:79], a[108:111], v[148:151], v[76:79]
    v_mfma_f32_16x16x32_bf16 v[64:67], a[96:99], v[148:151], v[64:67]
    v_mfma_f32_16x16x32_bf16 v[68:71], a[100:103], v[148:151], v[68:71]
    buffer_load_dwordx4 v[140:143], v237, s[16:19], s74 offen sc1
    v_mfma_f32_16x16x32_bf16 v[88:91], a[104:107], v[152:155], v[88:91]
    v_mfma_f32_16x16x32_bf16 v[92:95], a[108:111], v[152:155], v[92:95]
    v_mfma_f32_16x16x32_bf16 v[80:83], a[96:99], v[152:155], v[80:83]
    buffer_load_dwordx4 v[144:147], v238, s[16:19], s74 offen sc1
    s_add_u32 s74, s74, 1024
    v_mfma_f32_16x16x32_bf16 v[84:87], a[100:103], v[152:155], v[84:87]
    v_mfma_f32_16x16x32_bf16 v[104:107], a[104:107], v[156:159], v[104:107]
    v_mfma_f32_16x16x32_bf16 v[108:111], a[108:111], v[156:159], v[108:111]
    v_mfma_f32_16x16x32_bf16 v[96:99], a[96:99], v[156:159], v[96:99]
    v_mfma_f32_16x16x32_bf16 v[100:103], a[100:103], v[156:159], v[100:103]
    s_waitcnt vmcnt(18)
    v_mfma_f32_16x16x32_bf16 v[72:75], a[120:123], v[160:163], v[72:75]
    buffer_load_dwordx4 v[148:151], v236, s[16:19], s74 offen sc1
    v_mfma_f32_16x16x32_bf16 v[76:79], a[124:127], v[160:163], v[76:79]
    v_mfma_f32_16x16x32_bf16 v[64:67], a[112:115], v[160:163], v[64:67]
    v_mfma_f32_16x16x32_bf16 v[68:71], a[116:119], v[160:163], v[68:71]
    buffer_load_dwordx4 v[152:155], v237, s[16:19], s74 offen sc1
    v_mfma_f32_16x16x32_bf16 v[88:91], a[120:123], v[164:167], v[88:91]
    v_mfma_f32_16x16x32_bf16 v[92:95], a[124:127], v[164:167], v[92:95]
    v_mfma_f32_16x16x32_bf16 v[80:83], a[112:115], v[164:167], v[80:83]
    buffer_load_dwordx4 v[156:159], v238, s[16:19], s74 offen sc1
    s_add_u32 s74, s74, 1024
    v_mfma_f32_16x16x32_bf16 v[84:87], a[116:119], v[164:167], v[84:87]
    v_mfma_f32_16x16x32_bf16 v[104:107], a[120:123], v[168:171], v[104:107]
    v_mfma_f32_16x16x32_bf16 v[108:111], a[124:127], v[168:171], v[108:111]
    v_mfma_f32_16x16x32_bf16 v[96:99], a[112:115], v[168:171], v[96:99]
    v_mfma_f32_16x16x32_bf16 v[100:103], a[116:119], v[168:171], v[100:103]
    s_waitcnt vmcnt(18)
    v_mfma_f32_16x16x32_bf16 v[72:75], a[136:139], v[172:175], v[72:75]
    buffer_load_dwordx4 v[160:163], v236, s[16:19], s74 offen sc1
    v_mfma_f32_16x16x32_bf16 v[76:79], a[140:143], v[172:175], v[76:79]
    v_mfma_f32_16x16x32_bf16 v[64:67], a[128:131], v[172:175], v[64:67]
    v_mfma_f32_16x16x32_bf16 v[68:71], a[132:135], v[172:175], v[68:71]
    buffer_load_dwordx4 v[164:167], v237, s[16:19], s74 offen sc1
    v_mfma_f32_16x16x32_bf16 v[88:91], a[136:139], v[176:179], v[88:91]
    v_mfma_f32_16x16x32_bf16 v[92:95], a[140:143], v[176:179], v[92:95]
    v_mfma_f32_16x16x32_bf16 v[80:83], a[128:131], v[176:179], v[80:83]
    buffer_load_dwordx4 v[168:171], v238, s[16:19], s74 offen sc1
    s_add_u32 s74, s74, 1024
    v_mfma_f32_16x16x32_bf16 v[84:87], a[132:135], v[176:179], v[84:87]
    v_mfma_f32_16x16x32_bf16 v[104:107], a[136:139], v[180:183], v[104:107]
    v_mfma_f32_16x16x32_bf16 v[108:111], a[140:143], v[180:183], v[108:111]
    v_mfma_f32_16x16x32_bf16 v[96:99], a[128:131], v[180:183], v[96:99]
    v_mfma_f32_16x16x32_bf16 v[100:103], a[132:135], v[180:183], v[100:103]
    s_waitcnt vmcnt(18)
    v_mfma_f32_16x16x32_bf16 v[24:27], a[152:155], v[184:187], 0
    buffer_load_dwordx4 v[172:175], v236, s[16:19], s74 offen sc1
    v_mfma_f32_16x16x32_bf16 v[28:31], a[156:159], v[184:187], 0
    v_mfma_f32_16x16x32_bf16 v[16:19], a[144:147], v[184:187], 0
    v_mfma_f32_16x16x32_bf16 v[20:23], a[148:151], v[184:187], 0
    buffer_load_dwordx4 v[176:179], v237, s[16:19], s74 offen sc1
    v_mfma_f32_16x16x32_bf16 v[40:43], a[152:155], v[188:191], 0
    v_mfma_f32_16x16x32_bf16 v[44:47], a[156:159], v[188:191], 0
    v_mfma_f32_16x16x32_bf16 v[32:35], a[144:147], v[188:191], 0
    buffer_load_dwordx4 v[180:183], v238, s[16:19], s74 offen sc1
    s_add_u32 s74, s74, 1024
    v_mfma_f32_16x16x32_bf16 v[36:39], a[148:151], v[188:191], 0
    v_mfma_f32_16x16x32_bf16 v[56:59], a[152:155], v[192:195], 0
    v_mfma_f32_16x16x32_bf16 v[60:63], a[156:159], v[192:195], 0
    v_mfma_f32_16x16x32_bf16 v[48:51], a[144:147], v[192:195], 0
    v_mfma_f32_16x16x32_bf16 v[52:55], a[148:151], v[192:195], 0
    s_waitcnt vmcnt(18)
    v_mfma_f32_16x16x32_bf16 v[24:27], a[168:171], v[196:199], v[24:27]
    buffer_load_dwordx4 v[184:187], v236, s[16:19], s74 offen sc1
    v_mfma_f32_16x16x32_bf16 v[28:31], a[172:175], v[196:199], v[28:31]
    v_mfma_f32_16x16x32_bf16 v[16:19], a[160:163], v[196:199], v[16:19]
    v_mfma_f32_16x16x32_bf16 v[20:23], a[164:167], v[196:199], v[20:23]
    buffer_load_dwordx4 v[188:191], v237, s[16:19], s74 offen sc1
    v_mfma_f32_16x16x32_bf16 v[40:43], a[168:171], v[200:203], v[40:43]
    v_mfma_f32_16x16x32_bf16 v[44:47], a[172:175], v[200:203], v[44:47]
    ds_write_b128 v233, v[64:67] offset:0
    v_mfma_f32_16x16x32_bf16 v[32:35], a[160:163], v[200:203], v[32:35]
    buffer_load_dwordx4 v[192:195], v238, s[16:19], s74 offen sc1
    s_add_u32 s74, s74, 1024
    v_mfma_f32_16x16x32_bf16 v[36:39], a[164:167], v[200:203], v[36:39]
    v_mfma_f32_16x16x32_bf16 v[56:59], a[168:171], v[204:207], v[56:59]
    v_mfma_f32_16x16x32_bf16 v[60:63], a[172:175], v[204:207], v[60:63]
    v_mfma_f32_16x16x32_bf16 v[48:51], a[160:163], v[204:207], v[48:51]
    v_mfma_f32_16x16x32_bf16 v[52:55], a[164:167], v[204:207], v[52:55]
    s_waitcnt vmcnt(18)
    v_mfma_f32_16x16x32_bf16 v[24:27], a[184:187], v[112:115], v[24:27]
    buffer_load_dwordx4 v[196:199], v236, s[16:19], s74 offen sc1
    v_mfma_f32_16x16x32_bf16 v[28:31], a[188:191], v[112:115], v[28:31]
    v_mfma_f32_16x16x32_bf16 v[16:19], a[176:179], v[112:115], v[16:19]
    v_mfma_f32_16x16x32_bf16 v[20:23], a[180:183], v[112:115], v[20:23]
    buffer_load_dwordx4 v[200:203], v237, s[16:19], s74 offen sc1
    v_mfma_f32_16x16x32_bf16 v[40:43], a[184:187], v[116:119], v[40:43]
    v_mfma_f32_16x16x32_bf16 v[44:47], a[188:191], v[116:119], v[44:47]
    ds_write_b128 v233, v[68:71] offset:1024
    v_mfma_f32_16x16x32_bf16 v[32:35], a[176:179], v[116:119], v[32:35]
    buffer_load_dwordx4 v[204:207], v238, s[16:19], s74 offen sc1
    s_add_u32 s74, s74, 1024
    v_mfma_f32_16x16x32_bf16 v[36:39], a[180:183], v[116:119], v[36:39]
    v_mfma_f32_16x16x32_bf16 v[56:59], a[184:187], v[120:123], v[56:59]
    v_mfma_f32_16x16x32_bf16 v[60:63], a[188:191], v[120:123], v[60:63]
    v_mfma_f32_16x16x32_bf16 v[48:51], a[176:179], v[120:123], v[48:51]
    v_mfma_f32_16x16x32_bf16 v[52:55], a[180:183], v[120:123], v[52:55]
    s_waitcnt vmcnt(18)
    v_mfma_f32_16x16x32_bf16 v[24:27], a[200:203], v[124:127], v[24:27]
    buffer_load_dwordx4 v[112:115], v236, s[16:19], s74 offen sc1
    v_mfma_f32_16x16x32_bf16 v[28:31], a[204:207], v[124:127], v[28:31]
    v_mfma_f32_16x16x32_bf16 v[16:19], a[192:195], v[124:127], v[16:19]
    v_mfma_f32_16x16x32_bf16 v[20:23], a[196:199], v[124:127], v[20:23]
    buffer_load_dwordx4 v[116:119], v237, s[16:19], s74 offen sc1
    v_mfma_f32_16x16x32_bf16 v[40:43], a[200:203], v[128:131], v[40:43]
    v_mfma_f32_16x16x32_bf16 v[44:47], a[204:207], v[128:131], v[44:47]
    ds_write_b128 v234, v[72:75] offset:0
    v_mfma_f32_16x16x32_bf16 v[32:35], a[192:195], v[128:131], v[32:35]
    buffer_load_dwordx4 v[120:123], v238, s[16:19], s74 offen sc1
    s_add_u32 s74, s74, 1024
    v_mfma_f32_16x16x32_bf16 v[36:39], a[196:199], v[128:131], v[36:39]
    v_mfma_f32_16x16x32_bf16 v[56:59], a[200:203], v[132:135], v[56:59]
    v_mfma_f32_16x16x32_bf16 v[60:63], a[204:207], v[132:135], v[60:63]
    v_mfma_f32_16x16x32_bf16 v[48:51], a[192:195], v[132:135], v[48:51]
    v_mfma_f32_16x16x32_bf16 v[52:55], a[196:199], v[132:135], v[52:55]
    s_waitcnt vmcnt(18)
    v_mfma_f32_16x16x32_bf16 v[24:27], a[216:219], v[136:139], v[24:27]
    buffer_load_dwordx4 v[124:127], v236, s[16:19], s74 offen sc1
    v_mfma_f32_16x16x32_bf16 v[28:31], a[220:223], v[136:139], v[28:31]
    v_mfma_f32_16x16x32_bf16 v[16:19], a[208:211], v[136:139], v[16:19]
    v_mfma_f32_16x16x32_bf16 v[20:23], a[212:215], v[136:139], v[20:23]
    buffer_load_dwordx4 v[128:131], v237, s[16:19], s74 offen sc1
    v_mfma_f32_16x16x32_bf16 v[40:43], a[216:219], v[140:143], v[40:43]
    v_mfma_f32_16x16x32_bf16 v[44:47], a[220:223], v[140:143], v[44:47]
    ds_write_b128 v234, v[76:79] offset:1024
    v_mfma_f32_16x16x32_bf16 v[32:35], a[208:211], v[140:143], v[32:35]
    buffer_load_dwordx4 v[132:135], v238, s[16:19], s74 offen sc1
    s_add_u32 s74, s74, 1024
    v_mfma_f32_16x16x32_bf16 v[36:39], a[212:215], v[140:143], v[36:39]
    v_mfma_f32_16x16x32_bf16 v[56:59], a[216:219], v[144:147], v[56:59]
    v_mfma_f32_16x16x32_bf16 v[60:63], a[220:223], v[144:147], v[60:63]
    v_mfma_f32_16x16x32_bf16 v[48:51], a[208:211], v[144:147], v[48:51]
    v_mfma_f32_16x16x32_bf16 v[52:55], a[212:215], v[144:147], v[52:55]
    s_waitcnt vmcnt(18)
    v_mfma_f32_16x16x32_bf16 v[24:27], a[8:11], v[148:151], v[24:27]
    s_add_u32 s46, s73, 12
    s_cmp_lt_u32 s46, 54
    s_cselect_b32 s46, s74, 2146435072
    buffer_load_dwordx4 v[136:139], v236, s[16:19], s46 offen sc1
    v_mfma_f32_16x16x32_bf16 v[28:31], a[12:15], v[148:151], v[28:31]
    v_mfma_f32_16x16x32_bf16 v[16:19], a[0:3], v[148:151], v[16:19]
    v_mfma_f32_16x16x32_bf16 v[20:23], a[4:7], v[148:151], v[20:23]
    v_mfma_f32_16x16x32_bf16 v[40:43], a[8:11], v[152:155], v[40:43]
    buffer_load_dwordx4 v[140:143], v237, s[16:19], s46 offen sc1
    v_mfma_f32_16x16x32_bf16 v[44:47], a[12:15], v[152:155], v[44:47]
    ds_write_b128 v233, v[80:83] offset:2048
    v_mfma_f32_16x16x32_bf16 v[32:35], a[0:3], v[152:155], v[32:35]
    v_mfma_f32_16x16x32_bf16 v[36:39], a[4:7], v[152:155], v[36:39]
    buffer_load_dwordx4 v[144:147], v238, s[16:19], s46 offen sc1
    s_add_u32 s74, s74, 1024
    v_mfma_f32_16x16x32_bf16 v[56:59], a[8:11], v[156:159], v[56:59]
    v_mfma_f32_16x16x32_bf16 v[60:63], a[12:15], v[156:159], v[60:63]
    v_mfma_f32_16x16x32_bf16 v[48:51], a[0:3], v[156:159], v[48:51]
    v_mfma_f32_16x16x32_bf16 v[52:55], a[4:7], v[156:159], v[52:55]
    s_waitcnt vmcnt(18)
    v_mfma_f32_16x16x32_bf16 v[24:27], a[24:27], v[160:163], v[24:27]
    s_add_u32 s46, s73, 13
    s_cmp_lt_u32 s46, 54
    s_cselect_b32 s46, s74, 2146435072
    buffer_load_dwordx4 v[148:151], v236, s[16:19], s46 offen sc1
    v_mfma_f32_16x16x32_bf16 v[28:31], a[28:31], v[160:163], v[28:31]
    v_mfma_f32_16x16x32_bf16 v[16:19], a[16:19], v[160:163], v[16:19]
    v_mfma_f32_16x16x32_bf16 v[20:23], a[20:23], v[160:163], v[20:23]
    v_mfma_f32_16x16x32_bf16 v[40:43], a[24:27], v[164:167], v[40:43]
    buffer_load_dwordx4 v[152:155], v237, s[16:19], s46 offen sc1
    v_mfma_f32_16x16x32_bf16 v[44:47], a[28:31], v[164:167], v[44:47]
    ds_write_b128 v233, v[84:87] offset:3072
    v_mfma_f32_16x16x32_bf16 v[32:35], a[16:19], v[164:167], v[32:35]
    v_mfma_f32_16x16x32_bf16 v[36:39], a[20:23], v[164:167], v[36:39]
    buffer_load_dwordx4 v[156:159], v238, s[16:19], s46 offen sc1
    s_add_u32 s74, s74, 1024
    v_mfma_f32_16x16x32_bf16 v[56:59], a[24:27], v[168:171], v[56:59]
    v_mfma_f32_16x16x32_bf16 v[60:63], a[28:31], v[168:171], v[60:63]
    v_mfma_f32_16x16x32_bf16 v[48:51], a[16:19], v[168:171], v[48:51]
    v_mfma_f32_16x16x32_bf16 v[52:55], a[20:23], v[168:171], v[52:55]
    s_waitcnt vmcnt(18)
    v_mfma_f32_16x16x32_bf16 v[24:27], a[40:43], v[172:175], v[24:27]
    v_mfma_f32_16x16x32_bf16 v[28:31], a[44:47], v[172:175], v[28:31]
    v_mfma_f32_16x16x32_bf16 v[16:19], a[32:35], v[172:175], v[16:19]
    v_mfma_f32_16x16x32_bf16 v[20:23], a[36:39], v[172:175], v[20:23]
    v_mfma_f32_16x16x32_bf16 v[40:43], a[40:43], v[176:179], v[40:43]
    v_mfma_f32_16x16x32_bf16 v[44:47], a[44:47], v[176:179], v[44:47]
    ds_write_b128 v234, v[88:91] offset:2048
    v_mfma_f32_16x16x32_bf16 v[32:35], a[32:35], v[176:179], v[32:35]
    v_mfma_f32_16x16x32_bf16 v[36:39], a[36:39], v[176:179], v[36:39]
    v_mfma_f32_16x16x32_bf16 v[56:59], a[40:43], v[180:183], v[56:59]
    v_mfma_f32_16x16x32_bf16 v[60:63], a[44:47], v[180:183], v[60:63]
    v_mfma_f32_16x16x32_bf16 v[48:51], a[32:35], v[180:183], v[48:51]
    v_mfma_f32_16x16x32_bf16 v[52:55], a[36:39], v[180:183], v[52:55]
    s_waitcnt vmcnt(15)
    v_mfma_f32_16x16x32_bf16 v[24:27], a[56:59], v[184:187], v[24:27]
    v_mfma_f32_16x16x32_bf16 v[28:31], a[60:63], v[184:187], v[28:31]
    v_mfma_f32_16x16x32_bf16 v[16:19], a[48:51], v[184:187], v[16:19]
    v_mfma_f32_16x16x32_bf16 v[20:23], a[52:55], v[184:187], v[20:23]
    v_mfma_f32_16x16x32_bf16 v[40:43], a[56:59], v[188:191], v[40:43]
    v_mfma_f32_16x16x32_bf16 v[44:47], a[60:63], v[188:191], v[44:47]
    ds_write_b128 v234, v[92:95] offset:3072
    v_mfma_f32_16x16x32_bf16 v[32:35], a[48:51], v[188:191], v[32:35]
    v_mfma_f32_16x16x32_bf16 v[36:39], a[52:55], v[188:191], v[36:39]
    v_mfma_f32_16x16x32_bf16 v[56:59], a[56:59], v[192:195], v[56:59]
    v_mfma_f32_16x16x32_bf16 v[60:63], a[60:63], v[192:195], v[60:63]
    v_mfma_f32_16x16x32_bf16 v[48:51], a[48:51], v[192:195], v[48:51]
    v_mfma_f32_16x16x32_bf16 v[52:55], a[52:55], v[192:195], v[52:55]
    s_waitcnt vmcnt(12)
    v_mfma_f32_16x16x32_bf16 v[24:27], a[72:75], v[196:199], v[24:27]
    v_mfma_f32_16x16x32_bf16 v[28:31], a[76:79], v[196:199], v[28:31]
    v_mfma_f32_16x16x32_bf16 v[16:19], a[64:67], v[196:199], v[16:19]
    v_mfma_f32_16x16x32_bf16 v[20:23], a[68:71], v[196:199], v[20:23]
    v_mfma_f32_16x16x32_bf16 v[40:43], a[72:75], v[200:203], v[40:43]
    v_mfma_f32_16x16x32_bf16 v[44:47], a[76:79], v[200:203], v[44:47]
    ds_write_b128 v233, v[96:99] offset:4096
    v_mfma_f32_16x16x32_bf16 v[32:35], a[64:67], v[200:203], v[32:35]
    v_mfma_f32_16x16x32_bf16 v[36:39], a[68:71], v[200:203], v[36:39]
    v_mfma_f32_16x16x32_bf16 v[56:59], a[72:75], v[204:207], v[56:59]
    v_mfma_f32_16x16x32_bf16 v[60:63], a[76:79], v[204:207], v[60:63]
    v_mfma_f32_16x16x32_bf16 v[48:51], a[64:67], v[204:207], v[48:51]
    v_mfma_f32_16x16x32_bf16 v[52:55], a[68:71], v[204:207], v[52:55]
    s_waitcnt vmcnt(9)
    v_mfma_f32_16x16x32_bf16 v[24:27], a[88:91], v[112:115], v[24:27]
    v_mfma_f32_16x16x32_bf16 v[28:31], a[92:95], v[112:115], v[28:31]
    v_mfma_f32_16x16x32_bf16 v[16:19], a[80:83], v[112:115], v[16:19]
    v_mfma_f32_16x16x32_bf16 v[20:23], a[84:87], v[112:115], v[20:23]
    v_mfma_f32_16x16x32_bf16 v[40:43], a[88:91], v[116:119], v[40:43]
    v_mfma_f32_16x16x32_bf16 v[44:47], a[92:95], v[116:119], v[44:47]
    ds_write_b128 v233, v[100:103] offset:5120
    v_mfma_f32_16x16x32_bf16 v[32:35], a[80:83], v[116:119], v[32:35]
    v_mfma_f32_16x16x32_bf16 v[36:39], a[84:87], v[116:119], v[36:39]
    v_mfma_f32_16x16x32_bf16 v[56:59], a[88:91], v[120:123], v[56:59]
    v_mfma_f32_16x16x32_bf16 v[60:63], a[92:95], v[120:123], v[60:63]
    v_mfma_f32_16x16x32_bf16 v[48:51], a[80:83], v[120:123], v[48:51]
    v_mfma_f32_16x16x32_bf16 v[52:55], a[84:87], v[120:123], v[52:55]
    s_waitcnt vmcnt(6)
    v_mfma_f32_16x16x32_bf16 v[24:27], a[104:107], v[124:127], v[24:27]
    v_mfma_f32_16x16x32_bf16 v[28:31], a[108:111], v[124:127], v[28:31]
    v_mfma_f32_16x16x32_bf16 v[16:19], a[96:99], v[124:127], v[16:19]
    v_mfma_f32_16x16x32_bf16 v[20:23], a[100:103], v[124:127], v[20:23]
    v_mfma_f32_16x16x32_bf16 v[40:43], a[104:107], v[128:131], v[40:43]
    v_mfma_f32_16x16x32_bf16 v[44:47], a[108:111], v[128:131], v[44:47]
    ds_write_b128 v234, v[104:107] offset:4096
    v_mfma_f32_16x16x32_bf16 v[32:35], a[96:99], v[128:131], v[32:35]
    v_mfma_f32_16x16x32_bf16 v[36:39], a[100:103], v[128:131], v[36:39]
    v_mfma_f32_16x16x32_bf16 v[56:59], a[104:107], v[132:135], v[56:59]
    v_mfma_f32_16x16x32_bf16 v[60:63], a[108:111], v[132:135], v[60:63]
    v_mfma_f32_16x16x32_bf16 v[48:51], a[96:99], v[132:135], v[48:51]
    v_mfma_f32_16x16x32_bf16 v[52:55], a[100:103], v[132:135], v[52:55]
    s_waitcnt vmcnt(3)
    v_mfma_f32_16x16x32_bf16 v[24:27], a[120:123], v[136:139], v[24:27]
    v_mfma_f32_16x16x32_bf16 v[28:31], a[124:127], v[136:139], v[28:31]
    v_mfma_f32_16x16x32_bf16 v[16:19], a[112:115], v[136:139], v[16:19]
    v_mfma_f32_16x16x32_bf16 v[20:23], a[116:119], v[136:139], v[20:23]
    v_mfma_f32_16x16x32_bf16 v[40:43], a[120:123], v[140:143], v[40:43]
    v_mfma_f32_16x16x32_bf16 v[44:47], a[124:127], v[140:143], v[44:47]
    ds_write_b128 v234, v[108:111] offset:5120
    v_mfma_f32_16x16x32_bf16 v[32:35], a[112:115], v[140:143], v[32:35]
    v_mfma_f32_16x16x32_bf16 v[36:39], a[116:119], v[140:143], v[36:39]
    v_mfma_f32_16x16x32_bf16 v[56:59], a[120:123], v[144:147], v[56:59]
    v_mfma_f32_16x16x32_bf16 v[60:63], a[124:127], v[144:147], v[60:63]
    v_mfma_f32_16x16x32_bf16 v[48:51], a[112:115], v[144:147], v[48:51]
    v_mfma_f32_16x16x32_bf16 v[52:55], a[116:119], v[144:147], v[52:55]
    s_waitcnt vmcnt(0)
    v_mfma_f32_16x16x32_bf16 v[24:27], a[136:139], v[148:151], v[24:27]
    v_mfma_f32_16x16x32_bf16 v[28:31], a[140:143], v[148:151], v[28:31]
    v_mfma_f32_16x16x32_bf16 v[16:19], a[128:131], v[148:151], v[16:19]
    v_mfma_f32_16x16x32_bf16 v[20:23], a[132:135], v[148:151], v[20:23]
    v_mfma_f32_16x16x32_bf16 v[40:43], a[136:139], v[152:155], v[40:43]
    v_mfma_f32_16x16x32_bf16 v[44:47], a[140:143], v[152:155], v[44:47]
    v_mfma_f32_16x16x32_bf16 v[32:35], a[128:131], v[152:155], v[32:35]
    v_mfma_f32_16x16x32_bf16 v[36:39], a[132:135], v[152:155], v[36:39]
    v_mfma_f32_16x16x32_bf16 v[56:59], a[136:139], v[156:159], v[56:59]
    v_mfma_f32_16x16x32_bf16 v[60:63], a[140:143], v[156:159], v[60:63]
    v_mfma_f32_16x16x32_bf16 v[48:51], a[128:131], v[156:159], v[48:51]
    v_mfma_f32_16x16x32_bf16 v[52:55], a[132:135], v[156:159], v[52:55]
    ds_write_b128 v232, v[24:27] offset:0
    ds_write_b128 v232, v[28:31] offset:1024
    ds_write_b128 v232, v[40:43] offset:2048
    ds_write_b128 v232, v[44:47] offset:3072
    s_nop 0
    ds_write_b128 v232, v[56:59] offset:4096
    ds_write_b128 v232, v[60:63] offset:5120
    s_mov_b32 s20, s54
    s_mov_b32 s21, s55
    s_mov_b32 s22, 2621440
    s_mov_b32 s23, 0x20000
    s_waitcnt lgkmcnt(0)
    s_barrier
    ds_read_b128 v[112:115], v235 offset:0
    ds_read_b128 v[116:119], v235 offset:1024
    ds_read_b128 v[120:123], v235 offset:2048
    ds_read_b128 v[124:127], v235 offset:3072
    ds_read_b128 v[128:131], v235 offset:4096
    ds_read_b128 v[132:135], v235 offset:5120
    ds_read_b128 v[136:139], v235 offset:6144
    ds_read_b128 v[140:143], v235 offset:7168
    ds_read_b128 v[144:147], v235 offset:8192
    ds_read_b128 v[148:151], v235 offset:9216
    ds_read_b128 v[152:155], v235 offset:10240
    ds_read_b128 v[156:159], v235 offset:11264
    ds_read_b128 v[160:163], v235 offset:12288
    ds_read_b128 v[164:167], v235 offset:13312
    ds_read_b128 v[168:171], v235 offset:14336
    ds_read_b128 v[172:175], v235 offset:15360
    ds_read_b128 v[176:179], v235 offset:16384
    ds_read_b128 v[180:183], v235 offset:17408
    s_waitcnt lgkmcnt(12)
    v_pk_add_f32 v[16:17], v[16:17], v[112:113]
    v_pk_add_f32 v[18:19], v[18:19], v[114:115]
    v_pk_add_f32 v[20:21], v[20:21], v[116:117]
    v_pk_add_f32 v[22:23], v[22:23], v[118:119]
    v_pk_add_f32 v[32:33], v[32:33], v[120:121]
    v_pk_add_f32 v[34:35], v[34:35], v[122:123]
    v_pk_add_f32 v[36:37], v[36:37], v[124:125]
    v_pk_add_f32 v[38:39], v[38:39], v[126:127]
    v_pk_add_f32 v[48:49], v[48:49], v[128:129]
    v_pk_add_f32 v[50:51], v[50:51], v[130:131]
    v_pk_add_f32 v[52:53], v[52:53], v[132:133]
    v_pk_add_f32 v[54:55], v[54:55], v[134:135]
    s_waitcnt lgkmcnt(6)
    v_pk_add_f32 v[16:17], v[16:17], v[136:137]
    v_pk_add_f32 v[18:19], v[18:19], v[138:139]
    v_pk_add_f32 v[20:21], v[20:21], v[140:141]
    v_pk_add_f32 v[22:23], v[22:23], v[142:143]
    v_pk_add_f32 v[32:33], v[32:33], v[144:145]
    v_pk_add_f32 v[34:35], v[34:35], v[146:147]
    v_pk_add_f32 v[36:37], v[36:37], v[148:149]
    v_pk_add_f32 v[38:39], v[38:39], v[150:151]
    v_pk_add_f32 v[48:49], v[48:49], v[152:153]
    v_pk_add_f32 v[50:51], v[50:51], v[154:155]
    v_pk_add_f32 v[52:53], v[52:53], v[156:157]
    v_pk_add_f32 v[54:55], v[54:55], v[158:159]
    s_waitcnt lgkmcnt(0)
    v_pk_add_f32 v[16:17], v[16:17], v[160:161]
    v_pk_add_f32 v[18:19], v[18:19], v[162:163]
    v_pk_add_f32 v[20:21], v[20:21], v[164:165]
    v_pk_add_f32 v[22:23], v[22:23], v[166:167]
    v_pk_add_f32 v[32:33], v[32:33], v[168:169]
    v_pk_add_f32 v[34:35], v[34:35], v[170:171]
    v_pk_add_f32 v[36:37], v[36:37], v[172:173]
    v_pk_add_f32 v[38:39], v[38:39], v[174:175]
    v_pk_add_f32 v[48:49], v[48:49], v[176:177]
    v_pk_add_f32 v[50:51], v[50:51], v[178:179]
    v_pk_add_f32 v[52:53], v[52:53], v[180:181]
    v_pk_add_f32 v[54:55], v[54:55], v[182:183]
    v_and_b32 v2, 15, v1
    v_mul_u32_u24 v2, 144, v2
    v_lshrrev_b32 v3, 4, v1
    v_lshl_add_u32 v2, v3, 3, v2
    s_lshr_b32 s66, s60, 1
    s_mul_i32 s66, s66, 6912
    s_and_b32 s67, s60, 1
    s_lshl_b32 s67, s67, 6
    s_add_u32 s66, s66, s67
    v_add_u32 v2, s66, v2
    v_accvgpr_read_b32 v202, a240
    v_lshlrev_b32 v200, 16, v202
    v_and_b32 v201, 0xffff0000, v202
    v_pk_add_f32 v[16:17], v[16:17], v[200:201]
    v_accvgpr_read_b32 v202, a241
    v_lshlrev_b32 v200, 16, v202
    v_and_b32 v201, 0xffff0000, v202
    v_pk_add_f32 v[18:19], v[18:19], v[200:201]
    v_cvt_pk_bf16_f32 v16, v16, v17
    v_cvt_pk_bf16_f32 v17, v18, v19
    ds_write_b64 v2, v[16:17] offset:0
    v_accvgpr_read_b32 v202, a242
    v_lshlrev_b32 v200, 16, v202
    v_and_b32 v201, 0xffff0000, v202
    v_pk_add_f32 v[20:21], v[20:21], v[200:201]
    v_accvgpr_read_b32 v202, a243
    v_lshlrev_b32 v200, 16, v202
    v_and_b32 v201, 0xffff0000, v202
    v_pk_add_f32 v[22:23], v[22:23], v[200:201]
    v_cvt_pk_bf16_f32 v20, v20, v21
    v_cvt_pk_bf16_f32 v21, v22, v23
    ds_write_b64 v2, v[20:21] offset:32
    v_accvgpr_read_b32 v202, a244
    v_lshlrev_b32 v200, 16, v202
    v_and_b32 v201, 0xffff0000, v202
    v_pk_add_f32 v[32:33], v[32:33], v[200:201]
    v_accvgpr_read_b32 v202, a245
    v_lshlrev_b32 v200, 16, v202
    v_and_b32 v201, 0xffff0000, v202
    v_pk_add_f32 v[34:35], v[34:35], v[200:201]
    v_cvt_pk_bf16_f32 v32, v32, v33
    v_cvt_pk_bf16_f32 v33, v34, v35
    ds_write_b64 v2, v[32:33] offset:2304
    v_accvgpr_read_b32 v202, a246
    v_lshlrev_b32 v200, 16, v202
    v_and_b32 v201, 0xffff0000, v202
    v_pk_add_f32 v[36:37], v[36:37], v[200:201]
    v_accvgpr_read_b32 v202, a247
    v_lshlrev_b32 v200, 16, v202
    v_and_b32 v201, 0xffff0000, v202
    v_pk_add_f32 v[38:39], v[38:39], v[200:201]
    v_cvt_pk_bf16_f32 v36, v36, v37
    v_cvt_pk_bf16_f32 v37, v38, v39
    ds_write_b64 v2, v[36:37] offset:2336
    v_accvgpr_read_b32 v202, a248
    v_lshlrev_b32 v200, 16, v202
    v_and_b32 v201, 0xffff0000, v202
    v_pk_add_f32 v[48:49], v[48:49], v[200:201]
    v_accvgpr_read_b32 v202, a249
    v_lshlrev_b32 v200, 16, v202
    v_and_b32 v201, 0xffff0000, v202
    v_pk_add_f32 v[50:51], v[50:51], v[200:201]
    v_cvt_pk_bf16_f32 v48, v48, v49
    v_cvt_pk_bf16_f32 v49, v50, v51
    ds_write_b64 v2, v[48:49] offset:4608
    v_accvgpr_read_b32 v202, a250
    v_lshlrev_b32 v200, 16, v202
    v_and_b32 v201, 0xffff0000, v202
    v_pk_add_f32 v[52:53], v[52:53], v[200:201]
    v_accvgpr_read_b32 v202, a251
    v_lshlrev_b32 v200, 16, v202
    v_and_b32 v201, 0xffff0000, v202
    v_pk_add_f32 v[54:55], v[54:55], v[200:201]
    v_cvt_pk_bf16_f32 v52, v52, v53
    v_cvt_pk_bf16_f32 v53, v54, v55
    ds_write_b64 v2, v[52:53] offset:4640
    v_lshrrev_b32 v3, 3, v1
    v_and_b32 v4, 7, v1
    v_mul_u32_u24 v5, 144, v3
    v_lshl_add_u32 v5, v4, 4, v5
    s_mul_i32 s66, s60, 3456
    v_add_u32 v5, s66, v5
    v_mul_u32_u24 v3, 1280, v3
    v_lshl_add_u32 v3, v4, 4, v3
    s_mul_i32 s66, s95, 96
    s_mul_i32 s67, s60, 24
    s_add_u32 s66, s66, s67
    s_mul_i32 s66, s66, 1280
    s_lshl_b32 s67, s94, 7
    s_add_u32 s66, s66, s67
    s_waitcnt lgkmcnt(0)
    s_barrier
    ds_read_b128 v[200:203], v5 offset:0
    ds_read_b128 v[204:207], v5 offset:1152
    ds_read_b128 v[208:211], v5 offset:2304
    s_waitcnt lgkmcnt(2)
    buffer_store_dwordx4 v[200:203], v3, s[20:23], s66 offen sc1
    s_add_u32 s66, s66, 10240
    s_waitcnt lgkmcnt(1)
    buffer_store_dwordx4 v[204:207], v3, s[20:23], s66 offen sc1
    s_add_u32 s66, s66, 10240
    s_waitcnt lgkmcnt(0)
    buffer_store_dwordx4 v[208:211], v3, s[20:23], s66 offen sc1
L_p5end_28:
L_end:
    s_endpgm
.section .rodata,"a"
.p2align 6
.amdhsa_kernel sequential_preLN__linear_attn_block__glu_gated_reglu__prompt_kernel
  .amdhsa_next_free_vgpr 512
  .amdhsa_next_free_sgpr 102
  .amdhsa_accum_offset 256
  .amdhsa_group_segment_fixed_size 0
  .amdhsa_kernarg_size 80
  .amdhsa_user_sgpr_count 2
  .amdhsa_user_sgpr_kernarg_segment_ptr 1
  .amdhsa_system_sgpr_workgroup_id_x 1
.end_amdhsa_kernel
```
